```python
import torch

def _softmax(x, axis=-1):
    return torch.softmax(x, dim=axis)

def _gelu(x):
    return torch.nn.functional.gelu(x, approximate='tanh')

def _silu(x):
    return torch.nn.functional.silu(x)

def _sigmoid(x):
    return torch.sigmoid(x)

def _layernorm(x, axis=-1, eps=1e-05):
    m = x.mean(dim=axis, keepdim=True)
    v = x.var(dim=axis, keepdim=True, unbiased=False)
    return (x - m) / torch.sqrt(v + eps)

def _scatter_add(tgt, idx, src, axis=0):
    return tgt.clone().index_add_(axis, idx, src)

def _segment_sum(src, seg, n):
    out = torch.zeros((n,) + src.shape[1:], dtype=src.dtype)
    return out.index_add_(0, seg, src)

def _pad(x, pw):
    flat = tuple((v for pair in reversed(pw) for v in pair))
    return torch.nn.functional.pad(x, flat)
kernel_name = 'recurrent_scan__memory_aug_recurrent_mem_tr__swiglu_ffn__prompt'

def setup_inputs():

    _w = lambda a: (lambda t: t.to(torch.bfloat16) if t.is_floating_point() else t)(torch.as_tensor(a))

    def _A_setup():
        B, S, Dm = (1, 2048, 640)
        H, Dh = (32, 128)
        M, seg = (8, 32)
        seg = min(seg, S)
        S = S // seg * seg
        return {'x': _w((lambda *s: torch.randn(*s, dtype=torch.bfloat16) * 0.05)(B, S, Dm)), 'mem0': _w((lambda *s: torch.randn(*s, dtype=torch.bfloat16) * 0.2)(B, M, Dm)), 'Wq': _w((lambda *s: torch.randn(*s, dtype=torch.bfloat16) * 0.8)(Dm, H, Dh) * Dm ** (-0.5)), 'Wk': _w((lambda *s: torch.randn(*s, dtype=torch.bfloat16) * 0.8)(Dm, H, Dh) * Dm ** (-0.5)), 'Wv': _w((lambda *s: torch.randn(*s, dtype=torch.bfloat16) * 0.2)(Dm, H, Dh) * Dm ** (-0.5)), 'Wo': _w((lambda *s: torch.randn(*s, dtype=torch.bfloat16) * 0.2)(H, Dh, Dm) * (H * Dh) ** (-0.5)), 'seg_len': seg}
    _A_in = _A_setup()

    def _B_setup():
        B, S, D, F = (1, 2048, 640, 1728)
        return {'x': _w((lambda *s: torch.randn(*s, dtype=torch.bfloat16) * 0.05)(B, S, D)), 'w_gate': _w((lambda *s: torch.randn(*s, dtype=torch.bfloat16) * 0.1)(D, F)), 'w_up': _w((lambda *s: torch.randn(*s, dtype=torch.bfloat16) * 0.1)(D, F)), 'w_down': _w((lambda *s: torch.randn(*s, dtype=torch.bfloat16) * 0.1)(F, D))}
    _B_in = _B_setup()
    return {'A_x': _A_in['x'], 'A_mem0': _A_in['mem0'], 'A_Wq': _A_in['Wq'], 'A_Wk': _A_in['Wk'], 'A_Wv': _A_in['Wv'], 'A_Wo': _A_in['Wo'], 'A_seg_len': _A_in['seg_len'], 'B_x': _B_in['x'], 'B_w_gate': _B_in['w_gate'], 'B_w_up': _B_in['w_up'], 'B_w_down': _B_in['w_down']}

def reference(A_x, A_mem0, A_Wq, A_Wk, A_Wv, A_Wo, A_seg_len, B_x, B_w_gate, B_w_up, B_w_down):

    def _A_ref(x, mem0, Wq, Wk, Wv, Wo, seg_len):
        B, S, Dm = x.shape
        H, Dh = (Wq.shape[1], Wq.shape[2])
        M = mem0.shape[1]
        scale = Dh ** (-0.5)
        n_seg = S // seg_len
        L = M + seg_len
        idx = torch.arange(L)
        mask = (idx[:, None] < M) | (idx[:, None] >= idx[None, :])
        mem = mem0
        outs = []
        for s in range(n_seg):
            xs = x[:, s * seg_len:(s + 1) * seg_len, :].clone()
            h = torch.concatenate([mem, xs], axis=1)
            q = torch.einsum('btd,dhe->bhte', h, Wq)
            k = torch.einsum('btd,dhe->bhte', h, Wk)
            v = torch.einsum('btd,dhe->bhte', h, Wv)
            scores = torch.einsum('bhqe,bhke->bhqk', q, k) * scale
            scores = torch.where(mask[None, None], scores, -1000000000.0)
            p = _softmax(scores, axis=-1)
            o = torch.einsum('bhqk,bhke->bhqe', p, v)
            o = torch.einsum('bhte,hed->btd', o, Wo)
            mem = o[:, :M, :].clone()
            outs.append(o[:, M:, :])
        return torch.concatenate(outs, axis=1)

    def _B_ref(x, w_gate, w_up, w_down):
        g = _silu(x @ w_gate)
        u = x @ w_up
        return g * u @ w_down
    x = A_x
    xn = _layernorm(x, axis=-1)
    s = _A_ref(xn, A_mem0, A_Wq, A_Wk, A_Wv, A_Wo, A_seg_len)
    g = _silu(_B_ref(xn, B_w_gate, B_w_up, B_w_down))
    return x + s * g
```

```asm
; @launch grid=(256,1,1) block=(256,1,1) lds=163840
.amdgcn_target "amdgcn-amd-amdhsa--gfx950"
.text
.globl recurrent_scan__memory_aug_recurrent_mem_tr__swiglu_ffn__prompt_kernel
.p2align 8
.type recurrent_scan__memory_aug_recurrent_mem_tr__swiglu_ffn__prompt_kernel,@function
recurrent_scan__memory_aug_recurrent_mem_tr__swiglu_ffn__prompt_kernel:
    s_cmp_ge_u32 s2, 256
    s_cbranch_scc1 END
    s_load_dwordx2 s[4:5], s[0:1], 104
    s_mov_b32 s6, 0x10000000
    s_mov_b32 s7, 0x20000
    s_load_dwordx2 s[16:17], s[0:1], 96
    s_mov_b32 s18, 0x100
    s_mov_b32 s19, 0x20000
    s_load_dwordx2 s[8:9], s[0:1], 16
    s_mov_b32 s10, 0x500000
    s_mov_b32 s11, 0x20000
    s_load_dwordx2 s[12:13], s[0:1], 24
    s_mov_b32 s14, 0x500000
    s_mov_b32 s15, 0x20000
    s_load_dwordx2 s[20:21], s[0:1], 0
    s_mov_b32 s22, 0x280000
    s_mov_b32 s23, 0x20000
    s_load_dwordx2 s[24:25], s[0:1], 88
    s_mov_b32 s26, 0x280000
    s_mov_b32 s27, 0x20000
    s_getreg_b32 s35, hwreg(HW_REG_XCC_ID)
    s_and_b32 s35, s35, 15
    v_and_b32 v1, 63, v0
    v_lshrrev_b32 v2, 6, v0
    s_nop 1
    v_readfirstlane_b32 s28, v2
    s_mov_b32 s33, 200000
    s_waitcnt lgkmcnt(0)
    s_lshr_b32 s36, s2, 3
    s_and_b32 s37, s2, 7
    s_mul_i32 s29, s36, 6
    s_add_u32 s29, s29, s37
    s_add_u32 s29, s29, 62
    s_cmp_ge_u32 s37, 2
    s_cbranch_scc1 rl_1
    s_lshl_b32 s29, s37, 5
    s_add_u32 s29, s29, s36
    s_cmp_lg_u32 s28, 0
    s_cbranch_scc1 rl_1
    s_lshl_b32 s35, 1, s35
    s_lshl_b32 s37, s37, 2
    v_mov_b32 v4, s35
    v_mov_b32 v5, s37
    s_mov_b64 exec, 1
    buffer_atomic_or v4, v5, s[16:19], 0 offen sc1
    s_mov_b64 exec, -1
rl_1:
    s_cmp_lt_u32 s29, 64
    s_cbranch_scc1 ROLE_CH0
    s_mov_b32 s39, s2
clr_3:
    s_mul_i32 s36, s39, 17920
    s_add_u32 s36, s36, 0x6000000
    v_lshlrev_b32 v6, 4, v0
    v_mov_b32 v8, -1
    v_mov_b32 v12, 0
    v_mov_b32 v9, -1
    v_mov_b32 v13, 0
    v_mov_b32 v10, -1
    v_mov_b32 v14, 0
    v_mov_b32 v11, -1
    v_mov_b32 v15, 0
    buffer_store_dwordx4 v[8:11], v6, s[4:7], s36 offen sc1
    s_add_u32 s36, s36, 4096
    buffer_store_dwordx4 v[8:11], v6, s[4:7], s36 offen sc1
    s_add_u32 s36, s36, 4096
    buffer_store_dwordx4 v[8:11], v6, s[4:7], s36 offen sc1
    s_add_u32 s36, s36, 4096
    buffer_store_dwordx4 v[8:11], v6, s[4:7], s36 offen sc1
    s_add_u32 s36, s36, 4096
    s_mov_b32 s50, 96
    v_cmp_gt_u32 vcc, s50, v0
    s_and_saveexec_b64 s[50:51], vcc
    buffer_store_dwordx4 v[8:11], v6, s[4:7], s36 offen sc1
    s_mov_b64 exec, s[50:51]
    s_lshl_b32 s36, s39, 7
    s_add_u32 s36, s36, 0x6460000
    v_cmp_gt_u32 vcc, 8, v0
    s_and_saveexec_b64 s[50:51], vcc
    buffer_store_dwordx4 v[12:15], v6, s[4:7], s36 offen sc1
    s_mov_b64 exec, s[50:51]
    s_and_b32 s37, s39, 7
    s_sub_u32 s37, s37, 2
    s_cmp_ge_u32 s37, 2
    s_cbranch_scc1 clr_4
    s_sub_u32 s39, s39, 2
    s_branch clr_3
clr_4:
    s_waitcnt vmcnt(0)
    s_barrier
    s_cmp_lg_u32 s28, 0
    s_cbranch_scc1 arr_5
    v_mov_b32 v4, 1
    v_mov_b32 v5, 36
    s_mov_b64 exec, 1
    buffer_atomic_add v4, v5, s[16:19], 0 offen sc1
    s_mov_b64 exec, -1
arr_5:
    s_cmp_lt_u32 s29, 96
    s_cbranch_scc1 ROLE_K
    s_cmp_lt_u32 s29, 128
    s_cbranch_scc1 ROLE_V
    s_cmp_lt_u32 s29, 160
    s_cbranch_scc1 ROLE_QA
    s_cmp_lt_u32 s29, 200
    s_cbranch_scc1 ROLE_OP
    s_cmp_lt_u32 s29, 227
    s_cbranch_scc1 ROLE_F1
    s_cmp_lt_u32 s29, 247
    s_cbranch_scc1 ROLE_F2
    s_branch END
ROLE_CH0:
    s_branch ROLE_CH
END:
    s_endpgm
ROLE_CH:
    s_lshr_b32 s44, s29, 5
    s_and_b32 s45, s29, 31
    s_lshr_b32 s42, s29, 1
    s_and_b32 s43, s29, 1
    s_load_dwordx2 s[8:9], s[0:1], 16
    s_mov_b32 s10, 0x500000
    s_mov_b32 s11, 0x20000
    s_load_dwordx2 s[12:13], s[0:1], 24
    s_mov_b32 s14, 0x500000
    s_mov_b32 s15, 0x20000
    s_load_dwordx2 s[20:21], s[0:1], 32
    s_mov_b32 s22, 0x500000
    s_mov_b32 s23, 0x20000
    s_load_dwordx2 s[24:25], s[0:1], 40
    s_mov_b32 s26, 0x500000
    s_mov_b32 s27, 0x20000
    s_waitcnt lgkmcnt(0)
    s_lshl_b32 s46, s42, 8
    s_lshl_b32 s47, s28, 2
    v_lshrrev_b32 v48, 4, v1
    v_and_b32 v49, 15, v1
    v_lshlrev_b32 v50, 1, v48
    v_xor_b32 v49, v49, v50
    s_lshr_b32 s34, s28, 1
    s_lshl_b32 s34, s34, 3
    v_xor_b32 v49, s34, v49
    s_mov_b32 s34, 8192
    v_mul_lo_u32 v48, v48, s34
    v_lshlrev_b32 v49, 4, v49
    v_add_u32 v5, v48, v49
    v_lshrrev_b32 v48, 4, v1
    v_bfe_u32 v49, v1, 2, 2
    v_and_b32 v52, 3, v1
    v_add_u32 v50, s47, v52
    v_mov_b32 v51, 0
    v_and_b32 v53, 1, v48
    v_lshl_or_b32 v53, v53, 2, v49
    v_lshlrev_b32 v53, 1, v53
    v_xor_b32 v50, v50, v53
    v_lshlrev_b32 v50, 4, v50
    v_lshl_add_u32 v50, v51, 3, v50
    v_lshl_add_u32 v50, v49, 8, v50
    v_lshl_add_u32 v6, v48, 11, v50
    v_lshrrev_b32 v48, 4, v1
    v_bfe_u32 v49, v1, 2, 2
    v_and_b32 v52, 3, v1
    v_add_u32 v50, s47, v52
    v_mov_b32 v51, 1
    v_and_b32 v53, 1, v48
    v_lshl_or_b32 v53, v53, 2, v49
    v_lshlrev_b32 v53, 1, v53
    v_xor_b32 v50, v50, v53
    v_lshlrev_b32 v50, 4, v50
    v_lshl_add_u32 v50, v51, 3, v50
    v_lshl_add_u32 v50, v49, 8, v50
    v_lshl_add_u32 v7, v48, 11, v50
    v_add_u32 v54, 0x10000, v6
    v_add_u32 v55, 0x10000, v7
    v_add_u32 v56, 0x20000, v6
    v_add_u32 v57, 0x20000, v7
    s_add_u32 s49, s46, 2621440
    s_mul_i32 s41, s28, 32768
    s_add_u32 s41, s41, s46
    s_lshl_b32 s40, s28, 10
    s_add_u32 s40, s40, 0
    s_mov_b32 m0, s40
    s_nop 0
    buffer_load_dwordx4 v5, s[8:11], s41 offen lds
    s_add_u32 s40, s40, 4096
    s_add_u32 s41, s41, 131072
    s_mov_b32 m0, s40
    s_nop 0
    buffer_load_dwordx4 v5, s[8:11], s41 offen lds
    s_add_u32 s40, s40, 4096
    s_add_u32 s41, s41, 131072
    s_mov_b32 m0, s40
    s_nop 0
    buffer_load_dwordx4 v5, s[8:11], s41 offen lds
    s_add_u32 s40, s40, 4096
    s_add_u32 s41, s41, 131072
    s_mov_b32 m0, s40
    s_nop 0
    buffer_load_dwordx4 v5, s[8:11], s41 offen lds
    s_add_u32 s40, s40, 4096
    s_add_u32 s41, s41, 131072
    s_mov_b32 m0, s40
    s_nop 0
    buffer_load_dwordx4 v5, s[8:11], s41 offen lds
    s_add_u32 s40, s40, 4096
    s_add_u32 s41, s41, 131072
    s_mov_b32 m0, s40
    s_nop 0
    buffer_load_dwordx4 v5, s[8:11], s41 offen lds
    s_add_u32 s40, s40, 4096
    s_add_u32 s41, s41, 131072
    s_mov_b32 m0, s40
    s_nop 0
    buffer_load_dwordx4 v5, s[8:11], s41 offen lds
    s_add_u32 s40, s40, 4096
    s_add_u32 s41, s41, 131072
    s_mov_b32 m0, s40
    s_nop 0
    buffer_load_dwordx4 v5, s[8:11], s41 offen lds
    s_add_u32 s40, s40, 4096
    s_add_u32 s41, s41, 131072
    s_mov_b32 m0, s40
    s_nop 0
    buffer_load_dwordx4 v5, s[8:11], s41 offen lds
    s_add_u32 s40, s40, 4096
    s_add_u32 s41, s41, 131072
    s_mov_b32 m0, s40
    s_nop 0
    buffer_load_dwordx4 v5, s[8:11], s41 offen lds
    s_add_u32 s40, s40, 4096
    s_add_u32 s41, s41, 131072
    s_mov_b32 m0, s40
    s_nop 0
    buffer_load_dwordx4 v5, s[8:11], s41 offen lds
    s_add_u32 s40, s40, 4096
    s_add_u32 s41, s41, 131072
    s_mov_b32 m0, s40
    s_nop 0
    buffer_load_dwordx4 v5, s[8:11], s41 offen lds
    s_add_u32 s40, s40, 4096
    s_add_u32 s41, s41, 131072
    s_mov_b32 m0, s40
    s_nop 0
    buffer_load_dwordx4 v5, s[8:11], s41 offen lds
    s_add_u32 s40, s40, 4096
    s_add_u32 s41, s41, 131072
    s_mov_b32 m0, s40
    s_nop 0
    buffer_load_dwordx4 v5, s[8:11], s41 offen lds
    s_add_u32 s40, s40, 4096
    s_add_u32 s41, s41, 131072
    s_mov_b32 m0, s40
    s_nop 0
    buffer_load_dwordx4 v5, s[8:11], s41 offen lds
    s_add_u32 s40, s40, 4096
    s_add_u32 s41, s41, 131072
    s_mov_b32 m0, s40
    s_nop 0
    buffer_load_dwordx4 v5, s[8:11], s41 offen lds
    s_add_u32 s40, s40, 4096
    s_add_u32 s41, s41, 131072
    s_mov_b32 m0, s40
    s_nop 0
    buffer_load_dwordx4 v5, s[8:11], s41 offen lds
    s_add_u32 s40, s40, 4096
    s_add_u32 s41, s41, 131072
    s_mov_b32 m0, s40
    s_nop 0
    buffer_load_dwordx4 v5, s[8:11], s41 offen lds
    s_add_u32 s40, s40, 4096
    s_add_u32 s41, s41, 131072
    s_mov_b32 m0, s40
    s_nop 0
    buffer_load_dwordx4 v5, s[8:11], s41 offen lds
    s_add_u32 s40, s40, 4096
    s_add_u32 s41, s41, 131072
    s_mov_b32 m0, s40
    s_nop 0
    buffer_load_dwordx4 v5, s[8:11], s41 offen lds
    s_mul_i32 s41, s28, 32768
    s_add_u32 s41, s41, s49
    s_lshl_b32 s40, s28, 10
    s_add_u32 s40, s40, 81920
    s_mov_b32 m0, s40
    s_nop 0
    buffer_load_dwordx4 v5, s[8:11], s41 offen lds
    s_add_u32 s40, s40, 4096
    s_add_u32 s41, s41, 131072
    s_mov_b32 m0, s40
    s_nop 0
    buffer_load_dwordx4 v5, s[8:11], s41 offen lds
    s_add_u32 s40, s40, 4096
    s_add_u32 s41, s41, 131072
    s_mov_b32 m0, s40
    s_nop 0
    buffer_load_dwordx4 v5, s[8:11], s41 offen lds
    s_add_u32 s40, s40, 4096
    s_add_u32 s41, s41, 131072
    s_mov_b32 m0, s40
    s_nop 0
    buffer_load_dwordx4 v5, s[8:11], s41 offen lds
    s_add_u32 s40, s40, 4096
    s_add_u32 s41, s41, 131072
    s_mov_b32 m0, s40
    s_nop 0
    buffer_load_dwordx4 v5, s[8:11], s41 offen lds
    s_add_u32 s40, s40, 4096
    s_add_u32 s41, s41, 131072
    s_mov_b32 m0, s40
    s_nop 0
    buffer_load_dwordx4 v5, s[8:11], s41 offen lds
    s_add_u32 s40, s40, 4096
    s_add_u32 s41, s41, 131072
    s_mov_b32 m0, s40
    s_nop 0
    buffer_load_dwordx4 v5, s[8:11], s41 offen lds
    s_add_u32 s40, s40, 4096
    s_add_u32 s41, s41, 131072
    s_mov_b32 m0, s40
    s_nop 0
    buffer_load_dwordx4 v5, s[8:11], s41 offen lds
    s_add_u32 s40, s40, 4096
    s_add_u32 s41, s41, 131072
    s_mov_b32 m0, s40
    s_nop 0
    buffer_load_dwordx4 v5, s[8:11], s41 offen lds
    s_add_u32 s40, s40, 4096
    s_add_u32 s41, s41, 131072
    s_mov_b32 m0, s40
    s_nop 0
    buffer_load_dwordx4 v5, s[8:11], s41 offen lds
    s_add_u32 s40, s40, 4096
    s_add_u32 s41, s41, 131072
    s_mov_b32 m0, s40
    s_nop 0
    buffer_load_dwordx4 v5, s[8:11], s41 offen lds
    s_add_u32 s40, s40, 4096
    s_add_u32 s41, s41, 131072
    s_mov_b32 m0, s40
    s_nop 0
    buffer_load_dwordx4 v5, s[8:11], s41 offen lds
    s_add_u32 s40, s40, 4096
    s_add_u32 s41, s41, 131072
    s_mov_b32 m0, s40
    s_nop 0
    buffer_load_dwordx4 v5, s[8:11], s41 offen lds
    s_add_u32 s40, s40, 4096
    s_add_u32 s41, s41, 131072
    s_mov_b32 m0, s40
    s_nop 0
    buffer_load_dwordx4 v5, s[8:11], s41 offen lds
    s_add_u32 s40, s40, 4096
    s_add_u32 s41, s41, 131072
    s_mov_b32 m0, s40
    s_nop 0
    buffer_load_dwordx4 v5, s[8:11], s41 offen lds
    s_add_u32 s40, s40, 4096
    s_add_u32 s41, s41, 131072
    s_mov_b32 m0, s40
    s_nop 0
    buffer_load_dwordx4 v5, s[8:11], s41 offen lds
    s_add_u32 s40, s40, 4096
    s_add_u32 s41, s41, 131072
    s_mov_b32 m0, s40
    s_nop 0
    buffer_load_dwordx4 v5, s[8:11], s41 offen lds
    s_add_u32 s40, s40, 4096
    s_add_u32 s41, s41, 131072
    s_mov_b32 m0, s40
    s_nop 0
    buffer_load_dwordx4 v5, s[8:11], s41 offen lds
    s_add_u32 s40, s40, 4096
    s_add_u32 s41, s41, 131072
    s_mov_b32 m0, s40
    s_nop 0
    buffer_load_dwordx4 v5, s[8:11], s41 offen lds
    s_add_u32 s40, s40, 4096
    s_add_u32 s41, s41, 131072
    s_mov_b32 m0, s40
    s_nop 0
    buffer_load_dwordx4 v5, s[8:11], s41 offen lds
    s_waitcnt vmcnt(20)
    s_barrier
    s_cmp_lg_u32 s28, 0
    s_cbranch_scc1 arr_6
    v_mov_b32 v48, 1
    v_mov_b32 v49, 40
    s_mov_b64 exec, 1
    buffer_atomic_add v48, v49, s[16:19], 0 offen sc1
    s_mov_b64 exec, -1
arr_6:
    ds_read_b64_tr_b16 a[0:1], v6 offset:0
    ds_read_b64_tr_b16 a[2:3], v6 offset:1024
    ds_read_b64_tr_b16 a[80:81], v7 offset:0
    ds_read_b64_tr_b16 a[82:83], v7 offset:1024
    ds_read_b64_tr_b16 a[4:5], v6 offset:8192
    ds_read_b64_tr_b16 a[6:7], v6 offset:9216
    ds_read_b64_tr_b16 a[84:85], v7 offset:8192
    ds_read_b64_tr_b16 a[86:87], v7 offset:9216
    ds_read_b64_tr_b16 a[8:9], v6 offset:16384
    ds_read_b64_tr_b16 a[10:11], v6 offset:17408
    ds_read_b64_tr_b16 a[88:89], v7 offset:16384
    ds_read_b64_tr_b16 a[90:91], v7 offset:17408
    ds_read_b64_tr_b16 a[12:13], v6 offset:24576
    ds_read_b64_tr_b16 a[14:15], v6 offset:25600
    ds_read_b64_tr_b16 a[92:93], v7 offset:24576
    ds_read_b64_tr_b16 a[94:95], v7 offset:25600
    s_waitcnt lgkmcnt(0)
    ds_read_b64_tr_b16 a[16:17], v6 offset:32768
    ds_read_b64_tr_b16 a[18:19], v6 offset:33792
    ds_read_b64_tr_b16 a[96:97], v7 offset:32768
    ds_read_b64_tr_b16 a[98:99], v7 offset:33792
    ds_read_b64_tr_b16 a[20:21], v6 offset:40960
    ds_read_b64_tr_b16 a[22:23], v6 offset:41984
    ds_read_b64_tr_b16 a[100:101], v7 offset:40960
    ds_read_b64_tr_b16 a[102:103], v7 offset:41984
    ds_read_b64_tr_b16 a[24:25], v6 offset:49152
    ds_read_b64_tr_b16 a[26:27], v6 offset:50176
    ds_read_b64_tr_b16 a[104:105], v7 offset:49152
    ds_read_b64_tr_b16 a[106:107], v7 offset:50176
    ds_read_b64_tr_b16 a[28:29], v6 offset:57344
    ds_read_b64_tr_b16 a[30:31], v6 offset:58368
    ds_read_b64_tr_b16 a[108:109], v7 offset:57344
    ds_read_b64_tr_b16 a[110:111], v7 offset:58368
    s_waitcnt lgkmcnt(0)
    ds_read_b64_tr_b16 a[32:33], v54 offset:0
    ds_read_b64_tr_b16 a[34:35], v54 offset:1024
    ds_read_b64_tr_b16 a[112:113], v55 offset:0
    ds_read_b64_tr_b16 a[114:115], v55 offset:1024
    ds_read_b64_tr_b16 a[36:37], v54 offset:8192
    ds_read_b64_tr_b16 a[38:39], v54 offset:9216
    ds_read_b64_tr_b16 a[116:117], v55 offset:8192
    ds_read_b64_tr_b16 a[118:119], v55 offset:9216
    s_waitcnt lgkmcnt(0)
    s_barrier
    s_mul_i32 s41, s28, 32768
    s_add_u32 s41, s41, s46
    s_lshl_b32 s40, s28, 10
    s_add_u32 s40, s40, 0
    s_mov_b32 m0, s40
    s_nop 0
    buffer_load_dwordx4 v5, s[12:15], s41 offen lds
    s_add_u32 s40, s40, 4096
    s_add_u32 s41, s41, 131072
    s_mov_b32 m0, s40
    s_nop 0
    buffer_load_dwordx4 v5, s[12:15], s41 offen lds
    s_add_u32 s40, s40, 4096
    s_add_u32 s41, s41, 131072
    s_mov_b32 m0, s40
    s_nop 0
    buffer_load_dwordx4 v5, s[12:15], s41 offen lds
    s_add_u32 s40, s40, 4096
    s_add_u32 s41, s41, 131072
    s_mov_b32 m0, s40
    s_nop 0
    buffer_load_dwordx4 v5, s[12:15], s41 offen lds
    s_add_u32 s40, s40, 4096
    s_add_u32 s41, s41, 131072
    s_mov_b32 m0, s40
    s_nop 0
    buffer_load_dwordx4 v5, s[12:15], s41 offen lds
    s_add_u32 s40, s40, 4096
    s_add_u32 s41, s41, 131072
    s_mov_b32 m0, s40
    s_nop 0
    buffer_load_dwordx4 v5, s[12:15], s41 offen lds
    s_add_u32 s40, s40, 4096
    s_add_u32 s41, s41, 131072
    s_mov_b32 m0, s40
    s_nop 0
    buffer_load_dwordx4 v5, s[12:15], s41 offen lds
    s_add_u32 s40, s40, 4096
    s_add_u32 s41, s41, 131072
    s_mov_b32 m0, s40
    s_nop 0
    buffer_load_dwordx4 v5, s[12:15], s41 offen lds
    s_add_u32 s40, s40, 4096
    s_add_u32 s41, s41, 131072
    s_mov_b32 m0, s40
    s_nop 0
    buffer_load_dwordx4 v5, s[12:15], s41 offen lds
    s_add_u32 s40, s40, 4096
    s_add_u32 s41, s41, 131072
    s_mov_b32 m0, s40
    s_nop 0
    buffer_load_dwordx4 v5, s[12:15], s41 offen lds
    s_add_u32 s40, s40, 4096
    s_add_u32 s41, s41, 131072
    s_mov_b32 m0, s40
    s_nop 0
    buffer_load_dwordx4 v5, s[12:15], s41 offen lds
    s_add_u32 s40, s40, 4096
    s_add_u32 s41, s41, 131072
    s_mov_b32 m0, s40
    s_nop 0
    buffer_load_dwordx4 v5, s[12:15], s41 offen lds
    s_add_u32 s40, s40, 4096
    s_add_u32 s41, s41, 131072
    s_mov_b32 m0, s40
    s_nop 0
    buffer_load_dwordx4 v5, s[12:15], s41 offen lds
    s_add_u32 s40, s40, 4096
    s_add_u32 s41, s41, 131072
    s_mov_b32 m0, s40
    s_nop 0
    buffer_load_dwordx4 v5, s[12:15], s41 offen lds
    s_add_u32 s40, s40, 4096
    s_add_u32 s41, s41, 131072
    s_mov_b32 m0, s40
    s_nop 0
    buffer_load_dwordx4 v5, s[12:15], s41 offen lds
    s_add_u32 s40, s40, 4096
    s_add_u32 s41, s41, 131072
    s_mov_b32 m0, s40
    s_nop 0
    buffer_load_dwordx4 v5, s[12:15], s41 offen lds
    s_add_u32 s40, s40, 4096
    s_add_u32 s41, s41, 131072
    s_mov_b32 m0, s40
    s_nop 0
    buffer_load_dwordx4 v5, s[12:15], s41 offen lds
    s_add_u32 s40, s40, 4096
    s_add_u32 s41, s41, 131072
    s_mov_b32 m0, s40
    s_nop 0
    buffer_load_dwordx4 v5, s[12:15], s41 offen lds
    s_add_u32 s40, s40, 4096
    s_add_u32 s41, s41, 131072
    s_mov_b32 m0, s40
    s_nop 0
    buffer_load_dwordx4 v5, s[12:15], s41 offen lds
    s_add_u32 s40, s40, 4096
    s_add_u32 s41, s41, 131072
    s_mov_b32 m0, s40
    s_nop 0
    buffer_load_dwordx4 v5, s[12:15], s41 offen lds
    s_waitcnt vmcnt(20)
    s_barrier
    ds_read_b64_tr_b16 a[40:41], v54 offset:16384
    ds_read_b64_tr_b16 a[42:43], v54 offset:17408
    ds_read_b64_tr_b16 a[120:121], v55 offset:16384
    ds_read_b64_tr_b16 a[122:123], v55 offset:17408
    ds_read_b64_tr_b16 a[44:45], v54 offset:24576
    ds_read_b64_tr_b16 a[46:47], v54 offset:25600
    ds_read_b64_tr_b16 a[124:125], v55 offset:24576
    ds_read_b64_tr_b16 a[126:127], v55 offset:25600
    s_waitcnt lgkmcnt(0)
    ds_read_b64_tr_b16 a[48:49], v54 offset:32768
    ds_read_b64_tr_b16 a[50:51], v54 offset:33792
    ds_read_b64_tr_b16 a[128:129], v55 offset:32768
    ds_read_b64_tr_b16 a[130:131], v55 offset:33792
    ds_read_b64_tr_b16 a[52:53], v54 offset:40960
    ds_read_b64_tr_b16 a[54:55], v54 offset:41984
    ds_read_b64_tr_b16 a[132:133], v55 offset:40960
    ds_read_b64_tr_b16 a[134:135], v55 offset:41984
    ds_read_b64_tr_b16 a[56:57], v54 offset:49152
    ds_read_b64_tr_b16 a[58:59], v54 offset:50176
    ds_read_b64_tr_b16 a[136:137], v55 offset:49152
    ds_read_b64_tr_b16 a[138:139], v55 offset:50176
    ds_read_b64_tr_b16 a[60:61], v54 offset:57344
    ds_read_b64_tr_b16 a[62:63], v54 offset:58368
    ds_read_b64_tr_b16 a[140:141], v55 offset:57344
    ds_read_b64_tr_b16 a[142:143], v55 offset:58368
    s_waitcnt lgkmcnt(0)
    ds_read_b64_tr_b16 a[64:65], v56 offset:0
    ds_read_b64_tr_b16 a[66:67], v56 offset:1024
    ds_read_b64_tr_b16 a[144:145], v57 offset:0
    ds_read_b64_tr_b16 a[146:147], v57 offset:1024
    ds_read_b64_tr_b16 a[68:69], v56 offset:8192
    ds_read_b64_tr_b16 a[70:71], v56 offset:9216
    ds_read_b64_tr_b16 a[148:149], v57 offset:8192
    ds_read_b64_tr_b16 a[150:151], v57 offset:9216
    ds_read_b64_tr_b16 a[72:73], v56 offset:16384
    ds_read_b64_tr_b16 a[74:75], v56 offset:17408
    ds_read_b64_tr_b16 a[152:153], v57 offset:16384
    ds_read_b64_tr_b16 a[154:155], v57 offset:17408
    ds_read_b64_tr_b16 a[76:77], v56 offset:24576
    ds_read_b64_tr_b16 a[78:79], v56 offset:25600
    ds_read_b64_tr_b16 a[156:157], v57 offset:24576
    ds_read_b64_tr_b16 a[158:159], v57 offset:25600
    s_waitcnt lgkmcnt(0)
    s_waitcnt lgkmcnt(0)
    s_barrier
    s_mul_i32 s41, s28, 32768
    s_add_u32 s41, s41, s49
    s_lshl_b32 s40, s28, 10
    s_add_u32 s40, s40, 81920
    s_mov_b32 m0, s40
    s_nop 0
    buffer_load_dwordx4 v5, s[12:15], s41 offen lds
    s_add_u32 s40, s40, 4096
    s_add_u32 s41, s41, 131072
    s_mov_b32 m0, s40
    s_nop 0
    buffer_load_dwordx4 v5, s[12:15], s41 offen lds
    s_add_u32 s40, s40, 4096
    s_add_u32 s41, s41, 131072
    s_mov_b32 m0, s40
    s_nop 0
    buffer_load_dwordx4 v5, s[12:15], s41 offen lds
    s_add_u32 s40, s40, 4096
    s_add_u32 s41, s41, 131072
    s_mov_b32 m0, s40
    s_nop 0
    buffer_load_dwordx4 v5, s[12:15], s41 offen lds
    s_add_u32 s40, s40, 4096
    s_add_u32 s41, s41, 131072
    s_mov_b32 m0, s40
    s_nop 0
    buffer_load_dwordx4 v5, s[12:15], s41 offen lds
    s_add_u32 s40, s40, 4096
    s_add_u32 s41, s41, 131072
    s_mov_b32 m0, s40
    s_nop 0
    buffer_load_dwordx4 v5, s[12:15], s41 offen lds
    s_add_u32 s40, s40, 4096
    s_add_u32 s41, s41, 131072
    s_mov_b32 m0, s40
    s_nop 0
    buffer_load_dwordx4 v5, s[12:15], s41 offen lds
    s_add_u32 s40, s40, 4096
    s_add_u32 s41, s41, 131072
    s_mov_b32 m0, s40
    s_nop 0
    buffer_load_dwordx4 v5, s[12:15], s41 offen lds
    s_add_u32 s40, s40, 4096
    s_add_u32 s41, s41, 131072
    s_mov_b32 m0, s40
    s_nop 0
    buffer_load_dwordx4 v5, s[12:15], s41 offen lds
    s_add_u32 s40, s40, 4096
    s_add_u32 s41, s41, 131072
    s_mov_b32 m0, s40
    s_nop 0
    buffer_load_dwordx4 v5, s[12:15], s41 offen lds
    s_add_u32 s40, s40, 4096
    s_add_u32 s41, s41, 131072
    s_mov_b32 m0, s40
    s_nop 0
    buffer_load_dwordx4 v5, s[12:15], s41 offen lds
    s_add_u32 s40, s40, 4096
    s_add_u32 s41, s41, 131072
    s_mov_b32 m0, s40
    s_nop 0
    buffer_load_dwordx4 v5, s[12:15], s41 offen lds
    s_add_u32 s40, s40, 4096
    s_add_u32 s41, s41, 131072
    s_mov_b32 m0, s40
    s_nop 0
    buffer_load_dwordx4 v5, s[12:15], s41 offen lds
    s_add_u32 s40, s40, 4096
    s_add_u32 s41, s41, 131072
    s_mov_b32 m0, s40
    s_nop 0
    buffer_load_dwordx4 v5, s[12:15], s41 offen lds
    s_add_u32 s40, s40, 4096
    s_add_u32 s41, s41, 131072
    s_mov_b32 m0, s40
    s_nop 0
    buffer_load_dwordx4 v5, s[12:15], s41 offen lds
    s_add_u32 s40, s40, 4096
    s_add_u32 s41, s41, 131072
    s_mov_b32 m0, s40
    s_nop 0
    buffer_load_dwordx4 v5, s[12:15], s41 offen lds
    s_add_u32 s40, s40, 4096
    s_add_u32 s41, s41, 131072
    s_mov_b32 m0, s40
    s_nop 0
    buffer_load_dwordx4 v5, s[12:15], s41 offen lds
    s_add_u32 s40, s40, 4096
    s_add_u32 s41, s41, 131072
    s_mov_b32 m0, s40
    s_nop 0
    buffer_load_dwordx4 v5, s[12:15], s41 offen lds
    s_add_u32 s40, s40, 4096
    s_add_u32 s41, s41, 131072
    s_mov_b32 m0, s40
    s_nop 0
    buffer_load_dwordx4 v5, s[12:15], s41 offen lds
    s_add_u32 s40, s40, 4096
    s_add_u32 s41, s41, 131072
    s_mov_b32 m0, s40
    s_nop 0
    buffer_load_dwordx4 v5, s[12:15], s41 offen lds
    s_waitcnt vmcnt(20)
    s_barrier
    ds_read_b64_tr_b16 a[160:161], v6 offset:0
    ds_read_b64_tr_b16 a[162:163], v6 offset:1024
    ds_read_b64_tr_b16 a[240:241], v7 offset:0
    ds_read_b64_tr_b16 a[242:243], v7 offset:1024
    ds_read_b64_tr_b16 a[164:165], v6 offset:8192
    ds_read_b64_tr_b16 a[166:167], v6 offset:9216
    ds_read_b64_tr_b16 a[244:245], v7 offset:8192
    ds_read_b64_tr_b16 a[246:247], v7 offset:9216
    ds_read_b64_tr_b16 a[168:169], v6 offset:16384
    ds_read_b64_tr_b16 a[170:171], v6 offset:17408
    ds_read_b64_tr_b16 a[248:249], v7 offset:16384
    ds_read_b64_tr_b16 a[250:251], v7 offset:17408
    ds_read_b64_tr_b16 a[172:173], v6 offset:24576
    ds_read_b64_tr_b16 a[174:175], v6 offset:25600
    ds_read_b64_tr_b16 a[252:253], v7 offset:24576
    ds_read_b64_tr_b16 a[254:255], v7 offset:25600
    s_waitcnt lgkmcnt(0)
    ds_read_b64_tr_b16 a[176:177], v6 offset:32768
    ds_read_b64_tr_b16 a[178:179], v6 offset:33792
    ds_read_b64_tr_b16 v[192:193], v7 offset:32768
    ds_read_b64_tr_b16 v[194:195], v7 offset:33792
    ds_read_b64_tr_b16 a[180:181], v6 offset:40960
    ds_read_b64_tr_b16 a[182:183], v6 offset:41984
    ds_read_b64_tr_b16 v[196:197], v7 offset:40960
    ds_read_b64_tr_b16 v[198:199], v7 offset:41984
    ds_read_b64_tr_b16 a[184:185], v6 offset:49152
    ds_read_b64_tr_b16 a[186:187], v6 offset:50176
    ds_read_b64_tr_b16 v[200:201], v7 offset:49152
    ds_read_b64_tr_b16 v[202:203], v7 offset:50176
    ds_read_b64_tr_b16 a[188:189], v6 offset:57344
    ds_read_b64_tr_b16 a[190:191], v6 offset:58368
    ds_read_b64_tr_b16 v[204:205], v7 offset:57344
    ds_read_b64_tr_b16 v[206:207], v7 offset:58368
    s_waitcnt lgkmcnt(0)
    ds_read_b64_tr_b16 a[192:193], v54 offset:0
    ds_read_b64_tr_b16 a[194:195], v54 offset:1024
    ds_read_b64_tr_b16 v[208:209], v55 offset:0
    ds_read_b64_tr_b16 v[210:211], v55 offset:1024
    ds_read_b64_tr_b16 a[196:197], v54 offset:8192
    ds_read_b64_tr_b16 a[198:199], v54 offset:9216
    ds_read_b64_tr_b16 v[212:213], v55 offset:8192
    ds_read_b64_tr_b16 v[214:215], v55 offset:9216
    s_waitcnt lgkmcnt(0)
    s_barrier
    v_lshrrev_b32 v48, 4, v1
    v_and_b32 v49, 15, v1
    v_lshlrev_b32 v50, 1, v48
    v_xor_b32 v49, v49, v50
    s_lshr_b32 s34, s28, 1
    s_lshl_b32 s34, s34, 3
    v_xor_b32 v49, s34, v49
    s_mov_b32 s34, 1280
    v_mul_lo_u32 v48, v48, s34
    v_lshlrev_b32 v49, 4, v49
    v_add_u32 v5, v48, v49
    s_lshl_b32 s35, s42, 7
    s_lshl_b32 s36, s43, 6
    s_add_u32 s35, s35, s36
    s_mul_i32 s48, s35, 1280
    s_mul_i32 s41, s28, 5120
    s_add_u32 s41, s41, s48
    s_lshl_b32 s40, s28, 10
    s_add_u32 s40, s40, 0
    s_mov_b32 m0, s40
    s_nop 0
    buffer_load_dwordx4 v5, s[24:27], s41 offen lds
    s_add_u32 s40, s40, 4096
    s_add_u32 s41, s41, 20480
    s_mov_b32 m0, s40
    s_nop 0
    buffer_load_dwordx4 v5, s[24:27], s41 offen lds
    s_add_u32 s40, s40, 4096
    s_add_u32 s41, s41, 20480
    s_mov_b32 m0, s40
    s_nop 0
    buffer_load_dwordx4 v5, s[24:27], s41 offen lds
    s_add_u32 s40, s40, 4096
    s_add_u32 s41, s41, 20480
    s_mov_b32 m0, s40
    s_nop 0
    buffer_load_dwordx4 v5, s[24:27], s41 offen lds
    s_add_u32 s48, s48, 256
    s_mul_i32 s41, s28, 5120
    s_add_u32 s41, s41, s48
    s_lshl_b32 s40, s28, 10
    s_add_u32 s40, s40, 16384
    s_mov_b32 m0, s40
    s_nop 0
    buffer_load_dwordx4 v5, s[24:27], s41 offen lds
    s_add_u32 s40, s40, 4096
    s_add_u32 s41, s41, 20480
    s_mov_b32 m0, s40
    s_nop 0
    buffer_load_dwordx4 v5, s[24:27], s41 offen lds
    s_add_u32 s40, s40, 4096
    s_add_u32 s41, s41, 20480
    s_mov_b32 m0, s40
    s_nop 0
    buffer_load_dwordx4 v5, s[24:27], s41 offen lds
    s_add_u32 s40, s40, 4096
    s_add_u32 s41, s41, 20480
    s_mov_b32 m0, s40
    s_nop 0
    buffer_load_dwordx4 v5, s[24:27], s41 offen lds
    s_add_u32 s48, s48, 256
    s_mul_i32 s41, s28, 5120
    s_add_u32 s41, s41, s48
    s_lshl_b32 s40, s28, 10
    s_add_u32 s40, s40, 32768
    s_mov_b32 m0, s40
    s_nop 0
    buffer_load_dwordx4 v5, s[24:27], s41 offen lds
    s_add_u32 s40, s40, 4096
    s_add_u32 s41, s41, 20480
    s_mov_b32 m0, s40
    s_nop 0
    buffer_load_dwordx4 v5, s[24:27], s41 offen lds
    s_add_u32 s40, s40, 4096
    s_add_u32 s41, s41, 20480
    s_mov_b32 m0, s40
    s_nop 0
    buffer_load_dwordx4 v5, s[24:27], s41 offen lds
    s_add_u32 s40, s40, 4096
    s_add_u32 s41, s41, 20480
    s_mov_b32 m0, s40
    s_nop 0
    buffer_load_dwordx4 v5, s[24:27], s41 offen lds
    s_add_u32 s48, s48, 256
    s_mul_i32 s41, s28, 5120
    s_add_u32 s41, s41, s48
    s_lshl_b32 s40, s28, 10
    s_add_u32 s40, s40, 49152
    s_mov_b32 m0, s40
    s_nop 0
    buffer_load_dwordx4 v5, s[24:27], s41 offen lds
    s_add_u32 s40, s40, 4096
    s_add_u32 s41, s41, 20480
    s_mov_b32 m0, s40
    s_nop 0
    buffer_load_dwordx4 v5, s[24:27], s41 offen lds
    s_add_u32 s40, s40, 4096
    s_add_u32 s41, s41, 20480
    s_mov_b32 m0, s40
    s_nop 0
    buffer_load_dwordx4 v5, s[24:27], s41 offen lds
    s_add_u32 s40, s40, 4096
    s_add_u32 s41, s41, 20480
    s_mov_b32 m0, s40
    s_nop 0
    buffer_load_dwordx4 v5, s[24:27], s41 offen lds
    s_add_u32 s48, s48, 256
    s_mul_i32 s41, s28, 5120
    s_add_u32 s41, s41, s48
    s_lshl_b32 s40, s28, 10
    s_add_u32 s40, s40, 65536
    s_mov_b32 m0, s40
    s_nop 0
    buffer_load_dwordx4 v5, s[24:27], s41 offen lds
    s_add_u32 s40, s40, 4096
    s_add_u32 s41, s41, 20480
    s_mov_b32 m0, s40
    s_nop 0
    buffer_load_dwordx4 v5, s[24:27], s41 offen lds
    s_add_u32 s40, s40, 4096
    s_add_u32 s41, s41, 20480
    s_mov_b32 m0, s40
    s_nop 0
    buffer_load_dwordx4 v5, s[24:27], s41 offen lds
    s_add_u32 s40, s40, 4096
    s_add_u32 s41, s41, 20480
    s_mov_b32 m0, s40
    s_nop 0
    buffer_load_dwordx4 v5, s[24:27], s41 offen lds
    s_waitcnt vmcnt(20)
    s_barrier
    ds_read_b64_tr_b16 a[200:201], v54 offset:16384
    ds_read_b64_tr_b16 a[202:203], v54 offset:17408
    ds_read_b64_tr_b16 v[216:217], v55 offset:16384
    ds_read_b64_tr_b16 v[218:219], v55 offset:17408
    ds_read_b64_tr_b16 a[204:205], v54 offset:24576
    ds_read_b64_tr_b16 a[206:207], v54 offset:25600
    ds_read_b64_tr_b16 v[220:221], v55 offset:24576
    ds_read_b64_tr_b16 v[222:223], v55 offset:25600
    s_waitcnt lgkmcnt(0)
    ds_read_b64_tr_b16 a[208:209], v54 offset:32768
    ds_read_b64_tr_b16 a[210:211], v54 offset:33792
    ds_read_b64_tr_b16 v[224:225], v55 offset:32768
    ds_read_b64_tr_b16 v[226:227], v55 offset:33792
    ds_read_b64_tr_b16 a[212:213], v54 offset:40960
    ds_read_b64_tr_b16 a[214:215], v54 offset:41984
    ds_read_b64_tr_b16 v[228:229], v55 offset:40960
    ds_read_b64_tr_b16 v[230:231], v55 offset:41984
    ds_read_b64_tr_b16 a[216:217], v54 offset:49152
    ds_read_b64_tr_b16 a[218:219], v54 offset:50176
    ds_read_b64_tr_b16 v[232:233], v55 offset:49152
    ds_read_b64_tr_b16 v[234:235], v55 offset:50176
    ds_read_b64_tr_b16 a[220:221], v54 offset:57344
    ds_read_b64_tr_b16 a[222:223], v54 offset:58368
    ds_read_b64_tr_b16 v[236:237], v55 offset:57344
    ds_read_b64_tr_b16 v[238:239], v55 offset:58368
    s_waitcnt lgkmcnt(0)
    ds_read_b64_tr_b16 a[224:225], v56 offset:0
    ds_read_b64_tr_b16 a[226:227], v56 offset:1024
    ds_read_b64_tr_b16 v[240:241], v57 offset:0
    ds_read_b64_tr_b16 v[242:243], v57 offset:1024
    ds_read_b64_tr_b16 a[228:229], v56 offset:8192
    ds_read_b64_tr_b16 a[230:231], v56 offset:9216
    ds_read_b64_tr_b16 v[244:245], v57 offset:8192
    ds_read_b64_tr_b16 v[246:247], v57 offset:9216
    ds_read_b64_tr_b16 a[232:233], v56 offset:16384
    ds_read_b64_tr_b16 a[234:235], v56 offset:17408
    ds_read_b64_tr_b16 v[248:249], v57 offset:16384
    ds_read_b64_tr_b16 v[250:251], v57 offset:17408
    ds_read_b64_tr_b16 a[236:237], v56 offset:24576
    ds_read_b64_tr_b16 a[238:239], v56 offset:25600
    ds_read_b64_tr_b16 v[252:253], v57 offset:24576
    ds_read_b64_tr_b16 v[254:255], v57 offset:25600
    s_waitcnt lgkmcnt(0)
    s_waitcnt lgkmcnt(0)
    s_barrier
    v_lshrrev_b32 v48, 4, v1
    v_and_b32 v49, 15, v1
    v_lshlrev_b32 v50, 1, v48
    v_xor_b32 v49, v49, v50
    s_lshr_b32 s34, s28, 1
    s_lshl_b32 s34, s34, 3
    v_xor_b32 v49, s34, v49
    v_lshrrev_b32 v50, 3, v49
    v_lshlrev_b32 v50, 5, v50
    v_add_u32 v48, v48, v50
    v_and_b32 v49, 7, v49
    s_mov_b32 s34, 8192
    v_mul_lo_u32 v48, v48, s34
    v_lshlrev_b32 v49, 4, v49
    v_add_u32 v8, v48, v49
    s_lshl_b32 s36, s43, 7
    s_add_u32 s48, s46, s36
    s_mul_i32 s41, s28, 32768
    s_add_u32 s41, s41, s48
    s_lshl_b32 s40, s28, 10
    s_add_u32 s40, s40, 81920
    s_mov_b32 m0, s40
    s_nop 0
    buffer_load_dwordx4 v8, s[20:23], s41 offen lds
    s_add_u32 s40, s40, 4096
    s_add_u32 s41, s41, 131072
    s_mov_b32 m0, s40
    s_nop 0
    buffer_load_dwordx4 v8, s[20:23], s41 offen lds
    s_add_u32 s40, s40, 4096
    s_add_u32 s41, s41, 393216
    s_mov_b32 m0, s40
    s_nop 0
    buffer_load_dwordx4 v8, s[20:23], s41 offen lds
    s_add_u32 s40, s40, 4096
    s_add_u32 s41, s41, 131072
    s_mov_b32 m0, s40
    s_nop 0
    buffer_load_dwordx4 v8, s[20:23], s41 offen lds
    s_add_u32 s40, s40, 4096
    s_add_u32 s41, s41, 393216
    s_mov_b32 m0, s40
    s_nop 0
    buffer_load_dwordx4 v8, s[20:23], s41 offen lds
    s_add_u32 s40, s40, 4096
    s_add_u32 s41, s41, 131072
    s_mov_b32 m0, s40
    s_nop 0
    buffer_load_dwordx4 v8, s[20:23], s41 offen lds
    s_add_u32 s40, s40, 4096
    s_add_u32 s41, s41, 393216
    s_mov_b32 m0, s40
    s_nop 0
    buffer_load_dwordx4 v8, s[20:23], s41 offen lds
    s_add_u32 s40, s40, 4096
    s_add_u32 s41, s41, 131072
    s_mov_b32 m0, s40
    s_nop 0
    buffer_load_dwordx4 v8, s[20:23], s41 offen lds
    s_add_u32 s40, s40, 4096
    s_add_u32 s41, s41, 393216
    s_mov_b32 m0, s40
    s_nop 0
    buffer_load_dwordx4 v8, s[20:23], s41 offen lds
    s_add_u32 s40, s40, 4096
    s_add_u32 s41, s41, 131072
    s_mov_b32 m0, s40
    s_nop 0
    buffer_load_dwordx4 v8, s[20:23], s41 offen lds
    s_add_u32 s40, s40, 4096
    s_add_u32 s41, s41, 393216
    s_mov_b32 m0, s40
    s_nop 0
    buffer_load_dwordx4 v8, s[20:23], s41 offen lds
    s_add_u32 s40, s40, 4096
    s_add_u32 s41, s41, 131072
    s_mov_b32 m0, s40
    s_nop 0
    buffer_load_dwordx4 v8, s[20:23], s41 offen lds
    s_add_u32 s40, s40, 4096
    s_add_u32 s41, s41, 393216
    s_mov_b32 m0, s40
    s_nop 0
    buffer_load_dwordx4 v8, s[20:23], s41 offen lds
    s_add_u32 s40, s40, 4096
    s_add_u32 s41, s41, 131072
    s_mov_b32 m0, s40
    s_nop 0
    buffer_load_dwordx4 v8, s[20:23], s41 offen lds
    s_add_u32 s40, s40, 4096
    s_add_u32 s41, s41, 393216
    s_mov_b32 m0, s40
    s_nop 0
    buffer_load_dwordx4 v8, s[20:23], s41 offen lds
    s_add_u32 s40, s40, 4096
    s_add_u32 s41, s41, 131072
    s_mov_b32 m0, s40
    s_nop 0
    buffer_load_dwordx4 v8, s[20:23], s41 offen lds
    s_add_u32 s40, s40, 4096
    s_add_u32 s41, s41, 393216
    s_mov_b32 m0, s40
    s_nop 0
    buffer_load_dwordx4 v8, s[20:23], s41 offen lds
    s_add_u32 s40, s40, 4096
    s_add_u32 s41, s41, 131072
    s_mov_b32 m0, s40
    s_nop 0
    buffer_load_dwordx4 v8, s[20:23], s41 offen lds
    s_add_u32 s40, s40, 4096
    s_add_u32 s41, s41, 393216
    s_mov_b32 m0, s40
    s_nop 0
    buffer_load_dwordx4 v8, s[20:23], s41 offen lds
    s_add_u32 s40, s40, 4096
    s_add_u32 s41, s41, 131072
    s_mov_b32 m0, s40
    s_nop 0
    buffer_load_dwordx4 v8, s[20:23], s41 offen lds
    s_waitcnt vmcnt(20)
    s_barrier
    s_mul_i32 s35, s28, 10
    s_add_u32 s35, s35, 0
    s_and_b32 s36, s35, 7
    s_lshl_b32 s48, s36, 1
    s_lshr_b32 s35, s35, 3
    s_lshl_b32 s49, s35, 14
    v_lshrrev_b32 v48, 4, v1
    v_bfe_u32 v49, v1, 2, 2
    v_and_b32 v52, 3, v1
    v_lshrrev_b32 v50, 1, v52
    v_add_u32 v50, s48, v50
    v_and_b32 v51, 1, v52
    v_and_b32 v53, 1, v48
    v_lshl_or_b32 v53, v53, 2, v49
    v_lshlrev_b32 v53, 1, v53
    v_xor_b32 v50, v50, v53
    v_lshlrev_b32 v50, 4, v50
    v_lshl_add_u32 v50, v51, 3, v50
    v_lshl_add_u32 v50, v49, 8, v50
    v_lshl_add_u32 v6, v48, 11, v50
    v_add_u32 v6, s49, v6
    ds_read_b64_tr_b16 v[112:113], v6 offset:0
    ds_read_b64_tr_b16 v[114:115], v6 offset:1024
    ds_read_b64_tr_b16 v[116:117], v6 offset:8192
    ds_read_b64_tr_b16 v[118:119], v6 offset:9216
    s_waitcnt lgkmcnt(0)
    s_mul_i32 s35, s28, 10
    s_add_u32 s35, s35, 1
    s_and_b32 s36, s35, 7
    s_lshl_b32 s48, s36, 1
    s_lshr_b32 s35, s35, 3
    s_lshl_b32 s49, s35, 14
    v_lshrrev_b32 v48, 4, v1
    v_bfe_u32 v49, v1, 2, 2
    v_and_b32 v52, 3, v1
    v_lshrrev_b32 v50, 1, v52
    v_add_u32 v50, s48, v50
    v_and_b32 v51, 1, v52
    v_and_b32 v53, 1, v48
    v_lshl_or_b32 v53, v53, 2, v49
    v_lshlrev_b32 v53, 1, v53
    v_xor_b32 v50, v50, v53
    v_lshlrev_b32 v50, 4, v50
    v_lshl_add_u32 v50, v51, 3, v50
    v_lshl_add_u32 v50, v49, 8, v50
    v_lshl_add_u32 v6, v48, 11, v50
    v_add_u32 v6, s49, v6
    ds_read_b64_tr_b16 v[120:121], v6 offset:0
    ds_read_b64_tr_b16 v[122:123], v6 offset:1024
    ds_read_b64_tr_b16 v[124:125], v6 offset:8192
    ds_read_b64_tr_b16 v[126:127], v6 offset:9216
    s_waitcnt lgkmcnt(0)
    s_mul_i32 s35, s28, 10
    s_add_u32 s35, s35, 2
    s_and_b32 s36, s35, 7
    s_lshl_b32 s48, s36, 1
    s_lshr_b32 s35, s35, 3
    s_lshl_b32 s49, s35, 14
    v_lshrrev_b32 v48, 4, v1
    v_bfe_u32 v49, v1, 2, 2
    v_and_b32 v52, 3, v1
    v_lshrrev_b32 v50, 1, v52
    v_add_u32 v50, s48, v50
    v_and_b32 v51, 1, v52
    v_and_b32 v53, 1, v48
    v_lshl_or_b32 v53, v53, 2, v49
    v_lshlrev_b32 v53, 1, v53
    v_xor_b32 v50, v50, v53
    v_lshlrev_b32 v50, 4, v50
    v_lshl_add_u32 v50, v51, 3, v50
    v_lshl_add_u32 v50, v49, 8, v50
    v_lshl_add_u32 v6, v48, 11, v50
    v_add_u32 v6, s49, v6
    ds_read_b64_tr_b16 v[128:129], v6 offset:0
    ds_read_b64_tr_b16 v[130:131], v6 offset:1024
    ds_read_b64_tr_b16 v[132:133], v6 offset:8192
    ds_read_b64_tr_b16 v[134:135], v6 offset:9216
    s_waitcnt lgkmcnt(0)
    s_mul_i32 s35, s28, 10
    s_add_u32 s35, s35, 3
    s_and_b32 s36, s35, 7
    s_lshl_b32 s48, s36, 1
    s_lshr_b32 s35, s35, 3
    s_lshl_b32 s49, s35, 14
    v_lshrrev_b32 v48, 4, v1
    v_bfe_u32 v49, v1, 2, 2
    v_and_b32 v52, 3, v1
    v_lshrrev_b32 v50, 1, v52
    v_add_u32 v50, s48, v50
    v_and_b32 v51, 1, v52
    v_and_b32 v53, 1, v48
    v_lshl_or_b32 v53, v53, 2, v49
    v_lshlrev_b32 v53, 1, v53
    v_xor_b32 v50, v50, v53
    v_lshlrev_b32 v50, 4, v50
    v_lshl_add_u32 v50, v51, 3, v50
    v_lshl_add_u32 v50, v49, 8, v50
    v_lshl_add_u32 v6, v48, 11, v50
    v_add_u32 v6, s49, v6
    ds_read_b64_tr_b16 v[136:137], v6 offset:0
    ds_read_b64_tr_b16 v[138:139], v6 offset:1024
    ds_read_b64_tr_b16 v[140:141], v6 offset:8192
    ds_read_b64_tr_b16 v[142:143], v6 offset:9216
    s_waitcnt lgkmcnt(0)
    s_mul_i32 s35, s28, 10
    s_add_u32 s35, s35, 4
    s_and_b32 s36, s35, 7
    s_lshl_b32 s48, s36, 1
    s_lshr_b32 s35, s35, 3
    s_lshl_b32 s49, s35, 14
    v_lshrrev_b32 v48, 4, v1
    v_bfe_u32 v49, v1, 2, 2
    v_and_b32 v52, 3, v1
    v_lshrrev_b32 v50, 1, v52
    v_add_u32 v50, s48, v50
    v_and_b32 v51, 1, v52
    v_and_b32 v53, 1, v48
    v_lshl_or_b32 v53, v53, 2, v49
    v_lshlrev_b32 v53, 1, v53
    v_xor_b32 v50, v50, v53
    v_lshlrev_b32 v50, 4, v50
    v_lshl_add_u32 v50, v51, 3, v50
    v_lshl_add_u32 v50, v49, 8, v50
    v_lshl_add_u32 v6, v48, 11, v50
    v_add_u32 v6, s49, v6
    ds_read_b64_tr_b16 v[144:145], v6 offset:0
    ds_read_b64_tr_b16 v[146:147], v6 offset:1024
    ds_read_b64_tr_b16 v[148:149], v6 offset:8192
    ds_read_b64_tr_b16 v[150:151], v6 offset:9216
    s_waitcnt lgkmcnt(0)
    s_mul_i32 s35, s28, 10
    s_add_u32 s35, s35, 5
    s_and_b32 s36, s35, 7
    s_lshl_b32 s48, s36, 1
    s_lshr_b32 s35, s35, 3
    s_lshl_b32 s49, s35, 14
    v_lshrrev_b32 v48, 4, v1
    v_bfe_u32 v49, v1, 2, 2
    v_and_b32 v52, 3, v1
    v_lshrrev_b32 v50, 1, v52
    v_add_u32 v50, s48, v50
    v_and_b32 v51, 1, v52
    v_and_b32 v53, 1, v48
    v_lshl_or_b32 v53, v53, 2, v49
    v_lshlrev_b32 v53, 1, v53
    v_xor_b32 v50, v50, v53
    v_lshlrev_b32 v50, 4, v50
    v_lshl_add_u32 v50, v51, 3, v50
    v_lshl_add_u32 v50, v49, 8, v50
    v_lshl_add_u32 v6, v48, 11, v50
    v_add_u32 v6, s49, v6
    ds_read_b64_tr_b16 v[152:153], v6 offset:0
    ds_read_b64_tr_b16 v[154:155], v6 offset:1024
    ds_read_b64_tr_b16 v[156:157], v6 offset:8192
    ds_read_b64_tr_b16 v[158:159], v6 offset:9216
    s_waitcnt lgkmcnt(0)
    s_mul_i32 s35, s28, 10
    s_add_u32 s35, s35, 6
    s_and_b32 s36, s35, 7
    s_lshl_b32 s48, s36, 1
    s_lshr_b32 s35, s35, 3
    s_lshl_b32 s49, s35, 14
    v_lshrrev_b32 v48, 4, v1
    v_bfe_u32 v49, v1, 2, 2
    v_and_b32 v52, 3, v1
    v_lshrrev_b32 v50, 1, v52
    v_add_u32 v50, s48, v50
    v_and_b32 v51, 1, v52
    v_and_b32 v53, 1, v48
    v_lshl_or_b32 v53, v53, 2, v49
    v_lshlrev_b32 v53, 1, v53
    v_xor_b32 v50, v50, v53
    v_lshlrev_b32 v50, 4, v50
    v_lshl_add_u32 v50, v51, 3, v50
    v_lshl_add_u32 v50, v49, 8, v50
    v_lshl_add_u32 v6, v48, 11, v50
    v_add_u32 v6, s49, v6
    ds_read_b64_tr_b16 v[160:161], v6 offset:0
    ds_read_b64_tr_b16 v[162:163], v6 offset:1024
    ds_read_b64_tr_b16 v[164:165], v6 offset:8192
    ds_read_b64_tr_b16 v[166:167], v6 offset:9216
    s_waitcnt lgkmcnt(0)
    s_mul_i32 s35, s28, 10
    s_add_u32 s35, s35, 7
    s_and_b32 s36, s35, 7
    s_lshl_b32 s48, s36, 1
    s_lshr_b32 s35, s35, 3
    s_lshl_b32 s49, s35, 14
    v_lshrrev_b32 v48, 4, v1
    v_bfe_u32 v49, v1, 2, 2
    v_and_b32 v52, 3, v1
    v_lshrrev_b32 v50, 1, v52
    v_add_u32 v50, s48, v50
    v_and_b32 v51, 1, v52
    v_and_b32 v53, 1, v48
    v_lshl_or_b32 v53, v53, 2, v49
    v_lshlrev_b32 v53, 1, v53
    v_xor_b32 v50, v50, v53
    v_lshlrev_b32 v50, 4, v50
    v_lshl_add_u32 v50, v51, 3, v50
    v_lshl_add_u32 v50, v49, 8, v50
    v_lshl_add_u32 v6, v48, 11, v50
    v_add_u32 v6, s49, v6
    ds_read_b64_tr_b16 v[168:169], v6 offset:0
    ds_read_b64_tr_b16 v[170:171], v6 offset:1024
    ds_read_b64_tr_b16 v[172:173], v6 offset:8192
    ds_read_b64_tr_b16 v[174:175], v6 offset:9216
    s_waitcnt lgkmcnt(0)
    s_mul_i32 s35, s28, 10
    s_add_u32 s35, s35, 8
    s_and_b32 s36, s35, 7
    s_lshl_b32 s48, s36, 1
    s_lshr_b32 s35, s35, 3
    s_lshl_b32 s49, s35, 14
    v_lshrrev_b32 v48, 4, v1
    v_bfe_u32 v49, v1, 2, 2
    v_and_b32 v52, 3, v1
    v_lshrrev_b32 v50, 1, v52
    v_add_u32 v50, s48, v50
    v_and_b32 v51, 1, v52
    v_and_b32 v53, 1, v48
    v_lshl_or_b32 v53, v53, 2, v49
    v_lshlrev_b32 v53, 1, v53
    v_xor_b32 v50, v50, v53
    v_lshlrev_b32 v50, 4, v50
    v_lshl_add_u32 v50, v51, 3, v50
    v_lshl_add_u32 v50, v49, 8, v50
    v_lshl_add_u32 v6, v48, 11, v50
    v_add_u32 v6, s49, v6
    ds_read_b64_tr_b16 v[176:177], v6 offset:0
    ds_read_b64_tr_b16 v[178:179], v6 offset:1024
    ds_read_b64_tr_b16 v[180:181], v6 offset:8192
    ds_read_b64_tr_b16 v[182:183], v6 offset:9216
    s_waitcnt lgkmcnt(0)
    s_mul_i32 s35, s28, 10
    s_add_u32 s35, s35, 9
    s_and_b32 s36, s35, 7
    s_lshl_b32 s48, s36, 1
    s_lshr_b32 s35, s35, 3
    s_lshl_b32 s49, s35, 14
    v_lshrrev_b32 v48, 4, v1
    v_bfe_u32 v49, v1, 2, 2
    v_and_b32 v52, 3, v1
    v_lshrrev_b32 v50, 1, v52
    v_add_u32 v50, s48, v50
    v_and_b32 v51, 1, v52
    v_and_b32 v53, 1, v48
    v_lshl_or_b32 v53, v53, 2, v49
    v_lshlrev_b32 v53, 1, v53
    v_xor_b32 v50, v50, v53
    v_lshlrev_b32 v50, 4, v50
    v_lshl_add_u32 v50, v51, 3, v50
    v_lshl_add_u32 v50, v49, 8, v50
    v_lshl_add_u32 v6, v48, 11, v50
    v_add_u32 v6, s49, v6
    ds_read_b64_tr_b16 v[184:185], v6 offset:0
    ds_read_b64_tr_b16 v[186:187], v6 offset:1024
    ds_read_b64_tr_b16 v[188:189], v6 offset:8192
    ds_read_b64_tr_b16 v[190:191], v6 offset:9216
    s_waitcnt lgkmcnt(0)
    s_waitcnt vmcnt(0)
    s_barrier
    s_cmp_lg_u32 s28, 0
    s_cbranch_scc1 wd_7
    v_mov_b32 v48, 1
    v_mov_b32 v49, 128
    s_mov_b64 exec, 1
    buffer_atomic_add v48, v49, s[16:19], 0 offen sc1
    s_mov_b64 exec, -1
wd_7:
    s_lshl_b32 s48, s28, 1
    v_lshrrev_b32 v48, 4, v1
    v_bfe_u32 v49, v1, 2, 2
    v_and_b32 v52, 3, v1
    v_lshrrev_b32 v50, 1, v52
    v_add_u32 v50, s48, v50
    v_and_b32 v51, 1, v52
    v_and_b32 v53, 1, v48
    v_lshl_or_b32 v53, v53, 2, v49
    v_lshlrev_b32 v53, 1, v53
    v_xor_b32 v50, v50, v53
    v_lshlrev_b32 v50, 4, v50
    v_lshl_add_u32 v50, v51, 3, v50
    v_lshl_add_u32 v50, v49, 8, v50
    v_lshl_add_u32 v6, v48, 11, v50
    v_add_u32 v6, 81920, v6
    v_xor_b32 v7, 128, v6
    v_add_u32 v66, 0x10000, v6
    v_add_u32 v67, 0x10000, v7
    v_lshlrev_b32 v2, 4, v1
    s_mul_i32 s35, s28, 20480
    v_add_u32 v4, s35, v2
    ds_read_b64_tr_b16 v[26:27], v6 offset:0
    ds_read_b64_tr_b16 v[28:29], v6 offset:1024
    ds_read_b64_tr_b16 v[30:31], v7 offset:0
    ds_read_b64_tr_b16 v[32:33], v7 offset:1024
    ds_read_b64_tr_b16 v[34:35], v6 offset:8192
    ds_read_b64_tr_b16 v[36:37], v6 offset:9216
    ds_read_b64_tr_b16 v[38:39], v7 offset:8192
    ds_read_b64_tr_b16 v[40:41], v7 offset:9216
    ds_read_b64_tr_b16 v[42:43], v6 offset:16384
    ds_read_b64_tr_b16 v[44:45], v6 offset:17408
    ds_read_b64_tr_b16 v[46:47], v7 offset:16384
    ds_read_b64_tr_b16 v[48:49], v7 offset:17408
    ds_read_b64_tr_b16 v[50:51], v6 offset:24576
    ds_read_b64_tr_b16 v[52:53], v6 offset:25600
    ds_read_b64_tr_b16 v[54:55], v7 offset:24576
    ds_read_b64_tr_b16 v[56:57], v7 offset:25600
    ds_read_b64_tr_b16 v[58:59], v6 offset:32768
    ds_read_b64_tr_b16 v[60:61], v6 offset:33792
    ds_read_b64_tr_b16 v[62:63], v7 offset:32768
    ds_read_b64_tr_b16 v[64:65], v7 offset:33792
    s_waitcnt lgkmcnt(0)
    ds_write_b128 v4, v[26:29] offset:0
    ds_write_b128 v4, v[30:33] offset:1024
    ds_write_b128 v4, v[34:37] offset:2048
    ds_write_b128 v4, v[38:41] offset:3072
    ds_write_b128 v4, v[42:45] offset:4096
    ds_write_b128 v4, v[46:49] offset:5120
    ds_write_b128 v4, v[50:53] offset:6144
    ds_write_b128 v4, v[54:57] offset:7168
    ds_write_b128 v4, v[58:61] offset:8192
    ds_write_b128 v4, v[62:65] offset:9216
    s_waitcnt lgkmcnt(0)
    ds_read_b64_tr_b16 v[26:27], v6 offset:40960
    ds_read_b64_tr_b16 v[28:29], v6 offset:41984
    ds_read_b64_tr_b16 v[30:31], v7 offset:40960
    ds_read_b64_tr_b16 v[32:33], v7 offset:41984
    ds_read_b64_tr_b16 v[34:35], v6 offset:49152
    ds_read_b64_tr_b16 v[36:37], v6 offset:50176
    ds_read_b64_tr_b16 v[38:39], v7 offset:49152
    ds_read_b64_tr_b16 v[40:41], v7 offset:50176
    ds_read_b64_tr_b16 v[42:43], v6 offset:57344
    ds_read_b64_tr_b16 v[44:45], v6 offset:58368
    ds_read_b64_tr_b16 v[46:47], v7 offset:57344
    ds_read_b64_tr_b16 v[48:49], v7 offset:58368
    ds_read_b64_tr_b16 v[50:51], v66 offset:0
    ds_read_b64_tr_b16 v[52:53], v66 offset:1024
    ds_read_b64_tr_b16 v[54:55], v67 offset:0
    ds_read_b64_tr_b16 v[56:57], v67 offset:1024
    ds_read_b64_tr_b16 v[58:59], v66 offset:8192
    ds_read_b64_tr_b16 v[60:61], v66 offset:9216
    ds_read_b64_tr_b16 v[62:63], v67 offset:8192
    ds_read_b64_tr_b16 v[64:65], v67 offset:9216
    s_waitcnt lgkmcnt(0)
    ds_write_b128 v4, v[26:29] offset:10240
    ds_write_b128 v4, v[30:33] offset:11264
    ds_write_b128 v4, v[34:37] offset:12288
    ds_write_b128 v4, v[38:41] offset:13312
    ds_write_b128 v4, v[42:45] offset:14336
    ds_write_b128 v4, v[46:49] offset:15360
    ds_write_b128 v4, v[50:53] offset:16384
    ds_write_b128 v4, v[54:57] offset:17408
    ds_write_b128 v4, v[58:61] offset:18432
    ds_write_b128 v4, v[62:65] offset:19456
    s_waitcnt lgkmcnt(0)
    s_barrier
    v_add_u32 v3, 81920, v2
    v_and_b32 v26, 15, v1
    v_lshrrev_b32 v27, 4, v1
    v_and_b32 v29, 1, v27
    s_mul_i32 s35, s28, 2560
    v_add_u32 v5, s35, v2
    v_add_u32 v6, 81920, v5
    s_mul_i32 s35, s28, 81920
    s_lshl_b32 s36, s45, 8
    s_add_u32 s35, s35, s36
    v_and_b32 v28, 1, v26
    v_lshlrev_b32 v28, 7, v28
    v_lshrrev_b32 v30, 1, v26
    v_lshl_add_u32 v28, v30, 4, v28
    v_lshl_add_u32 v28, v27, 2, v28
    v_add_u32 v7, s35, v28
    v_lshrrev_b32 v30, 1, v27
    v_lshl_add_u32 v28, v26, 1, v30
    v_lshlrev_b32 v28, 4, v28
    v_lshl_add_u32 v9, v29, 3, v28
    v_lshrrev_b32 v28, 2, v26
    v_lshlrev_b32 v28, 3, v28
    v_and_b32 v30, 3, v26
    v_add_u32 v28, v28, v30
    s_lshl_b32 s35, s28, 5
    v_add_u32 v28, s35, v28
    v_lshlrev_b32 v30, 5, v28
    v_lshl_add_u32 v30, v27, 3, v30
    v_add_u32 v10, 92160, v30
    v_lshlrev_b32 v30, 4, v28
    v_lshl_add_u32 v30, v27, 2, v30
    v_add_u32 v8, 96256, v30
    v_bfe_u32 v28, v1, 2, 2
    v_lshl_add_u32 v28, v27, 3, v28
    v_and_b32 v30, 3, v1
    v_lshlrev_b32 v30, 3, v30
    v_lshl_add_u32 v30, v28, 5, v30
    v_add_u32 v0, 92160, v30
    v_and_b32 v30, 1, v1
    v_lshlrev_b32 v30, 3, v30
    v_lshl_add_u32 v30, v28, 4, v30
    v_add_u32 v11, 96256, v30
    s_lshl_b32 s35, s28, 8
    v_lshlrev_b32 v28, 4, v26
    v_lshl_add_u32 v28, v27, 2, v28
    v_add_u32 v28, s35, v28
    v_add_u32 v13, 104448, v28
    s_lshl_b32 s35, s43, 10
    v_add_u32 v12, s35, v28
    v_lshrrev_b32 v28, 2, v26
    v_lshlrev_b32 v28, 4, v28
    v_and_b32 v30, 3, v26
    v_lshl_add_u32 v28, v30, 1, v28
    v_lshlrev_b32 v30, 4, v28
    v_lshl_add_u32 v30, v29, 3, v30
    v_add_u32 v14, 104448, v30
    v_lshlrev_b32 v30, 6, v28
    v_lshl_add_u32 v30, v27, 4, v30
    v_add_u32 v15, 113664, v30
    v_and_b32 v30, 7, v26
    v_lshlrev_b32 v30, 4, v30
    v_lshl_add_u32 v30, v27, 7, v30
    s_lshl_b32 s35, s28, 10
    v_add_u32 v16, s35, v30
    v_and_b32 v30, 1, v1
    v_cmp_eq_u32 s[58:59], 1, v30
    v_mov_b32 v31, 0x88888888
    v_mov_b32 v32, 0xdddddddd
    v_cndmask_b32 v17, v31, v32, s[58:59]
    v_and_b32 v31, 1, v26
    v_lshlrev_b32 v31, 4, v31
    v_mov_b32 v32, 0x3f80
    v_lshlrev_b32 v31, v31, v32
    v_lshrrev_b32 v30, 1, v26
    v_cmp_eq_u32 vcc, 0, v30
    v_cndmask_b32 v18, 0, v31, vcc
    v_cmp_eq_u32 vcc, 1, v30
    v_cndmask_b32 v19, 0, v31, vcc
    v_cmp_eq_u32 vcc, 2, v30
    v_cndmask_b32 v20, 0, v31, vcc
    v_cmp_eq_u32 vcc, 3, v30
    v_cndmask_b32 v21, 0, v31, vcc
    v_mov_b32 v22, 0x3f803f80
    v_mov_b32 v23, 0x3f803f80
    v_mov_b32 v24, 0x3f803f80
    v_mov_b32 v25, 0x3f803f80
    s_cmp_eq_u32 s28, 0
    s_cselect_b32 s2, 1, 0
    s_mov_b32 s3, 0
    s_lshl_b32 s54, s29, 7
    s_add_u32 s54, s54, 0x6460000
    s_mov_b32 s52, 0
    s_mov_b32 s100, 0
    s_mul_i32 s101, s44, 327680
    s_add_u32 s101, s101, 0x6000000
    s_mov_b32 s96, 0x3e0293ee
    s_mov_b32 s97, 0x3e0293ee
    s_mov_b32 s55, 0x3e0293ee
    s_mov_b32 s56, -1
    s_mov_b32 s57, 0
    s_mov_b32 s53, -1
    s_cmp_eq_u32 s28, 2
    s_cselect_b32 s53, s45, s53
    s_add_u32 s35, s45, 32
    s_cmp_lt_u32 s45, 8
    s_cselect_b32 s35, s35, -1
    s_cmp_eq_u32 s28, 3
    s_cselect_b32 s53, s35, s53
    s_load_dwordx2 s[8:9], s[0:1], 8
    s_mov_b32 s10, 0x2800
    s_mov_b32 s11, 0x20000
    v_lshrrev_b32 v28, 1, v26
    v_mul_u32_u24 v28, 1280, v28
    v_lshl_add_u32 v28, v27, 5, v28
    v_mov_b32 v30, 0x05040100
    v_mov_b32 v31, 0x07060302
    v_cndmask_b32 v29, v30, v31, s[58:59]
    s_waitcnt lgkmcnt(0)
    s_add_u32 s35, s28, 0
    s_lshl_b32 s36, s35, 7
    buffer_load_dwordx4 v[32:35], v28, s[8:11], s36 offen
    buffer_load_dwordx4 v[36:39], v28, s[8:11], s36 offen offset:16
    s_waitcnt vmcnt(0)
    v_perm_b32 v40, v33, v32, v29
    v_perm_b32 v41, v35, v34, v29
    v_perm_b32 v42, v37, v36, v29
    v_perm_b32 v43, v39, v38, v29
    s_lshl_b32 s36, s35, 10
    v_add_u32 v30, s36, v3
    ds_write_b128 v30, v[40:43]
m0_8:
    s_add_u32 s35, s28, 4
    s_lshl_b32 s36, s35, 7
    buffer_load_dwordx4 v[32:35], v28, s[8:11], s36 offen
    buffer_load_dwordx4 v[36:39], v28, s[8:11], s36 offen offset:16
    s_waitcnt vmcnt(0)
    v_perm_b32 v40, v33, v32, v29
    v_perm_b32 v41, v35, v34, v29
    v_perm_b32 v42, v37, v36, v29
    v_perm_b32 v43, v39, v38, v29
    s_lshl_b32 s36, s35, 10
    v_add_u32 v30, s36, v3
    ds_write_b128 v30, v[40:43]
m0_9:
    s_add_u32 s35, s28, 8
    s_cmp_ge_u32 s35, 10
    s_cbranch_scc1 m0_10
    s_lshl_b32 s36, s35, 7
    buffer_load_dwordx4 v[32:35], v28, s[8:11], s36 offen
    buffer_load_dwordx4 v[36:39], v28, s[8:11], s36 offen offset:16
    s_waitcnt vmcnt(0)
    v_perm_b32 v40, v33, v32, v29
    v_perm_b32 v41, v35, v34, v29
    v_perm_b32 v42, v37, v36, v29
    v_perm_b32 v43, v39, v38, v29
    s_lshl_b32 s36, s35, 10
    v_add_u32 v30, s36, v3
    ds_write_b128 v30, v[40:43]
m0_10:
    v_mov_b32 v27, 36
dw_11:
    buffer_load_dword v26, v27, s[16:19], 0 offen sc1
    s_waitcnt vmcnt(0)
    v_readfirstlane_b32 s34, v26
    s_sub_u32 s33, s33, 1
    s_cbranch_scc1 END
    s_sleep 1
    s_cmp_lt_u32 s34, 192
    s_cbranch_scc1 dw_11
    v_mov_b32 v27, 40
dw_12:
    buffer_load_dword v26, v27, s[16:19], 0 offen sc1
    s_waitcnt vmcnt(0)
    v_readfirstlane_b32 s34, v26
    s_sub_u32 s33, s33, 1
    s_cbranch_scc1 END
    s_sleep 1
    s_cmp_lt_u32 s34, 64
    s_cbranch_scc1 dw_12
    v_mov_b32 v28, 0
    buffer_load_dwordx2 v[26:27], v28, s[16:19], 0 offen sc1
    s_waitcnt vmcnt(0)
    v_readfirstlane_b32 s35, v26
    v_readfirstlane_b32 s36, v27
    s_bcnt1_i32_b32 s35, s35
    s_bcnt1_i32_b32 s36, s36
    s_add_u32 s35, s35, s36
    s_cmp_lg_u32 s35, 2
    s_cselect_b32 s30, 1, 0
    s_mov_b32 s51, 0
    s_mov_b32 s50, 0
    s_lshl_b32 s35, s42, 13
    s_mul_i32 s36, s28, 3072
    s_add_u32 s35, s35, s36
    s_lshl_b32 s37, s43, 12
    s_add_u32 s37, s37, s35
    s_add_u32 s37, s37, 0x13fe000
    s_add_u32 s35, s35, 0x400000
    s_cmp_lt_u32 s28, 3
    s_cselect_b32 s8, s35, s37
    s_cmp_lt_u32 s28, 2
    s_cselect_b32 s9, s35, s37
    s_add_u32 s10, s36, 105472
    s_lshl_b32 s35, s45, 13
    s_lshl_b32 s36, s28, 11
    s_add_u32 s35, s35, s36
    s_add_u32 s11, s35, s101
    s_cmp_lt_u32 s45, 8
    s_cselect_b32 s12, -1, 0
    s_mov_b32 s13, s12
    s_mul_i32 s14, s28, 2560
    s_add_u32 s14, s14, 2048
    s_mov_b32 s25, 0x00003f80
    s_mov_b32 s26, 0x3f800000
    s_cmp_ge_u32 s28, 2
    s_cbranch_scc1 kve_16
    s_cmp_gt_u32 s51, s50
    s_cbranch_scc1 kvok_13
    v_and_b32 v66, 1, v1
    v_lshlrev_b32 v66, 5, v66
    s_add_u32 s35, s42, 64
    v_add_u32 v66, s35, v66
    v_lshlrev_b32 v66, 7, v66
    v_add_u32 v66, 0x6460000, v66
kvp_14:
    buffer_load_dword v67, v66, s[4:7], 0 offen sc1
    s_waitcnt vmcnt(0)
    v_readlane_b32 s35, v67, 0
    v_readlane_b32 s36, v67, 1
    s_min_u32 s51, s35, s36
    s_sub_u32 s33, s33, 1
    s_cbranch_scc1 END
    s_cmp_le_u32 s51, s50
    s_cbranch_scc1 kvp_14
kvok_13:
    s_lshl_b32 s35, s50, 18
    s_lshl_b32 s36, s42, 13
    s_add_u32 s35, s35, s36
    s_and_b32 s37, s50, 1
    s_mul_i32 s37, s37, 12288
    s_add_u32 s37, s37, 105472
    s_cmp_eq_u32 s28, 0
    s_cbranch_scc1 kvv_15
    s_add_u32 s41, s35, 0x400000
    s_mov_b32 s40, s37
    s_mov_b32 m0, s40
    s_nop 0
    buffer_load_dwordx4 v2, s[4:7], s41 offen offset:0 sc1 lds
    buffer_load_dwordx4 v2, s[4:7], s41 offen offset:1024 sc1 lds
    buffer_load_dwordx4 v2, s[4:7], s41 offen offset:2048 sc1 lds
    buffer_load_dwordx4 v2, s[4:7], s41 offen offset:3072 sc1 lds
    s_add_u32 s40, s40, 4096
    s_add_u32 s41, s41, 4096
    s_mov_b32 m0, s40
    s_nop 0
    buffer_load_dwordx4 v2, s[4:7], s41 offen offset:0 sc1 lds
    buffer_load_dwordx4 v2, s[4:7], s41 offen offset:1024 sc1 lds
    buffer_load_dwordx4 v2, s[4:7], s41 offen offset:2048 sc1 lds
    buffer_load_dwordx4 v2, s[4:7], s41 offen offset:3072 sc1 lds
    s_branch kve_16
kvv_15:
    s_lshl_b32 s38, s43, 12
    s_add_u32 s41, s35, s38
    s_add_u32 s41, s41, 0x1400000
    s_add_u32 s40, s37, 8192
    s_mov_b32 m0, s40
    s_nop 0
    buffer_load_dwordx4 v2, s[4:7], s41 offen offset:0 sc1 lds
    buffer_load_dwordx4 v2, s[4:7], s41 offen offset:1024 sc1 lds
    buffer_load_dwordx4 v2, s[4:7], s41 offen offset:2048 sc1 lds
    buffer_load_dwordx4 v2, s[4:7], s41 offen offset:3072 sc1 lds
kve_16:
    s_add_u32 s46, s50, 1
    s_and_b32 s37, s46, 1
    s_mul_i32 s37, s37, 12288
    s_add_u32 s37, s37, s10
    s_mov_b32 m0, s37
    s_min_u32 s46, s46, 63
    s_cmp_gt_u32 s51, s46
    s_cbranch_scc1 kvok_17
    v_and_b32 v66, 1, v1
    v_lshlrev_b32 v66, 5, v66
    s_add_u32 s35, s42, 64
    v_add_u32 v66, s35, v66
    v_lshlrev_b32 v66, 7, v66
    v_add_u32 v66, 0x6460000, v66
kvp_18:
    buffer_load_dword v67, v66, s[4:7], 0 offen sc1
    s_waitcnt vmcnt(0)
    v_readlane_b32 s35, v67, 0
    v_readlane_b32 s36, v67, 1
    s_min_u32 s51, s35, s36
    s_sub_u32 s33, s33, 1
    s_cbranch_scc1 END
    s_cmp_le_u32 s51, s46
    s_cbranch_scc1 kvp_18
kvok_17:
    s_lshl_b32 s35, s46, 18
    s_add_u32 s20, s8, s35
    s_add_u32 s21, s9, s35
    s_add_u32 s23, s11, 1310720
    s_add_u32 s24, s23, 262144
    s_waitcnt vmcnt(0) lgkmcnt(0)
    ds_read_b128 v[38:41], v4 offset:0
    ds_read_b128 v[42:45], v4 offset:1024
    ds_read_b128 v[46:49], v4 offset:2048
    ds_read_b128 v[50:53], v4 offset:3072
    ds_read_b128 v[54:57], v4 offset:4096
    ds_read_b128 v[58:61], v4 offset:5120
    ds_read_b128 v[88:91], v4 offset:6144
    ds_read_b128 v[92:95], v4 offset:7168
    ds_read_b128 v[96:99], v4 offset:8192
    ds_read_b128 v[100:103], v4 offset:9216
    ds_read_b128 v[104:107], v4 offset:10240
    ds_read_b128 v[108:111], v4 offset:11264
    v_mov_b32 v68, 0
    v_mov_b32 v69, 0
    v_mov_b32 v70, 0
    v_mov_b32 v71, 0
    v_mov_b32 v72, 0
    v_mov_b32 v73, 0
    v_mov_b32 v74, 0
    v_mov_b32 v75, 0
    v_mov_b32 v76, 0
    v_mov_b32 v77, 0
    v_mov_b32 v78, 0
    v_mov_b32 v79, 0
    v_mov_b32 v80, 0
    v_mov_b32 v81, 0
    v_mov_b32 v82, 0
    v_mov_b32 v83, 0
    v_mov_b32 v84, 0
    v_mov_b32 v85, 0
    v_mov_b32 v86, 0
    v_mov_b32 v87, 0
    s_waitcnt lgkmcnt(0)
    s_cmp_eq_u32 s30, 0
    s_cbranch_scc1 CH_B1
    s_branch CH_B1_F
CH_LOOP:
    buffer_load_dwordx4 v[68:71], v5, s[4:7], s61 offen sc1
    buffer_load_dwordx4 v[72:75], v5, s[4:7], s61 offen offset:1024 sc1
    buffer_load_dwordx2 v[76:77], v62, s[4:7], s61 offen sc1
    s_cmp_eq_u32 s28, 0
    s_cbranch_scc1 w0fl_20
    s_cmp_eq_u32 s53, -1
    s_cbranch_scc1 nowv_19
    ds_read_b128 v[38:41], v4 offset:0
    ds_read_b128 v[42:45], v4 offset:1024
    ds_read_b128 v[46:49], v4 offset:2048
    ds_read_b128 v[50:53], v4 offset:3072
    ds_read_b128 v[54:57], v4 offset:4096
    ds_read_b128 v[58:61], v4 offset:5120
    ds_read_b128 v[88:91], v4 offset:6144
    ds_read_b128 v[92:95], v4 offset:7168
    ds_read_b128 v[96:99], v4 offset:8192
    ds_read_b128 v[100:103], v4 offset:9216
    ds_read_b128 v[104:107], v4 offset:10240
    ds_read_b128 v[108:111], v4 offset:11264
nowv_19:
    s_branch CH_HB1
w0fl_20:
    v_mov_b32 v64, s50
    s_mov_b64 exec, 1
    buffer_store_dword v64, off, s[4:7], s54 sc1
    s_mov_b64 exec, -1
    s_waitcnt vmcnt(1)
    s_branch CH_HB2
CH_HBs:
    s_sub_u32 s33, s33, 1
    s_cbranch_scc1 END
    s_branch CH_HB
CH_HRs:
    s_sub_u32 s33, s33, 1
    s_cbranch_scc1 END
    buffer_load_dwordx4 v[26:29], v5, s[4:7], s75 offen sc1
    buffer_load_dwordx4 v[30:33], v5, s[4:7], s75 offen offset:1024 sc1
    buffer_load_dwordx2 v[34:35], v62, s[4:7], s75 offen sc1
    s_branch CH_HR1
CH_HAs:
    s_sub_u32 s33, s33, 1
    s_cbranch_scc1 END
    s_branch CH_HA
CH_HB:
    buffer_load_dwordx4 v[68:71], v5, s[4:7], s61 offen sc1
    buffer_load_dwordx4 v[72:75], v5, s[4:7], s61 offen offset:1024 sc1
    buffer_load_dwordx2 v[76:77], v62, s[4:7], s61 offen sc1
CH_HB1:
    s_waitcnt vmcnt(0)
CH_HB2:
    v_max3_u32 v64, v68, v70, v72
    v_max3_u32 v64, v64, v74, v76
    v_cmp_eq_u32 vcc, -1, v64
    s_cbranch_vccnz CH_HBs
    buffer_load_dwordx4 v[26:29], v5, s[4:7], s75 offen sc1
    buffer_load_dwordx4 v[30:33], v5, s[4:7], s75 offen offset:1024 sc1
    buffer_load_dwordx2 v[34:35], v62, s[4:7], s75 offen sc1
    v_and_b32 v87, 0xffff0000, v77
    v_lshlrev_b32 v86, 16, v77
    v_and_b32 v85, 0xffff0000, v76
    v_lshlrev_b32 v84, 16, v76
    v_and_b32 v83, 0xffff0000, v75
    v_lshlrev_b32 v82, 16, v75
    v_and_b32 v81, 0xffff0000, v74
    v_lshlrev_b32 v80, 16, v74
    v_and_b32 v79, 0xffff0000, v73
    v_lshlrev_b32 v78, 16, v73
    v_and_b32 v77, 0xffff0000, v72
    v_lshlrev_b32 v76, 16, v72
    v_and_b32 v75, 0xffff0000, v71
    v_lshlrev_b32 v74, 16, v71
    v_and_b32 v73, 0xffff0000, v70
    v_lshlrev_b32 v72, 16, v70
    v_and_b32 v71, 0xffff0000, v69
    v_lshlrev_b32 v70, 16, v69
    v_and_b32 v69, 0xffff0000, v68
    v_lshlrev_b32 v68, 16, v68
CH_HR1:
    s_waitcnt vmcnt(0)
    v_max3_u32 v64, v26, v28, v30
    v_max3_u32 v64, v64, v32, v34
    v_cmp_eq_u32 vcc, -1, v64
    s_cbranch_vccnz CH_HRs
CH_HD:
    v_dot2_f32_bf16 v68, v26, s25, v68
    v_dot2_f32_bf16 v69, v26, s26, v69
    v_dot2_f32_bf16 v70, v27, s25, v70
    v_dot2_f32_bf16 v71, v27, s26, v71
    v_dot2_f32_bf16 v72, v28, s25, v72
    v_dot2_f32_bf16 v73, v28, s26, v73
    v_dot2_f32_bf16 v74, v29, s25, v74
    v_dot2_f32_bf16 v75, v29, s26, v75
    v_dot2_f32_bf16 v76, v30, s25, v76
    v_dot2_f32_bf16 v77, v30, s26, v77
    v_dot2_f32_bf16 v78, v31, s25, v78
    v_dot2_f32_bf16 v79, v31, s26, v79
    v_cvt_pk_bf16_f32 v26, v68, v69
    v_cvt_pk_bf16_f32 v27, v70, v71
    v_cvt_pk_bf16_f32 v28, v72, v73
    v_cvt_pk_bf16_f32 v29, v74, v75
    ds_write_b128 v6, v[26:29]
    v_dot2_f32_bf16 v80, v32, s25, v80
    v_dot2_f32_bf16 v81, v32, s26, v81
    v_dot2_f32_bf16 v82, v33, s25, v82
    v_dot2_f32_bf16 v83, v33, s26, v83
    v_dot2_f32_bf16 v84, v34, s25, v84
    v_dot2_f32_bf16 v85, v34, s26, v85
    v_dot2_f32_bf16 v86, v35, s25, v86
    v_dot2_f32_bf16 v87, v35, s26, v87
    v_cvt_pk_bf16_f32 v30, v76, v77
    v_cvt_pk_bf16_f32 v31, v78, v79
    v_cvt_pk_bf16_f32 v32, v80, v81
    v_cvt_pk_bf16_f32 v33, v82, v83
    ds_write_b128 v6, v[30:33] offset:1024
    v_cvt_pk_bf16_f32 v34, v84, v85
    v_cvt_pk_bf16_f32 v35, v86, v87
    ds_write_b64 v63, v[34:35]
    v_mov_b64 v[68:69], 0
    v_mov_b64 v[70:71], 0
    v_mov_b64 v[72:73], 0
    v_mov_b64 v[74:75], 0
    v_mov_b64 v[76:77], 0
    v_mov_b64 v[78:79], 0
    v_mov_b64 v[80:81], 0
    v_mov_b64 v[82:83], 0
    v_mov_b64 v[84:85], 0
    v_mov_b64 v[86:87], 0
    s_waitcnt lgkmcnt(0)
CH_B1:
    s_barrier
    ds_read_b128 v[26:29], v3 offset:0
    ds_read_b128 v[30:33], v3 offset:1024
    buffer_load_dwordx4 v2, s[4:7], s20 offen offset:0 sc1 lds
    buffer_load_dwordx4 v2, s[4:7], s20 offen offset:1024 sc1 lds
    s_and_b32 s60, s50, 1
    s_mul_i32 s60, s60, 12288
    s_add_u32 s35, s60, 105472
    v_add_u32 v63, s35, v2
    s_lshl_b32 s35, s50, 16
    s_lshl_b32 s36, s42, 11
    s_add_u32 s47, s35, s36
    s_waitcnt lgkmcnt(1)
    v_smfmac_f32_16x16x64_bf16 v[68:71], v[26:29], a[0:7], v17
    ds_read_b128 v[34:37], v3 offset:2048
    v_smfmac_f32_16x16x64_bf16 v[72:75], v[26:29], a[80:87], v17
    v_mov_b64 v[64:65], -1
    v_mov_b64 v[66:67], -1
    v_smfmac_f32_16x16x64_bf16 v[76:79], v[26:29], a[160:167], v17
    v_smfmac_f32_16x16x64_bf16 v[80:83], v[26:29], a[240:247], v17
    v_smfmac_f32_16x16x64_bf16 v[84:87], v[26:29], v[38:45], v17
    s_waitcnt lgkmcnt(1)
    v_smfmac_f32_16x16x64_bf16 v[68:71], v[30:33], a[8:15], v17
    ds_read_b128 v[26:29], v3 offset:3072
    v_smfmac_f32_16x16x64_bf16 v[72:75], v[30:33], a[88:95], v17
    ds_read_b128 v[38:41], v4 offset:12288
    v_smfmac_f32_16x16x64_bf16 v[76:79], v[30:33], a[168:175], v17
    ds_read_b128 v[42:45], v4 offset:13312
    v_smfmac_f32_16x16x64_bf16 v[80:83], v[30:33], a[248:255], v17
    buffer_store_dwordx4 v[64:67], v2, s[4:7], s23 offen offset:0
    v_smfmac_f32_16x16x64_bf16 v[84:87], v[30:33], v[46:53], v17
    s_waitcnt lgkmcnt(3)
    v_smfmac_f32_16x16x64_bf16 v[68:71], v[34:37], a[16:23], v17
    ds_read_b128 v[30:33], v3 offset:4096
    v_smfmac_f32_16x16x64_bf16 v[72:75], v[34:37], a[96:103], v17
    s_add_u32 s63, s47, 0x5c00000
    v_smfmac_f32_16x16x64_bf16 v[76:79], v[34:37], a[176:183], v17
    v_smfmac_f32_16x16x64_bf16 v[80:83], v[34:37], v[192:199], v17
    buffer_store_dwordx4 v[64:67], v2, s[4:7], s23 offen offset:1024
    v_smfmac_f32_16x16x64_bf16 v[84:87], v[34:37], v[54:61], v17
    s_waitcnt lgkmcnt(3)
    v_smfmac_f32_16x16x64_bf16 v[68:71], v[26:29], a[24:31], v17
    ds_read_b128 v[34:37], v3 offset:5120
    v_smfmac_f32_16x16x64_bf16 v[72:75], v[26:29], a[104:111], v17
    ds_read_b128 v[46:49], v4 offset:14336
    v_smfmac_f32_16x16x64_bf16 v[76:79], v[26:29], a[184:191], v17
    ds_read_b128 v[50:53], v4 offset:15360
    v_smfmac_f32_16x16x64_bf16 v[80:83], v[26:29], v[200:207], v17
    s_mov_b64 exec, s[12:13]
    buffer_store_dwordx4 v[64:67], v2, s[4:7], s24 offen offset:0
    s_mov_b64 exec, -1
    v_smfmac_f32_16x16x64_bf16 v[84:87], v[26:29], v[88:95], v17
    s_waitcnt lgkmcnt(3)
    v_smfmac_f32_16x16x64_bf16 v[68:71], v[30:33], a[32:39], v17
    ds_read_b128 v[26:29], v3 offset:6144
    v_smfmac_f32_16x16x64_bf16 v[72:75], v[30:33], a[112:119], v17
    v_smfmac_f32_16x16x64_bf16 v[76:79], v[30:33], a[192:199], v17
    v_smfmac_f32_16x16x64_bf16 v[80:83], v[30:33], v[208:215], v17
    s_mov_b64 exec, s[12:13]
    buffer_store_dwordx4 v[64:67], v2, s[4:7], s24 offen offset:1024
    s_mov_b64 exec, -1
    v_smfmac_f32_16x16x64_bf16 v[84:87], v[30:33], v[96:103], v17
    s_waitcnt lgkmcnt(3)
    v_smfmac_f32_16x16x64_bf16 v[68:71], v[34:37], a[40:47], v17
    ds_read_b128 v[30:33], v3 offset:7168
    v_smfmac_f32_16x16x64_bf16 v[72:75], v[34:37], a[120:127], v17
    ds_read_b128 v[54:57], v4 offset:16384
    v_smfmac_f32_16x16x64_bf16 v[76:79], v[34:37], a[200:207], v17
    ds_read_b128 v[58:61], v4 offset:17408
    v_smfmac_f32_16x16x64_bf16 v[80:83], v[34:37], v[216:223], v17
    v_smfmac_f32_16x16x64_bf16 v[84:87], v[34:37], v[104:111], v17
    s_waitcnt lgkmcnt(3)
    v_smfmac_f32_16x16x64_bf16 v[68:71], v[26:29], a[48:55], v17
    ds_read_b128 v[34:37], v3 offset:8192
    v_smfmac_f32_16x16x64_bf16 v[72:75], v[26:29], a[128:135], v17
    ds_read_b128 v[88:91], v4 offset:18432
    v_smfmac_f32_16x16x64_bf16 v[76:79], v[26:29], a[208:215], v17
    ds_read_b128 v[92:95], v4 offset:19456
    v_smfmac_f32_16x16x64_bf16 v[80:83], v[26:29], v[224:231], v17
    v_smfmac_f32_16x16x64_bf16 v[84:87], v[26:29], v[38:45], v17
    s_waitcnt lgkmcnt(5)
    v_smfmac_f32_16x16x64_bf16 v[68:71], v[30:33], a[56:63], v17
    ds_read_b128 v[26:29], v3 offset:9216
    v_smfmac_f32_16x16x64_bf16 v[72:75], v[30:33], a[136:143], v17
    v_smfmac_f32_16x16x64_bf16 v[76:79], v[30:33], a[216:223], v17
    v_smfmac_f32_16x16x64_bf16 v[80:83], v[30:33], v[232:239], v17
    v_smfmac_f32_16x16x64_bf16 v[84:87], v[30:33], v[46:53], v17
    s_waitcnt lgkmcnt(3)
    v_smfmac_f32_16x16x64_bf16 v[68:71], v[34:37], a[64:71], v17
    ds_read_b128 v[38:41], v63 offset:0
    ds_read_b128 v[42:45], v63 offset:1024
    v_smfmac_f32_16x16x64_bf16 v[72:75], v[34:37], a[144:151], v17
    ds_read_b128 v[46:49], v63 offset:2048
    ds_read_b128 v[50:53], v63 offset:3072
    v_smfmac_f32_16x16x64_bf16 v[76:79], v[34:37], a[224:231], v17
    ds_read_b128 v[30:33], v63 offset:6144
    v_smfmac_f32_16x16x64_bf16 v[80:83], v[34:37], v[240:247], v17
    v_smfmac_f32_16x16x64_bf16 v[84:87], v[34:37], v[54:61], v17
    s_waitcnt lgkmcnt(5)
    v_smfmac_f32_16x16x64_bf16 v[68:71], v[26:29], a[72:79], v17
    ds_read_b128 v[54:57], v63 offset:4096
    ds_read_b128 v[58:61], v63 offset:5120
    v_smfmac_f32_16x16x64_bf16 v[72:75], v[26:29], a[152:159], v17
    ds_read_b128 v[34:37], v63 offset:7168
    v_smfmac_f32_16x16x64_bf16 v[76:79], v[26:29], a[232:239], v17
    v_smfmac_f32_16x16x64_bf16 v[80:83], v[26:29], v[248:255], v17
    v_smfmac_f32_16x16x64_bf16 v[84:87], v[26:29], v[88:95], v17
    v_add_f32 v68, v68, v69
    v_add_f32 v70, v70, v71
    v_cvt_pk_bf16_f32 v62, v68, v68
    v_cvt_pk_bf16_f32 v63, v70, v70
    ds_write_b64 v10, v[62:63] offset:0
    v_add_f32 v72, v72, v73
    v_add_f32 v74, v74, v75
    v_cvt_pk_bf16_f32 v64, v72, v72
    v_cvt_pk_bf16_f32 v65, v74, v74
    ds_write_b64 v10, v[64:65] offset:128
    v_add_f32 v76, v76, v77
    v_add_f32 v78, v78, v79
    v_cvt_pk_bf16_f32 v66, v76, v78
    ds_write_b32 v8, v66 offset:0
    v_add_f32 v80, v80, v81
    v_add_f32 v82, v82, v83
    v_cvt_pk_bf16_f32 v67, v80, v82
    ds_write_b32 v8, v67 offset:64
    v_add_f32 v84, v84, v85
    v_add_f32 v86, v86, v87
    v_cvt_pk_bf16_f32 v84, v84, v86
    ds_write_b32 v13, v84
    s_waitcnt lgkmcnt(0)
    s_barrier
    s_cmp_eq_u32 s50, 63
    s_cbranch_scc1 CH_LAST
    ds_read_b64_tr_b16 v[88:89], v0 offset:0
    ds_read_b64_tr_b16 v[90:91], v0 offset:128
    ds_read_b64_tr_b16 v[104:105], v11 offset:0
    ds_read_b64_tr_b16 v[106:107], v11 offset:64
    buffer_store_dword v84, v12, s[4:7], s63 offen sc1
    ds_read_b64_tr_b16 v[92:93], v0 offset:1024
    ds_read_b64_tr_b16 v[94:95], v0 offset:1152
    ds_read_b64_tr_b16 v[108:109], v11 offset:512
    ds_read_b64_tr_b16 v[110:111], v11 offset:576
    ds_read_b64_tr_b16 v[96:97], v0 offset:2048
    ds_read_b64_tr_b16 v[98:99], v0 offset:2176
    ds_read_b64_tr_b16 v[68:69], v11 offset:1024
    ds_read_b64_tr_b16 v[70:71], v11 offset:1088
    ds_read_b64_tr_b16 v[100:101], v0 offset:3072
    ds_read_b64_tr_b16 v[102:103], v0 offset:3200
    ds_read_b64_tr_b16 v[72:73], v11 offset:1536
    ds_read_b64_tr_b16 v[74:75], v11 offset:1600
    v_add_u32 v62, s60, v15
    buffer_load_dwordx4 v2, s[4:7], s21 offen offset:2048 sc1 lds
    s_waitcnt lgkmcnt(14)
    v_mfma_f32_16x16x32_bf16 v[80:83], v[38:41], v[88:91], 0
    v_mfma_f32_16x16x32_bf16 v[26:29], v[42:45], v[88:91], 0
    s_waitcnt lgkmcnt(12)
    v_mfma_f32_16x16x32_bf16 v[76:79], v[104:107], v[88:91], 0
    s_waitcnt lgkmcnt(10)
    v_mfma_f32_16x16x32_bf16 v[80:83], v[46:49], v[92:95], v[80:83]
    v_mov_b64 v[104:105], 0
    v_mfma_f32_16x16x32_bf16 v[26:29], v[50:53], v[92:95], v[26:29]
    v_mov_b64 v[106:107], 0
    s_waitcnt lgkmcnt(8)
    v_mfma_f32_16x16x32_bf16 v[76:79], v[108:111], v[92:95], v[76:79]
    s_waitcnt lgkmcnt(6)
    v_mfma_f32_16x16x32_bf16 v[80:83], v[54:57], v[96:99], v[80:83]
    v_mov_b64 v[108:109], 0
    v_mfma_f32_16x16x32_bf16 v[26:29], v[58:61], v[96:99], v[26:29]
    v_mov_b64 v[110:111], 0
    s_waitcnt lgkmcnt(4)
    v_mfma_f32_16x16x32_bf16 v[76:79], v[68:71], v[96:99], v[76:79]
    s_waitcnt lgkmcnt(2)
    v_mfma_f32_16x16x32_bf16 v[80:83], v[30:33], v[100:103], v[80:83]
    v_mov_b64 v[68:69], 0
    v_mfma_f32_16x16x32_bf16 v[26:29], v[34:37], v[100:103], v[26:29]
    v_mov_b64 v[70:71], 0
    s_waitcnt lgkmcnt(0)
    v_mfma_f32_16x16x32_bf16 v[76:79], v[72:75], v[100:103], v[76:79]
    ds_read_b128 v[38:41], v62 offset:0
    ds_read_b64 v[54:55], v14 offset:0
    ds_read_b128 v[42:45], v62 offset:512
    ds_read_b64 v[56:57], v14 offset:128
    ds_read_b128 v[46:49], v62 offset:64
    ds_read_b64 v[58:59], v14 offset:16
    ds_read_b128 v[50:53], v62 offset:576
    ds_read_b64 v[60:61], v14 offset:144
    v_max3_f32 v62, v80, v81, v82
    v_max3_f32 v63, v83, v26, v27
    v_max3_f32 v64, v28, v29, v76
    v_max3_f32 v62, v62, v63, v64
    v_max3_f32 v63, v77, v78, v79
    v_max_f32 v62, v62, v63
    v_mov_b32 v63, v62
    v_mov_b64 v[72:73], 0
    v_permlane16_swap_b32 v62, v63
    s_nop 0
    v_max_f32 v62, v62, v63
    v_mov_b32 v63, v62
    v_mov_b64 v[74:75], 0
    v_permlane32_swap_b32 v62, v63
    s_nop 0
    v_max_f32 v62, v62, v63
    v_mul_f32 v62, s55, v62
    v_pk_fma_f32 v[80:81], v[80:81], s[96:97], v[62:63] op_sel_hi:[1,1,0] neg_lo:[0,0,1] neg_hi:[0,0,1]
    v_pk_fma_f32 v[82:83], v[82:83], s[96:97], v[62:63] op_sel_hi:[1,1,0] neg_lo:[0,0,1] neg_hi:[0,0,1]
    v_pk_fma_f32 v[26:27], v[26:27], s[96:97], v[62:63] op_sel_hi:[1,1,0] neg_lo:[0,0,1] neg_hi:[0,0,1]
    v_pk_fma_f32 v[28:29], v[28:29], s[96:97], v[62:63] op_sel_hi:[1,1,0] neg_lo:[0,0,1] neg_hi:[0,0,1]
    v_pk_fma_f32 v[76:77], v[76:77], s[96:97], v[62:63] op_sel_hi:[1,1,0] neg_lo:[0,0,1] neg_hi:[0,0,1]
    v_pk_fma_f32 v[78:79], v[78:79], s[96:97], v[62:63] op_sel_hi:[1,1,0] neg_lo:[0,0,1] neg_hi:[0,0,1]
    v_exp_f32 v80, v80
    v_exp_f32 v81, v81
    v_exp_f32 v82, v82
    v_exp_f32 v83, v83
    v_exp_f32 v26, v26
    v_exp_f32 v27, v27
    v_exp_f32 v28, v28
    v_exp_f32 v29, v29
    v_exp_f32 v76, v76
    v_exp_f32 v77, v77
    v_exp_f32 v78, v78
    v_exp_f32 v79, v79
    v_cvt_pk_bf16_f32 v84, v80, v81
    v_cvt_pk_bf16_f32 v85, v82, v83
    v_cvt_pk_bf16_f32 v86, v26, v27
    v_cvt_pk_bf16_f32 v87, v28, v29
    v_cndmask_b32 v76, 0, v76, s[56:57]
    s_waitcnt lgkmcnt(0)
    v_cndmask_b32 v77, 0, v77, s[56:57]
    v_mfma_f32_16x16x32_bf16 v[30:33], v[22:25], v[84:87], 0
    v_cndmask_b32 v78, 0, v78, s[56:57]
    v_cndmask_b32 v79, 0, v79, s[56:57]
    v_mfma_f32_16x16x32_bf16 v[88:91], v[38:41], v[84:87], 0
    v_cvt_pk_bf16_f32 v66, v76, v77
    v_cvt_pk_bf16_f32 v67, v78, v79
    v_mfma_f32_16x16x32_bf16 v[92:95], v[42:45], v[84:87], 0
    v_mov_b64 v[80:81], 0
    v_mov_b64 v[82:83], 0
    v_mfma_f32_16x16x32_bf16 v[96:99], v[46:49], v[84:87], 0
    v_mov_b64 v[26:27], 0
    v_mov_b64 v[28:29], 0
    v_mfma_f32_16x16x32_bf16 v[100:103], v[50:53], v[84:87], 0
    v_mov_b64 v[76:77], 0
    v_mov_b64 v[78:79], 0
    v_mfma_f32_16x16x16_bf16 v[30:33], v[22:23], v[66:67], v[30:33]
    v_mfma_f32_16x16x16_bf16 v[88:91], v[54:55], v[66:67], v[88:91]
    v_mov_b64 v[38:39], 0
    v_mov_b64 v[40:41], 0
    v_mfma_f32_16x16x16_bf16 v[96:99], v[58:59], v[66:67], v[96:99]
    v_mov_b64 v[42:43], 0
    v_mov_b64 v[44:45], 0
    v_mfma_f32_16x16x16_bf16 v[92:95], v[56:57], v[66:67], v[92:95]
    v_mov_b64 v[46:47], 0
    v_mov_b64 v[48:49], 0
    v_mfma_f32_16x16x16_bf16 v[100:103], v[60:61], v[66:67], v[100:103]
    v_rcp_f32 v62, v30
    v_cndmask_b32 v88, v88, v96, s[58:59]
    v_cndmask_b32 v89, v89, v97, s[58:59]
    v_cndmask_b32 v90, v90, v98, s[58:59]
    v_cndmask_b32 v91, v91, v99, s[58:59]
    v_cndmask_b32 v92, v92, v100, s[58:59]
    v_cndmask_b32 v93, v93, v101, s[58:59]
    v_cndmask_b32 v94, v94, v102, s[58:59]
    v_cndmask_b32 v95, v95, v103, s[58:59]
    v_pk_mul_f32 v[88:89], v[88:89], v[62:63] op_sel_hi:[1,0]
    v_pk_mul_f32 v[90:91], v[90:91], v[62:63] op_sel_hi:[1,0]
    v_pk_mul_f32 v[92:93], v[92:93], v[62:63] op_sel_hi:[1,0]
    v_pk_mul_f32 v[94:95], v[94:95], v[62:63] op_sel_hi:[1,0]
    s_add_u32 s35, s52, s101
    v_cvt_pk_bf16_f32 v50, v88, v89
    v_cvt_pk_bf16_f32 v51, v90, v91
    v_cvt_pk_bf16_f32 v52, v92, v93
    v_cvt_pk_bf16_f32 v53, v94, v95
    s_nop 0
    v_smfmac_f32_16x16x64_bf16 v[104:107], v[50:53], v[112:119], v17
    v_smfmac_f32_16x16x64_bf16 v[108:111], v[50:53], v[120:127], v17
    v_smfmac_f32_16x16x64_bf16 v[68:71], v[50:53], v[128:135], v17
    v_smfmac_f32_16x16x64_bf16 v[72:75], v[50:53], v[136:143], v17
    v_add_f32 v104, v104, v105
    v_add_f32 v106, v106, v107
    v_smfmac_f32_16x16x64_bf16 v[80:83], v[50:53], v[144:151], v17
    v_cvt_pk_bf16_f32 v104, v104, v106
    buffer_store_dword v104, v7, s[4:7], s35 offen
    s_add_u32 s35, s35, 8192
    v_smfmac_f32_16x16x64_bf16 v[26:29], v[50:53], v[152:159], v17
    v_add_f32 v108, v108, v109
    v_add_f32 v110, v110, v111
    v_smfmac_f32_16x16x64_bf16 v[76:79], v[50:53], v[160:167], v17
    v_cvt_pk_bf16_f32 v108, v108, v110
    buffer_store_dword v108, v7, s[4:7], s35 offen
    s_add_u32 s35, s35, 8192
    v_smfmac_f32_16x16x64_bf16 v[38:41], v[50:53], v[168:175], v17
    v_add_f32 v68, v68, v69
    v_add_f32 v70, v70, v71
    v_smfmac_f32_16x16x64_bf16 v[42:45], v[50:53], v[176:183], v17
    v_cvt_pk_bf16_f32 v68, v68, v70
    buffer_store_dword v68, v7, s[4:7], s35 offen
    s_add_u32 s35, s35, 8192
    v_smfmac_f32_16x16x64_bf16 v[46:49], v[50:53], v[184:191], v17
    v_add_f32 v72, v72, v73
    v_add_f32 v74, v74, v75
    v_cvt_pk_bf16_f32 v72, v72, v74
    buffer_store_dword v72, v7, s[4:7], s35 offen
    s_add_u32 s35, s35, 8192
    v_add_f32 v80, v80, v81
    v_add_f32 v82, v82, v83
    v_cvt_pk_bf16_f32 v80, v80, v82
    buffer_store_dword v80, v7, s[4:7], s35 offen
    s_add_u32 s35, s35, 8192
    v_add_f32 v26, v26, v27
    v_add_f32 v28, v28, v29
    v_cvt_pk_bf16_f32 v26, v26, v28
    buffer_store_dword v26, v7, s[4:7], s35 offen
    s_add_u32 s35, s35, 8192
    v_add_f32 v76, v76, v77
    v_add_f32 v78, v78, v79
    v_cvt_pk_bf16_f32 v76, v76, v78
    buffer_store_dword v76, v7, s[4:7], s35 offen
    s_add_u32 s35, s35, 8192
    v_add_f32 v38, v38, v39
    v_add_f32 v40, v40, v41
    v_cvt_pk_bf16_f32 v38, v38, v40
    buffer_store_dword v38, v7, s[4:7], s35 offen
    s_add_u32 s35, s35, 8192
    v_add_f32 v42, v42, v43
    v_add_f32 v44, v44, v45
    v_cvt_pk_bf16_f32 v42, v42, v44
    buffer_store_dword v42, v7, s[4:7], s35 offen
    s_add_u32 s35, s35, 8192
    v_add_f32 v46, v46, v47
    v_add_f32 v48, v48, v49
    v_cvt_pk_bf16_f32 v46, v46, v48
    buffer_store_dword v46, v7, s[4:7], s35 offen
    s_add_u32 s50, s50, 1
    s_cmp_eq_u32 s53, -1
    s_cbranch_scc1 noown_21
    s_lshl_b32 s35, s53, 13
    s_add_u32 s62, s52, s35
    s_add_u32 s62, s62, s101
    s_add_u32 s63, s62, 4096
CH_HA:
    buffer_load_dwordx4 v[26:29], v2, s[4:7], s62 offen offset:0 sc1
    buffer_load_dwordx4 v[30:33], v2, s[4:7], s62 offen offset:1024 sc1
    buffer_load_dwordx4 v[34:37], v2, s[4:7], s62 offen offset:2048 sc1
    buffer_load_dwordx4 v[38:41], v2, s[4:7], s62 offen offset:3072 sc1
    buffer_load_dwordx4 v[42:45], v2, s[4:7], s63 offen offset:0 sc1
    buffer_load_dwordx4 v[46:49], v2, s[4:7], s63 offen offset:1024 sc1
    buffer_load_dwordx4 v[50:53], v2, s[4:7], s63 offen offset:2048 sc1
    buffer_load_dwordx4 v[54:57], v2, s[4:7], s63 offen offset:3072 sc1
    s_mul_i32 s35, s50, 20480
    s_lshl_b32 s36, s53, 8
    s_add_u32 s35, s35, s36
    s_mul_i32 s36, s44, 10240
    s_add_u32 s48, s35, s36
    s_add_u32 s74, s48, 0x61e0000
    s_add_u32 s48, s48, 0x6320000
    s_mul_i32 s36, s50, 20480
    s_mul_i32 s35, s44, 10240
    s_add_u32 s61, s36, s35
    s_add_u32 s61, s61, 0x6320000
    s_xor_b32 s35, s35, 10240
    s_add_u32 s75, s36, s35
    s_add_u32 s75, s75, 0x61e0000
    v_lshrrev_b32 v62, 1, v2
    v_add_u32 v62, s14, v62
    v_add_u32 v63, 81920, v62
    s_add_u32 s46, s50, 1
    s_and_b32 s37, s46, 1
    s_mul_i32 s37, s37, 12288
    s_add_u32 s37, s37, s10
    s_mov_b32 m0, s37
    s_min_u32 s46, s46, 63
    s_cmp_gt_u32 s51, s46
    s_cbranch_scc1 kvok_23
    v_and_b32 v66, 1, v1
    v_lshlrev_b32 v66, 5, v66
    s_add_u32 s35, s42, 64
    v_add_u32 v66, s35, v66
    v_lshlrev_b32 v66, 7, v66
    v_add_u32 v66, 0x6460000, v66
kvp_24:
    buffer_load_dword v67, v66, s[4:7], 0 offen sc1
    s_waitcnt vmcnt(0)
    v_readlane_b32 s35, v67, 0
    v_readlane_b32 s36, v67, 1
    s_min_u32 s51, s35, s36
    s_sub_u32 s33, s33, 1
    s_cbranch_scc1 END
    s_cmp_le_u32 s51, s46
    s_cbranch_scc1 kvp_24
kvok_23:
    s_lshl_b32 s35, s46, 18
    s_add_u32 s20, s8, s35
    s_add_u32 s21, s9, s35
    s_add_u32 s23, s11, s52
    s_add_u32 s24, s23, 262144
    s_waitcnt vmcnt(7)
    v_mfma_f32_16x16x32_bf16 v[68:71], v[26:29], v[18:21], 0
    v_max_u32 v58, v26, v27
    v_max_u32 v59, v28, v29
    s_waitcnt vmcnt(6)
    v_mfma_f32_16x16x32_bf16 v[72:75], v[30:33], v[18:21], 0
    v_max3_u32 v58, v58, v30, v31
    v_max3_u32 v59, v59, v32, v33
    s_waitcnt vmcnt(5)
    v_mfma_f32_16x16x32_bf16 v[68:71], v[34:37], v[18:21], v[68:71]
    v_max3_u32 v58, v58, v34, v35
    v_max3_u32 v59, v59, v36, v37
    s_waitcnt vmcnt(4)
    v_mfma_f32_16x16x32_bf16 v[72:75], v[38:41], v[18:21], v[72:75]
    v_max3_u32 v58, v58, v38, v39
    v_max3_u32 v59, v59, v40, v41
    s_waitcnt vmcnt(3)
    v_mfma_f32_16x16x32_bf16 v[68:71], v[42:45], v[18:21], v[68:71]
    v_max3_u32 v58, v58, v42, v43
    v_max3_u32 v59, v59, v44, v45
    s_waitcnt vmcnt(2)
    v_mfma_f32_16x16x32_bf16 v[72:75], v[46:49], v[18:21], v[72:75]
    v_max3_u32 v58, v58, v46, v47
    v_max3_u32 v59, v59, v48, v49
    s_waitcnt vmcnt(1)
    v_mfma_f32_16x16x32_bf16 v[68:71], v[50:53], v[18:21], v[68:71]
    v_max3_u32 v58, v58, v50, v51
    v_max3_u32 v59, v59, v52, v53
    s_waitcnt vmcnt(0)
    v_mfma_f32_16x16x32_bf16 v[72:75], v[54:57], v[18:21], v[72:75]
    v_max3_u32 v58, v58, v54, v55
    v_max3_u32 v59, v59, v56, v57
    v_max_u32 v58, v58, v59
    v_cmp_eq_u32 vcc, -1, v58
    s_cbranch_vccnz CH_HAs
    s_nop 1
    v_add_f32 v68, v68, v72
    v_add_f32 v69, v69, v73
    v_add_f32 v70, v70, v74
    v_add_f32 v71, v71, v75
    v_cvt_pk_bf16_f32 v64, v68, v69
    v_cvt_pk_bf16_f32 v65, v70, v71
    s_mov_b32 exec_lo, 0x00ff00ff
    s_mov_b32 exec_hi, 0x00ff00ff
    buffer_store_dwordx2 v[64:65], v9, s[4:7], s74 offen sc1
    buffer_store_dwordx2 v[64:65], v9, s[4:7], s48 offen
    s_mov_b64 exec, -1
    s_branch b0_22
noown_21:
    s_cmp_lg_u32 s43, 0
    s_cbranch_scc1 nokm_25
    s_cmp_ge_u32 s28, 2
    s_cbranch_scc1 nokm_25
    s_lshl_b32 s35, s28, 10
    v_add_u32 v30, s35, v11
    ds_read_b64_tr_b16 v[26:27], v30
    ds_read_b64_tr_b16 v[28:29], v30 offset:64
    ds_read_b64_tr_b16 v[32:33], v30 offset:512
    ds_read_b64_tr_b16 v[34:35], v30 offset:576
    s_add_u32 s35, s47, 0x5800000
    s_waitcnt lgkmcnt(0)
    buffer_store_dwordx4 v[26:29], v16, s[4:7], s35 offen sc1
    buffer_store_dwordx4 v[32:35], v16, s[4:7], s35 offen offset:512 sc1
nokm_25:
    ds_read_b128 v[38:41], v4 offset:0
    ds_read_b128 v[42:45], v4 offset:1024
    ds_read_b128 v[46:49], v4 offset:2048
    ds_read_b128 v[50:53], v4 offset:3072
    ds_read_b128 v[54:57], v4 offset:4096
    ds_read_b128 v[58:61], v4 offset:5120
    ds_read_b128 v[88:91], v4 offset:6144
    ds_read_b128 v[92:95], v4 offset:7168
    ds_read_b128 v[96:99], v4 offset:8192
    ds_read_b128 v[100:103], v4 offset:9216
    ds_read_b128 v[104:107], v4 offset:10240
    ds_read_b128 v[108:111], v4 offset:11264
    s_mul_i32 s36, s50, 20480
    s_mul_i32 s35, s44, 10240
    s_add_u32 s61, s36, s35
    s_add_u32 s61, s61, 0x6320000
    s_xor_b32 s35, s35, 10240
    s_add_u32 s75, s36, s35
    s_add_u32 s75, s75, 0x61e0000
    v_lshrrev_b32 v62, 1, v2
    v_add_u32 v62, s14, v62
    v_add_u32 v63, 81920, v62
    s_add_u32 s46, s50, 1
    s_and_b32 s37, s46, 1
    s_mul_i32 s37, s37, 12288
    s_add_u32 s37, s37, s10
    s_mov_b32 m0, s37
    s_min_u32 s46, s46, 63
    s_cmp_gt_u32 s51, s46
    s_cbranch_scc1 kvok_26
    v_and_b32 v66, 1, v1
    v_lshlrev_b32 v66, 5, v66
    s_add_u32 s35, s42, 64
    v_add_u32 v66, s35, v66
    v_lshlrev_b32 v66, 7, v66
    v_add_u32 v66, 0x6460000, v66
kvp_27:
    buffer_load_dword v67, v66, s[4:7], 0 offen sc1
    s_waitcnt vmcnt(0)
    v_readlane_b32 s35, v67, 0
    v_readlane_b32 s36, v67, 1
    s_min_u32 s51, s35, s36
    s_sub_u32 s33, s33, 1
    s_cbranch_scc1 END
    s_cmp_le_u32 s51, s46
    s_cbranch_scc1 kvp_27
kvok_26:
    s_lshl_b32 s35, s46, 18
    s_add_u32 s20, s8, s35
    s_add_u32 s21, s9, s35
    s_add_u32 s23, s11, s52
    s_add_u32 s24, s23, 262144
    s_waitcnt vmcnt(0)
b0_22:
    s_add_u32 s52, s52, 655360
    s_cmp_eq_u32 s52, 1966080
    s_cselect_b32 s52, 0, s52
    s_barrier
    s_branch CH_LOOP
CH_LOOP_F:
    buffer_load_dwordx4 v[68:71], v5, s[4:7], s61 offen sc1
    buffer_load_dwordx4 v[72:75], v5, s[4:7], s61 offen offset:1024 sc1
    buffer_load_dwordx2 v[76:77], v62, s[4:7], s61 offen sc1
    s_cmp_eq_u32 s28, 0
    s_cbranch_scc1 w0fl_29
    s_cmp_eq_u32 s53, -1
    s_cbranch_scc1 nowv_28
    ds_read_b128 v[38:41], v4 offset:0
    ds_read_b128 v[42:45], v4 offset:1024
    ds_read_b128 v[46:49], v4 offset:2048
    ds_read_b128 v[50:53], v4 offset:3072
    ds_read_b128 v[54:57], v4 offset:4096
    ds_read_b128 v[58:61], v4 offset:5120
    ds_read_b128 v[88:91], v4 offset:6144
    ds_read_b128 v[92:95], v4 offset:7168
    ds_read_b128 v[96:99], v4 offset:8192
    ds_read_b128 v[100:103], v4 offset:9216
    ds_read_b128 v[104:107], v4 offset:10240
    ds_read_b128 v[108:111], v4 offset:11264
nowv_28:
    s_branch CH_HB1_F
w0fl_29:
    v_mov_b32 v64, s50
    s_mov_b64 exec, 1
    buffer_store_dword v64, off, s[4:7], s54 sc1
    s_mov_b64 exec, -1
    s_waitcnt vmcnt(1)
    s_branch CH_HB2_F
CH_HBs_F:
    s_sub_u32 s33, s33, 1
    s_cbranch_scc1 END
    s_branch CH_HB_F
CH_HRs_F:
    s_sub_u32 s33, s33, 1
    s_cbranch_scc1 END
    buffer_load_dwordx4 v[26:29], v5, s[4:7], s75 offen sc1
    buffer_load_dwordx4 v[30:33], v5, s[4:7], s75 offen offset:1024 sc1
    buffer_load_dwordx2 v[34:35], v62, s[4:7], s75 offen sc1
    s_branch CH_HR1_F
CH_HAs_F:
    s_sub_u32 s33, s33, 1
    s_cbranch_scc1 END
    s_branch CH_HA_F
CH_HB_F:
    buffer_load_dwordx4 v[68:71], v5, s[4:7], s61 offen sc1
    buffer_load_dwordx4 v[72:75], v5, s[4:7], s61 offen offset:1024 sc1
    buffer_load_dwordx2 v[76:77], v62, s[4:7], s61 offen sc1
CH_HB1_F:
    s_waitcnt vmcnt(0)
CH_HB2_F:
    v_max3_u32 v64, v68, v70, v72
    v_max3_u32 v64, v64, v74, v76
    v_cmp_eq_u32 vcc, -1, v64
    s_cbranch_vccnz CH_HBs_F
    buffer_load_dwordx4 v[26:29], v5, s[4:7], s75 offen sc1
    buffer_load_dwordx4 v[30:33], v5, s[4:7], s75 offen offset:1024 sc1
    buffer_load_dwordx2 v[34:35], v62, s[4:7], s75 offen sc1
    v_and_b32 v87, 0xffff0000, v77
    v_lshlrev_b32 v86, 16, v77
    v_and_b32 v85, 0xffff0000, v76
    v_lshlrev_b32 v84, 16, v76
    v_and_b32 v83, 0xffff0000, v75
    v_lshlrev_b32 v82, 16, v75
    v_and_b32 v81, 0xffff0000, v74
    v_lshlrev_b32 v80, 16, v74
    v_and_b32 v79, 0xffff0000, v73
    v_lshlrev_b32 v78, 16, v73
    v_and_b32 v77, 0xffff0000, v72
    v_lshlrev_b32 v76, 16, v72
    v_and_b32 v75, 0xffff0000, v71
    v_lshlrev_b32 v74, 16, v71
    v_and_b32 v73, 0xffff0000, v70
    v_lshlrev_b32 v72, 16, v70
    v_and_b32 v71, 0xffff0000, v69
    v_lshlrev_b32 v70, 16, v69
    v_and_b32 v69, 0xffff0000, v68
    v_lshlrev_b32 v68, 16, v68
CH_HR1_F:
    s_waitcnt vmcnt(0)
    v_max3_u32 v64, v26, v28, v30
    v_max3_u32 v64, v64, v32, v34
    v_cmp_eq_u32 vcc, -1, v64
    s_cbranch_vccnz CH_HRs_F
CH_HD_F:
    v_dot2_f32_bf16 v68, v26, s25, v68
    v_dot2_f32_bf16 v69, v26, s26, v69
    v_dot2_f32_bf16 v70, v27, s25, v70
    v_dot2_f32_bf16 v71, v27, s26, v71
    v_dot2_f32_bf16 v72, v28, s25, v72
    v_dot2_f32_bf16 v73, v28, s26, v73
    v_dot2_f32_bf16 v74, v29, s25, v74
    v_dot2_f32_bf16 v75, v29, s26, v75
    v_dot2_f32_bf16 v76, v30, s25, v76
    v_dot2_f32_bf16 v77, v30, s26, v77
    v_dot2_f32_bf16 v78, v31, s25, v78
    v_dot2_f32_bf16 v79, v31, s26, v79
    v_cvt_pk_bf16_f32 v26, v68, v69
    v_cvt_pk_bf16_f32 v27, v70, v71
    v_cvt_pk_bf16_f32 v28, v72, v73
    v_cvt_pk_bf16_f32 v29, v74, v75
    ds_write_b128 v6, v[26:29]
    v_dot2_f32_bf16 v80, v32, s25, v80
    v_dot2_f32_bf16 v81, v32, s26, v81
    v_dot2_f32_bf16 v82, v33, s25, v82
    v_dot2_f32_bf16 v83, v33, s26, v83
    v_dot2_f32_bf16 v84, v34, s25, v84
    v_dot2_f32_bf16 v85, v34, s26, v85
    v_dot2_f32_bf16 v86, v35, s25, v86
    v_dot2_f32_bf16 v87, v35, s26, v87
    v_cvt_pk_bf16_f32 v30, v76, v77
    v_cvt_pk_bf16_f32 v31, v78, v79
    v_cvt_pk_bf16_f32 v32, v80, v81
    v_cvt_pk_bf16_f32 v33, v82, v83
    ds_write_b128 v6, v[30:33] offset:1024
    v_cvt_pk_bf16_f32 v34, v84, v85
    v_cvt_pk_bf16_f32 v35, v86, v87
    ds_write_b64 v63, v[34:35]
    v_mov_b64 v[68:69], 0
    v_mov_b64 v[70:71], 0
    v_mov_b64 v[72:73], 0
    v_mov_b64 v[74:75], 0
    v_mov_b64 v[76:77], 0
    v_mov_b64 v[78:79], 0
    v_mov_b64 v[80:81], 0
    v_mov_b64 v[82:83], 0
    v_mov_b64 v[84:85], 0
    v_mov_b64 v[86:87], 0
    s_waitcnt lgkmcnt(0)
CH_B1_F:
    s_barrier
    ds_read_b128 v[26:29], v3 offset:0
    ds_read_b128 v[30:33], v3 offset:1024
    buffer_load_dwordx4 v2, s[4:7], s20 offen offset:0 sc1 lds
    buffer_load_dwordx4 v2, s[4:7], s20 offen offset:1024 sc1 lds
    s_and_b32 s60, s50, 1
    s_mul_i32 s60, s60, 12288
    s_add_u32 s35, s60, 105472
    v_add_u32 v63, s35, v2
    s_lshl_b32 s35, s50, 16
    s_lshl_b32 s36, s42, 11
    s_add_u32 s47, s35, s36
    s_waitcnt lgkmcnt(1)
    v_smfmac_f32_16x16x64_bf16 v[68:71], v[26:29], a[0:7], v17
    ds_read_b128 v[34:37], v3 offset:2048
    v_smfmac_f32_16x16x64_bf16 v[72:75], v[26:29], a[80:87], v17
    v_mov_b64 v[64:65], -1
    v_mov_b64 v[66:67], -1
    v_smfmac_f32_16x16x64_bf16 v[76:79], v[26:29], a[160:167], v17
    v_smfmac_f32_16x16x64_bf16 v[80:83], v[26:29], a[240:247], v17
    v_smfmac_f32_16x16x64_bf16 v[84:87], v[26:29], v[38:45], v17
    s_waitcnt lgkmcnt(1)
    v_smfmac_f32_16x16x64_bf16 v[68:71], v[30:33], a[8:15], v17
    ds_read_b128 v[26:29], v3 offset:3072
    v_smfmac_f32_16x16x64_bf16 v[72:75], v[30:33], a[88:95], v17
    ds_read_b128 v[38:41], v4 offset:12288
    v_smfmac_f32_16x16x64_bf16 v[76:79], v[30:33], a[168:175], v17
    ds_read_b128 v[42:45], v4 offset:13312
    v_smfmac_f32_16x16x64_bf16 v[80:83], v[30:33], a[248:255], v17
    buffer_store_dwordx4 v[64:67], v2, s[4:7], s23 offen offset:0 sc1
    v_smfmac_f32_16x16x64_bf16 v[84:87], v[30:33], v[46:53], v17
    s_waitcnt lgkmcnt(3)
    v_smfmac_f32_16x16x64_bf16 v[68:71], v[34:37], a[16:23], v17
    ds_read_b128 v[30:33], v3 offset:4096
    v_smfmac_f32_16x16x64_bf16 v[72:75], v[34:37], a[96:103], v17
    s_add_u32 s63, s47, 0x5c00000
    v_smfmac_f32_16x16x64_bf16 v[76:79], v[34:37], a[176:183], v17
    v_smfmac_f32_16x16x64_bf16 v[80:83], v[34:37], v[192:199], v17
    buffer_store_dwordx4 v[64:67], v2, s[4:7], s23 offen offset:1024 sc1
    v_smfmac_f32_16x16x64_bf16 v[84:87], v[34:37], v[54:61], v17
    s_waitcnt lgkmcnt(3)
    v_smfmac_f32_16x16x64_bf16 v[68:71], v[26:29], a[24:31], v17
    ds_read_b128 v[34:37], v3 offset:5120
    v_smfmac_f32_16x16x64_bf16 v[72:75], v[26:29], a[104:111], v17
    ds_read_b128 v[46:49], v4 offset:14336
    v_smfmac_f32_16x16x64_bf16 v[76:79], v[26:29], a[184:191], v17
    ds_read_b128 v[50:53], v4 offset:15360
    v_smfmac_f32_16x16x64_bf16 v[80:83], v[26:29], v[200:207], v17
    s_mov_b64 exec, s[12:13]
    buffer_store_dwordx4 v[64:67], v2, s[4:7], s24 offen offset:0 sc1
    s_mov_b64 exec, -1
    v_smfmac_f32_16x16x64_bf16 v[84:87], v[26:29], v[88:95], v17
    s_waitcnt lgkmcnt(3)
    v_smfmac_f32_16x16x64_bf16 v[68:71], v[30:33], a[32:39], v17
    ds_read_b128 v[26:29], v3 offset:6144
    v_smfmac_f32_16x16x64_bf16 v[72:75], v[30:33], a[112:119], v17
    v_smfmac_f32_16x16x64_bf16 v[76:79], v[30:33], a[192:199], v17
    v_smfmac_f32_16x16x64_bf16 v[80:83], v[30:33], v[208:215], v17
    s_mov_b64 exec, s[12:13]
    buffer_store_dwordx4 v[64:67], v2, s[4:7], s24 offen offset:1024 sc1
    s_mov_b64 exec, -1
    v_smfmac_f32_16x16x64_bf16 v[84:87], v[30:33], v[96:103], v17
    s_waitcnt lgkmcnt(3)
    v_smfmac_f32_16x16x64_bf16 v[68:71], v[34:37], a[40:47], v17
    ds_read_b128 v[30:33], v3 offset:7168
    v_smfmac_f32_16x16x64_bf16 v[72:75], v[34:37], a[120:127], v17
    ds_read_b128 v[54:57], v4 offset:16384
    v_smfmac_f32_16x16x64_bf16 v[76:79], v[34:37], a[200:207], v17
    ds_read_b128 v[58:61], v4 offset:17408
    v_smfmac_f32_16x16x64_bf16 v[80:83], v[34:37], v[216:223], v17
    v_smfmac_f32_16x16x64_bf16 v[84:87], v[34:37], v[104:111], v17
    s_waitcnt lgkmcnt(3)
    v_smfmac_f32_16x16x64_bf16 v[68:71], v[26:29], a[48:55], v17
    ds_read_b128 v[34:37], v3 offset:8192
    v_smfmac_f32_16x16x64_bf16 v[72:75], v[26:29], a[128:135], v17
    ds_read_b128 v[88:91], v4 offset:18432
    v_smfmac_f32_16x16x64_bf16 v[76:79], v[26:29], a[208:215], v17
    ds_read_b128 v[92:95], v4 offset:19456
    v_smfmac_f32_16x16x64_bf16 v[80:83], v[26:29], v[224:231], v17
    v_smfmac_f32_16x16x64_bf16 v[84:87], v[26:29], v[38:45], v17
    s_waitcnt lgkmcnt(5)
    v_smfmac_f32_16x16x64_bf16 v[68:71], v[30:33], a[56:63], v17
    ds_read_b128 v[26:29], v3 offset:9216
    v_smfmac_f32_16x16x64_bf16 v[72:75], v[30:33], a[136:143], v17
    v_smfmac_f32_16x16x64_bf16 v[76:79], v[30:33], a[216:223], v17
    v_smfmac_f32_16x16x64_bf16 v[80:83], v[30:33], v[232:239], v17
    v_smfmac_f32_16x16x64_bf16 v[84:87], v[30:33], v[46:53], v17
    s_waitcnt lgkmcnt(3)
    v_smfmac_f32_16x16x64_bf16 v[68:71], v[34:37], a[64:71], v17
    ds_read_b128 v[38:41], v63 offset:0
    ds_read_b128 v[42:45], v63 offset:1024
    v_smfmac_f32_16x16x64_bf16 v[72:75], v[34:37], a[144:151], v17
    ds_read_b128 v[46:49], v63 offset:2048
    ds_read_b128 v[50:53], v63 offset:3072
    v_smfmac_f32_16x16x64_bf16 v[76:79], v[34:37], a[224:231], v17
    ds_read_b128 v[30:33], v63 offset:6144
    v_smfmac_f32_16x16x64_bf16 v[80:83], v[34:37], v[240:247], v17
    v_smfmac_f32_16x16x64_bf16 v[84:87], v[34:37], v[54:61], v17
    s_waitcnt lgkmcnt(5)
    v_smfmac_f32_16x16x64_bf16 v[68:71], v[26:29], a[72:79], v17
    ds_read_b128 v[54:57], v63 offset:4096
    ds_read_b128 v[58:61], v63 offset:5120
    v_smfmac_f32_16x16x64_bf16 v[72:75], v[26:29], a[152:159], v17
    ds_read_b128 v[34:37], v63 offset:7168
    v_smfmac_f32_16x16x64_bf16 v[76:79], v[26:29], a[232:239], v17
    v_smfmac_f32_16x16x64_bf16 v[80:83], v[26:29], v[248:255], v17
    v_smfmac_f32_16x16x64_bf16 v[84:87], v[26:29], v[88:95], v17
    v_add_f32 v68, v68, v69
    v_add_f32 v70, v70, v71
    v_cvt_pk_bf16_f32 v62, v68, v68
    v_cvt_pk_bf16_f32 v63, v70, v70
    ds_write_b64 v10, v[62:63] offset:0
    v_add_f32 v72, v72, v73
    v_add_f32 v74, v74, v75
    v_cvt_pk_bf16_f32 v64, v72, v72
    v_cvt_pk_bf16_f32 v65, v74, v74
    ds_write_b64 v10, v[64:65] offset:128
    v_add_f32 v76, v76, v77
    v_add_f32 v78, v78, v79
    v_cvt_pk_bf16_f32 v66, v76, v78
    ds_write_b32 v8, v66 offset:0
    v_add_f32 v80, v80, v81
    v_add_f32 v82, v82, v83
    v_cvt_pk_bf16_f32 v67, v80, v82
    ds_write_b32 v8, v67 offset:64
    v_add_f32 v84, v84, v85
    v_add_f32 v86, v86, v87
    v_cvt_pk_bf16_f32 v84, v84, v86
    ds_write_b32 v13, v84
    s_waitcnt lgkmcnt(0)
    s_barrier
    s_cmp_eq_u32 s50, 63
    s_cbranch_scc1 CH_LAST
    ds_read_b64_tr_b16 v[88:89], v0 offset:0
    ds_read_b64_tr_b16 v[90:91], v0 offset:128
    ds_read_b64_tr_b16 v[104:105], v11 offset:0
    ds_read_b64_tr_b16 v[106:107], v11 offset:64
    buffer_store_dword v84, v12, s[4:7], s63 offen sc1
    ds_read_b64_tr_b16 v[92:93], v0 offset:1024
    ds_read_b64_tr_b16 v[94:95], v0 offset:1152
    ds_read_b64_tr_b16 v[108:109], v11 offset:512
    ds_read_b64_tr_b16 v[110:111], v11 offset:576
    ds_read_b64_tr_b16 v[96:97], v0 offset:2048
    ds_read_b64_tr_b16 v[98:99], v0 offset:2176
    ds_read_b64_tr_b16 v[68:69], v11 offset:1024
    ds_read_b64_tr_b16 v[70:71], v11 offset:1088
    ds_read_b64_tr_b16 v[100:101], v0 offset:3072
    ds_read_b64_tr_b16 v[102:103], v0 offset:3200
    ds_read_b64_tr_b16 v[72:73], v11 offset:1536
    ds_read_b64_tr_b16 v[74:75], v11 offset:1600
    v_add_u32 v62, s60, v15
    buffer_load_dwordx4 v2, s[4:7], s21 offen offset:2048 sc1 lds
    s_waitcnt lgkmcnt(14)
    v_mfma_f32_16x16x32_bf16 v[80:83], v[38:41], v[88:91], 0
    v_mfma_f32_16x16x32_bf16 v[26:29], v[42:45], v[88:91], 0
    s_waitcnt lgkmcnt(12)
    v_mfma_f32_16x16x32_bf16 v[76:79], v[104:107], v[88:91], 0
    s_waitcnt lgkmcnt(10)
    v_mfma_f32_16x16x32_bf16 v[80:83], v[46:49], v[92:95], v[80:83]
    v_mov_b64 v[104:105], 0
    v_mfma_f32_16x16x32_bf16 v[26:29], v[50:53], v[92:95], v[26:29]
    v_mov_b64 v[106:107], 0
    s_waitcnt lgkmcnt(8)
    v_mfma_f32_16x16x32_bf16 v[76:79], v[108:111], v[92:95], v[76:79]
    s_waitcnt lgkmcnt(6)
    v_mfma_f32_16x16x32_bf16 v[80:83], v[54:57], v[96:99], v[80:83]
    v_mov_b64 v[108:109], 0
    v_mfma_f32_16x16x32_bf16 v[26:29], v[58:61], v[96:99], v[26:29]
    v_mov_b64 v[110:111], 0
    s_waitcnt lgkmcnt(4)
    v_mfma_f32_16x16x32_bf16 v[76:79], v[68:71], v[96:99], v[76:79]
    s_waitcnt lgkmcnt(2)
    v_mfma_f32_16x16x32_bf16 v[80:83], v[30:33], v[100:103], v[80:83]
    v_mov_b64 v[68:69], 0
    v_mfma_f32_16x16x32_bf16 v[26:29], v[34:37], v[100:103], v[26:29]
    v_mov_b64 v[70:71], 0
    s_waitcnt lgkmcnt(0)
    v_mfma_f32_16x16x32_bf16 v[76:79], v[72:75], v[100:103], v[76:79]
    ds_read_b128 v[38:41], v62 offset:0
    ds_read_b64 v[54:55], v14 offset:0
    ds_read_b128 v[42:45], v62 offset:512
    ds_read_b64 v[56:57], v14 offset:128
    ds_read_b128 v[46:49], v62 offset:64
    ds_read_b64 v[58:59], v14 offset:16
    ds_read_b128 v[50:53], v62 offset:576
    ds_read_b64 v[60:61], v14 offset:144
    v_max3_f32 v62, v80, v81, v82
    v_max3_f32 v63, v83, v26, v27
    v_max3_f32 v64, v28, v29, v76
    v_max3_f32 v62, v62, v63, v64
    v_max3_f32 v63, v77, v78, v79
    v_max_f32 v62, v62, v63
    v_mov_b32 v63, v62
    v_mov_b64 v[72:73], 0
    v_permlane16_swap_b32 v62, v63
    s_nop 0
    v_max_f32 v62, v62, v63
    v_mov_b32 v63, v62
    v_mov_b64 v[74:75], 0
    v_permlane32_swap_b32 v62, v63
    s_nop 0
    v_max_f32 v62, v62, v63
    v_mul_f32 v62, s55, v62
    v_pk_fma_f32 v[80:81], v[80:81], s[96:97], v[62:63] op_sel_hi:[1,1,0] neg_lo:[0,0,1] neg_hi:[0,0,1]
    v_pk_fma_f32 v[82:83], v[82:83], s[96:97], v[62:63] op_sel_hi:[1,1,0] neg_lo:[0,0,1] neg_hi:[0,0,1]
    v_pk_fma_f32 v[26:27], v[26:27], s[96:97], v[62:63] op_sel_hi:[1,1,0] neg_lo:[0,0,1] neg_hi:[0,0,1]
    v_pk_fma_f32 v[28:29], v[28:29], s[96:97], v[62:63] op_sel_hi:[1,1,0] neg_lo:[0,0,1] neg_hi:[0,0,1]
    v_pk_fma_f32 v[76:77], v[76:77], s[96:97], v[62:63] op_sel_hi:[1,1,0] neg_lo:[0,0,1] neg_hi:[0,0,1]
    v_pk_fma_f32 v[78:79], v[78:79], s[96:97], v[62:63] op_sel_hi:[1,1,0] neg_lo:[0,0,1] neg_hi:[0,0,1]
    v_exp_f32 v80, v80
    v_exp_f32 v81, v81
    v_exp_f32 v82, v82
    v_exp_f32 v83, v83
    v_exp_f32 v26, v26
    v_exp_f32 v27, v27
    v_exp_f32 v28, v28
    v_exp_f32 v29, v29
    v_exp_f32 v76, v76
    v_exp_f32 v77, v77
    v_exp_f32 v78, v78
    v_exp_f32 v79, v79
    v_cvt_pk_bf16_f32 v84, v80, v81
    v_cvt_pk_bf16_f32 v85, v82, v83
    v_cvt_pk_bf16_f32 v86, v26, v27
    v_cvt_pk_bf16_f32 v87, v28, v29
    v_cndmask_b32 v76, 0, v76, s[56:57]
    s_waitcnt lgkmcnt(0)
    v_cndmask_b32 v77, 0, v77, s[56:57]
    v_mfma_f32_16x16x32_bf16 v[30:33], v[22:25], v[84:87], 0
    v_cndmask_b32 v78, 0, v78, s[56:57]
    v_cndmask_b32 v79, 0, v79, s[56:57]
    v_mfma_f32_16x16x32_bf16 v[88:91], v[38:41], v[84:87], 0
    v_cvt_pk_bf16_f32 v66, v76, v77
    v_cvt_pk_bf16_f32 v67, v78, v79
    v_mfma_f32_16x16x32_bf16 v[92:95], v[42:45], v[84:87], 0
    v_mov_b64 v[80:81], 0
    v_mov_b64 v[82:83], 0
    v_mfma_f32_16x16x32_bf16 v[96:99], v[46:49], v[84:87], 0
    v_mov_b64 v[26:27], 0
    v_mov_b64 v[28:29], 0
    v_mfma_f32_16x16x32_bf16 v[100:103], v[50:53], v[84:87], 0
    v_mov_b64 v[76:77], 0
    v_mov_b64 v[78:79], 0
    v_mfma_f32_16x16x16_bf16 v[30:33], v[22:23], v[66:67], v[30:33]
    v_mfma_f32_16x16x16_bf16 v[88:91], v[54:55], v[66:67], v[88:91]
    v_mov_b64 v[38:39], 0
    v_mov_b64 v[40:41], 0
    v_mfma_f32_16x16x16_bf16 v[96:99], v[58:59], v[66:67], v[96:99]
    v_mov_b64 v[42:43], 0
    v_mov_b64 v[44:45], 0
    v_mfma_f32_16x16x16_bf16 v[92:95], v[56:57], v[66:67], v[92:95]
    v_mov_b64 v[46:47], 0
    v_mov_b64 v[48:49], 0
    v_mfma_f32_16x16x16_bf16 v[100:103], v[60:61], v[66:67], v[100:103]
    v_rcp_f32 v62, v30
    v_cndmask_b32 v88, v88, v96, s[58:59]
    v_cndmask_b32 v89, v89, v97, s[58:59]
    v_cndmask_b32 v90, v90, v98, s[58:59]
    v_cndmask_b32 v91, v91, v99, s[58:59]
    v_cndmask_b32 v92, v92, v100, s[58:59]
    v_cndmask_b32 v93, v93, v101, s[58:59]
    v_cndmask_b32 v94, v94, v102, s[58:59]
    v_cndmask_b32 v95, v95, v103, s[58:59]
    v_pk_mul_f32 v[88:89], v[88:89], v[62:63] op_sel_hi:[1,0]
    v_pk_mul_f32 v[90:91], v[90:91], v[62:63] op_sel_hi:[1,0]
    v_pk_mul_f32 v[92:93], v[92:93], v[62:63] op_sel_hi:[1,0]
    v_pk_mul_f32 v[94:95], v[94:95], v[62:63] op_sel_hi:[1,0]
    s_add_u32 s35, s52, s101
    v_cvt_pk_bf16_f32 v50, v88, v89
    v_cvt_pk_bf16_f32 v51, v90, v91
    v_cvt_pk_bf16_f32 v52, v92, v93
    v_cvt_pk_bf16_f32 v53, v94, v95
    s_nop 0
    v_smfmac_f32_16x16x64_bf16 v[104:107], v[50:53], v[112:119], v17
    v_smfmac_f32_16x16x64_bf16 v[108:111], v[50:53], v[120:127], v17
    v_smfmac_f32_16x16x64_bf16 v[68:71], v[50:53], v[128:135], v17
    v_smfmac_f32_16x16x64_bf16 v[72:75], v[50:53], v[136:143], v17
    v_add_f32 v104, v104, v105
    v_add_f32 v106, v106, v107
    v_smfmac_f32_16x16x64_bf16 v[80:83], v[50:53], v[144:151], v17
    v_cvt_pk_bf16_f32 v104, v104, v106
    buffer_store_dword v104, v7, s[4:7], s35 offen sc1
    s_add_u32 s35, s35, 8192
    v_smfmac_f32_16x16x64_bf16 v[26:29], v[50:53], v[152:159], v17
    v_add_f32 v108, v108, v109
    v_add_f32 v110, v110, v111
    v_smfmac_f32_16x16x64_bf16 v[76:79], v[50:53], v[160:167], v17
    v_cvt_pk_bf16_f32 v108, v108, v110
    buffer_store_dword v108, v7, s[4:7], s35 offen sc1
    s_add_u32 s35, s35, 8192
    v_smfmac_f32_16x16x64_bf16 v[38:41], v[50:53], v[168:175], v17
    v_add_f32 v68, v68, v69
    v_add_f32 v70, v70, v71
    v_smfmac_f32_16x16x64_bf16 v[42:45], v[50:53], v[176:183], v17
    v_cvt_pk_bf16_f32 v68, v68, v70
    buffer_store_dword v68, v7, s[4:7], s35 offen sc1
    s_add_u32 s35, s35, 8192
    v_smfmac_f32_16x16x64_bf16 v[46:49], v[50:53], v[184:191], v17
    v_add_f32 v72, v72, v73
    v_add_f32 v74, v74, v75
    v_cvt_pk_bf16_f32 v72, v72, v74
    buffer_store_dword v72, v7, s[4:7], s35 offen sc1
    s_add_u32 s35, s35, 8192
    v_add_f32 v80, v80, v81
    v_add_f32 v82, v82, v83
    v_cvt_pk_bf16_f32 v80, v80, v82
    buffer_store_dword v80, v7, s[4:7], s35 offen sc1
    s_add_u32 s35, s35, 8192
    v_add_f32 v26, v26, v27
    v_add_f32 v28, v28, v29
    v_cvt_pk_bf16_f32 v26, v26, v28
    buffer_store_dword v26, v7, s[4:7], s35 offen sc1
    s_add_u32 s35, s35, 8192
    v_add_f32 v76, v76, v77
    v_add_f32 v78, v78, v79
    v_cvt_pk_bf16_f32 v76, v76, v78
    buffer_store_dword v76, v7, s[4:7], s35 offen sc1
    s_add_u32 s35, s35, 8192
    v_add_f32 v38, v38, v39
    v_add_f32 v40, v40, v41
    v_cvt_pk_bf16_f32 v38, v38, v40
    buffer_store_dword v38, v7, s[4:7], s35 offen sc1
    s_add_u32 s35, s35, 8192
    v_add_f32 v42, v42, v43
    v_add_f32 v44, v44, v45
    v_cvt_pk_bf16_f32 v42, v42, v44
    buffer_store_dword v42, v7, s[4:7], s35 offen sc1
    s_add_u32 s35, s35, 8192
    v_add_f32 v46, v46, v47
    v_add_f32 v48, v48, v49
    v_cvt_pk_bf16_f32 v46, v46, v48
    buffer_store_dword v46, v7, s[4:7], s35 offen sc1
    s_add_u32 s50, s50, 1
    s_cmp_eq_u32 s53, -1
    s_cbranch_scc1 noown_30
    s_lshl_b32 s35, s53, 13
    s_add_u32 s62, s52, s35
    s_add_u32 s62, s62, s101
    s_add_u32 s63, s62, 4096
CH_HA_F:
    buffer_load_dwordx4 v[26:29], v2, s[4:7], s62 offen offset:0 sc1
    buffer_load_dwordx4 v[30:33], v2, s[4:7], s62 offen offset:1024 sc1
    buffer_load_dwordx4 v[34:37], v2, s[4:7], s62 offen offset:2048 sc1
    buffer_load_dwordx4 v[38:41], v2, s[4:7], s62 offen offset:3072 sc1
    buffer_load_dwordx4 v[42:45], v2, s[4:7], s63 offen offset:0 sc1
    buffer_load_dwordx4 v[46:49], v2, s[4:7], s63 offen offset:1024 sc1
    buffer_load_dwordx4 v[50:53], v2, s[4:7], s63 offen offset:2048 sc1
    buffer_load_dwordx4 v[54:57], v2, s[4:7], s63 offen offset:3072 sc1
    s_mul_i32 s35, s50, 20480
    s_lshl_b32 s36, s53, 8
    s_add_u32 s35, s35, s36
    s_mul_i32 s36, s44, 10240
    s_add_u32 s48, s35, s36
    s_add_u32 s74, s48, 0x61e0000
    s_add_u32 s48, s48, 0x6320000
    s_mul_i32 s36, s50, 20480
    s_mul_i32 s35, s44, 10240
    s_add_u32 s61, s36, s35
    s_add_u32 s61, s61, 0x6320000
    s_xor_b32 s35, s35, 10240
    s_add_u32 s75, s36, s35
    s_add_u32 s75, s75, 0x61e0000
    v_lshrrev_b32 v62, 1, v2
    v_add_u32 v62, s14, v62
    v_add_u32 v63, 81920, v62
    s_add_u32 s46, s50, 1
    s_and_b32 s37, s46, 1
    s_mul_i32 s37, s37, 12288
    s_add_u32 s37, s37, s10
    s_mov_b32 m0, s37
    s_min_u32 s46, s46, 63
    s_cmp_gt_u32 s51, s46
    s_cbranch_scc1 kvok_32
    v_and_b32 v66, 1, v1
    v_lshlrev_b32 v66, 5, v66
    s_add_u32 s35, s42, 64
    v_add_u32 v66, s35, v66
    v_lshlrev_b32 v66, 7, v66
    v_add_u32 v66, 0x6460000, v66
kvp_33:
    buffer_load_dword v67, v66, s[4:7], 0 offen sc1
    s_waitcnt vmcnt(0)
    v_readlane_b32 s35, v67, 0
    v_readlane_b32 s36, v67, 1
    s_min_u32 s51, s35, s36
    s_sub_u32 s33, s33, 1
    s_cbranch_scc1 END
    s_cmp_le_u32 s51, s46
    s_cbranch_scc1 kvp_33
kvok_32:
    s_lshl_b32 s35, s46, 18
    s_add_u32 s20, s8, s35
    s_add_u32 s21, s9, s35
    s_add_u32 s23, s11, s52
    s_add_u32 s24, s23, 262144
    s_waitcnt vmcnt(7)
    v_mfma_f32_16x16x32_bf16 v[68:71], v[26:29], v[18:21], 0
    v_max_u32 v58, v26, v27
    v_max_u32 v59, v28, v29
    s_waitcnt vmcnt(6)
    v_mfma_f32_16x16x32_bf16 v[72:75], v[30:33], v[18:21], 0
    v_max3_u32 v58, v58, v30, v31
    v_max3_u32 v59, v59, v32, v33
    s_waitcnt vmcnt(5)
    v_mfma_f32_16x16x32_bf16 v[68:71], v[34:37], v[18:21], v[68:71]
    v_max3_u32 v58, v58, v34, v35
    v_max3_u32 v59, v59, v36, v37
    s_waitcnt vmcnt(4)
    v_mfma_f32_16x16x32_bf16 v[72:75], v[38:41], v[18:21], v[72:75]
    v_max3_u32 v58, v58, v38, v39
    v_max3_u32 v59, v59, v40, v41
    s_waitcnt vmcnt(3)
    v_mfma_f32_16x16x32_bf16 v[68:71], v[42:45], v[18:21], v[68:71]
    v_max3_u32 v58, v58, v42, v43
    v_max3_u32 v59, v59, v44, v45
    s_waitcnt vmcnt(2)
    v_mfma_f32_16x16x32_bf16 v[72:75], v[46:49], v[18:21], v[72:75]
    v_max3_u32 v58, v58, v46, v47
    v_max3_u32 v59, v59, v48, v49
    s_waitcnt vmcnt(1)
    v_mfma_f32_16x16x32_bf16 v[68:71], v[50:53], v[18:21], v[68:71]
    v_max3_u32 v58, v58, v50, v51
    v_max3_u32 v59, v59, v52, v53
    s_waitcnt vmcnt(0)
    v_mfma_f32_16x16x32_bf16 v[72:75], v[54:57], v[18:21], v[72:75]
    v_max3_u32 v58, v58, v54, v55
    v_max3_u32 v59, v59, v56, v57
    v_max_u32 v58, v58, v59
    v_cmp_eq_u32 vcc, -1, v58
    s_cbranch_vccnz CH_HAs_F
    s_nop 1
    v_add_f32 v68, v68, v72
    v_add_f32 v69, v69, v73
    v_add_f32 v70, v70, v74
    v_add_f32 v71, v71, v75
    v_cvt_pk_bf16_f32 v64, v68, v69
    v_cvt_pk_bf16_f32 v65, v70, v71
    s_mov_b32 exec_lo, 0x00ff00ff
    s_mov_b32 exec_hi, 0x00ff00ff
    buffer_store_dwordx2 v[64:65], v9, s[4:7], s74 offen sc1
    buffer_store_dwordx2 v[64:65], v9, s[4:7], s48 offen sc1
    s_mov_b64 exec, -1
    s_branch b0_31
noown_30:
    s_cmp_lg_u32 s43, 0
    s_cbranch_scc1 nokm_34
    s_cmp_ge_u32 s28, 2
    s_cbranch_scc1 nokm_34
    s_lshl_b32 s35, s28, 10
    v_add_u32 v30, s35, v11
    ds_read_b64_tr_b16 v[26:27], v30
    ds_read_b64_tr_b16 v[28:29], v30 offset:64
    ds_read_b64_tr_b16 v[32:33], v30 offset:512
    ds_read_b64_tr_b16 v[34:35], v30 offset:576
    s_add_u32 s35, s47, 0x5800000
    s_waitcnt lgkmcnt(0)
    buffer_store_dwordx4 v[26:29], v16, s[4:7], s35 offen sc1
    buffer_store_dwordx4 v[32:35], v16, s[4:7], s35 offen offset:512 sc1
nokm_34:
    ds_read_b128 v[38:41], v4 offset:0
    ds_read_b128 v[42:45], v4 offset:1024
    ds_read_b128 v[46:49], v4 offset:2048
    ds_read_b128 v[50:53], v4 offset:3072
    ds_read_b128 v[54:57], v4 offset:4096
    ds_read_b128 v[58:61], v4 offset:5120
    ds_read_b128 v[88:91], v4 offset:6144
    ds_read_b128 v[92:95], v4 offset:7168
    ds_read_b128 v[96:99], v4 offset:8192
    ds_read_b128 v[100:103], v4 offset:9216
    ds_read_b128 v[104:107], v4 offset:10240
    ds_read_b128 v[108:111], v4 offset:11264
    s_mul_i32 s36, s50, 20480
    s_mul_i32 s35, s44, 10240
    s_add_u32 s61, s36, s35
    s_add_u32 s61, s61, 0x6320000
    s_xor_b32 s35, s35, 10240
    s_add_u32 s75, s36, s35
    s_add_u32 s75, s75, 0x61e0000
    v_lshrrev_b32 v62, 1, v2
    v_add_u32 v62, s14, v62
    v_add_u32 v63, 81920, v62
    s_add_u32 s46, s50, 1
    s_and_b32 s37, s46, 1
    s_mul_i32 s37, s37, 12288
    s_add_u32 s37, s37, s10
    s_mov_b32 m0, s37
    s_min_u32 s46, s46, 63
    s_cmp_gt_u32 s51, s46
    s_cbranch_scc1 kvok_35
    v_and_b32 v66, 1, v1
    v_lshlrev_b32 v66, 5, v66
    s_add_u32 s35, s42, 64
    v_add_u32 v66, s35, v66
    v_lshlrev_b32 v66, 7, v66
    v_add_u32 v66, 0x6460000, v66
kvp_36:
    buffer_load_dword v67, v66, s[4:7], 0 offen sc1
    s_waitcnt vmcnt(0)
    v_readlane_b32 s35, v67, 0
    v_readlane_b32 s36, v67, 1
    s_min_u32 s51, s35, s36
    s_sub_u32 s33, s33, 1
    s_cbranch_scc1 END
    s_cmp_le_u32 s51, s46
    s_cbranch_scc1 kvp_36
kvok_35:
    s_lshl_b32 s35, s46, 18
    s_add_u32 s20, s8, s35
    s_add_u32 s21, s9, s35
    s_add_u32 s23, s11, s52
    s_add_u32 s24, s23, 262144
    s_waitcnt vmcnt(0)
b0_31:
    s_add_u32 s52, s52, 655360
    s_cmp_eq_u32 s52, 1966080
    s_cselect_b32 s52, 0, s52
    s_barrier
    s_branch CH_LOOP_F
CH_LAST:
    buffer_store_dword v84, v12, s[4:7], s63 offen sc1
    s_cmp_lg_u32 s43, 0
    s_cbranch_scc1 nokm_37
    s_lshl_b32 s35, s28, 9
    v_add_u32 v63, s35, v11
    ds_read_b64_tr_b16 v[30:31], v63
    ds_read_b64_tr_b16 v[32:33], v63 offset:64
    s_waitcnt lgkmcnt(0)
    s_lshl_b32 s36, s28, 9
    v_subrev_u32 v34, s36, v16
    s_add_u32 s35, s47, 0x5800000
    buffer_store_dwordx4 v[30:33], v34, s[4:7], s35 offen sc1
nokm_37:
    s_waitcnt vmcnt(0) lgkmcnt(0)
    s_barrier
    s_mov_b32 s50, 64
    s_cmp_lg_u32 s28, 0
    s_cbranch_scc1 fp_38
    s_lshl_b32 s34, s29, 7
    s_add_u32 s34, s34, 0x6460000
    v_mov_b32 v100, s50
    v_mov_b32 v101, 0
    s_mov_b64 exec, 1
    buffer_store_dword v100, v101, s[4:7], s34 offen sc1
    s_mov_b64 exec, -1
fp_38:
    s_branch END
ROLE_K:
    s_load_dwordx2 s[8:9], s[0:1], 24
    s_mov_b32 s10, 0x500000
    s_mov_b32 s11, 0x20000
    s_waitcnt lgkmcnt(0)
    s_sub_u32 s42, s29, 64
    s_lshl_b32 s46, s42, 8
    s_lshl_b32 s47, s28, 2
    v_lshrrev_b32 v48, 4, v1
    v_and_b32 v49, 15, v1
    v_lshlrev_b32 v50, 1, v48
    v_xor_b32 v49, v49, v50
    s_lshr_b32 s34, s28, 1
    s_lshl_b32 s34, s34, 3
    v_xor_b32 v49, s34, v49
    s_mov_b32 s34, 8192
    v_mul_lo_u32 v48, v48, s34
    v_lshlrev_b32 v49, 4, v49
    v_add_u32 v5, v48, v49
    s_mul_i32 s41, s28, 32768
    s_add_u32 s41, s41, s46
    s_lshl_b32 s40, s28, 10
    s_add_u32 s40, s40, 0
    s_mov_b32 m0, s40
    s_nop 0
    buffer_load_dwordx4 v5, s[8:11], s41 offen lds
    s_add_u32 s40, s40, 4096
    s_add_u32 s41, s41, 131072
    s_mov_b32 m0, s40
    s_nop 0
    buffer_load_dwordx4 v5, s[8:11], s41 offen lds
    s_add_u32 s40, s40, 4096
    s_add_u32 s41, s41, 131072
    s_mov_b32 m0, s40
    s_nop 0
    buffer_load_dwordx4 v5, s[8:11], s41 offen lds
    s_add_u32 s40, s40, 4096
    s_add_u32 s41, s41, 131072
    s_mov_b32 m0, s40
    s_nop 0
    buffer_load_dwordx4 v5, s[8:11], s41 offen lds
    s_add_u32 s40, s40, 4096
    s_add_u32 s41, s41, 131072
    s_mov_b32 m0, s40
    s_nop 0
    buffer_load_dwordx4 v5, s[8:11], s41 offen lds
    s_add_u32 s40, s40, 4096
    s_add_u32 s41, s41, 131072
    s_mov_b32 m0, s40
    s_nop 0
    buffer_load_dwordx4 v5, s[8:11], s41 offen lds
    s_add_u32 s40, s40, 4096
    s_add_u32 s41, s41, 131072
    s_mov_b32 m0, s40
    s_nop 0
    buffer_load_dwordx4 v5, s[8:11], s41 offen lds
    s_add_u32 s40, s40, 4096
    s_add_u32 s41, s41, 131072
    s_mov_b32 m0, s40
    s_nop 0
    buffer_load_dwordx4 v5, s[8:11], s41 offen lds
    s_add_u32 s40, s40, 4096
    s_add_u32 s41, s41, 131072
    s_mov_b32 m0, s40
    s_nop 0
    buffer_load_dwordx4 v5, s[8:11], s41 offen lds
    s_add_u32 s40, s40, 4096
    s_add_u32 s41, s41, 131072
    s_mov_b32 m0, s40
    s_nop 0
    buffer_load_dwordx4 v5, s[8:11], s41 offen lds
    s_add_u32 s40, s40, 4096
    s_add_u32 s41, s41, 131072
    s_mov_b32 m0, s40
    s_nop 0
    buffer_load_dwordx4 v5, s[8:11], s41 offen lds
    s_add_u32 s40, s40, 4096
    s_add_u32 s41, s41, 131072
    s_mov_b32 m0, s40
    s_nop 0
    buffer_load_dwordx4 v5, s[8:11], s41 offen lds
    s_add_u32 s40, s40, 4096
    s_add_u32 s41, s41, 131072
    s_mov_b32 m0, s40
    s_nop 0
    buffer_load_dwordx4 v5, s[8:11], s41 offen lds
    s_add_u32 s40, s40, 4096
    s_add_u32 s41, s41, 131072
    s_mov_b32 m0, s40
    s_nop 0
    buffer_load_dwordx4 v5, s[8:11], s41 offen lds
    s_add_u32 s40, s40, 4096
    s_add_u32 s41, s41, 131072
    s_mov_b32 m0, s40
    s_nop 0
    buffer_load_dwordx4 v5, s[8:11], s41 offen lds
    s_add_u32 s40, s40, 4096
    s_add_u32 s41, s41, 131072
    s_mov_b32 m0, s40
    s_nop 0
    buffer_load_dwordx4 v5, s[8:11], s41 offen lds
    s_add_u32 s40, s40, 4096
    s_add_u32 s41, s41, 131072
    s_mov_b32 m0, s40
    s_nop 0
    buffer_load_dwordx4 v5, s[8:11], s41 offen lds
    s_add_u32 s40, s40, 4096
    s_add_u32 s41, s41, 131072
    s_mov_b32 m0, s40
    s_nop 0
    buffer_load_dwordx4 v5, s[8:11], s41 offen lds
    s_add_u32 s40, s40, 4096
    s_add_u32 s41, s41, 131072
    s_mov_b32 m0, s40
    s_nop 0
    buffer_load_dwordx4 v5, s[8:11], s41 offen lds
    s_add_u32 s40, s40, 4096
    s_add_u32 s41, s41, 131072
    s_mov_b32 m0, s40
    s_nop 0
    buffer_load_dwordx4 v5, s[8:11], s41 offen lds
    s_add_u32 s40, s40, 4096
    s_add_u32 s41, s41, 131072
    s_mov_b32 m0, s40
    s_nop 0
    buffer_load_dwordx4 v5, s[8:11], s41 offen lds
    s_add_u32 s40, s40, 4096
    s_add_u32 s41, s41, 131072
    s_mov_b32 m0, s40
    s_nop 0
    buffer_load_dwordx4 v5, s[8:11], s41 offen lds
    s_add_u32 s40, s40, 4096
    s_add_u32 s41, s41, 131072
    s_mov_b32 m0, s40
    s_nop 0
    buffer_load_dwordx4 v5, s[8:11], s41 offen lds
    s_add_u32 s40, s40, 4096
    s_add_u32 s41, s41, 131072
    s_mov_b32 m0, s40
    s_nop 0
    buffer_load_dwordx4 v5, s[8:11], s41 offen lds
    s_add_u32 s40, s40, 4096
    s_add_u32 s41, s41, 131072
    s_mov_b32 m0, s40
    s_nop 0
    buffer_load_dwordx4 v5, s[8:11], s41 offen lds
    s_add_u32 s40, s40, 4096
    s_add_u32 s41, s41, 131072
    s_mov_b32 m0, s40
    s_nop 0
    buffer_load_dwordx4 v5, s[8:11], s41 offen lds
    s_add_u32 s40, s40, 4096
    s_add_u32 s41, s41, 131072
    s_mov_b32 m0, s40
    s_nop 0
    buffer_load_dwordx4 v5, s[8:11], s41 offen lds
    s_add_u32 s40, s40, 4096
    s_add_u32 s41, s41, 131072
    s_mov_b32 m0, s40
    s_nop 0
    buffer_load_dwordx4 v5, s[8:11], s41 offen lds
    s_add_u32 s40, s40, 4096
    s_add_u32 s41, s41, 131072
    s_mov_b32 m0, s40
    s_nop 0
    buffer_load_dwordx4 v5, s[8:11], s41 offen lds
    s_add_u32 s40, s40, 4096
    s_add_u32 s41, s41, 131072
    s_mov_b32 m0, s40
    s_nop 0
    buffer_load_dwordx4 v5, s[8:11], s41 offen lds
    s_add_u32 s40, s40, 4096
    s_add_u32 s41, s41, 131072
    s_mov_b32 m0, s40
    s_nop 0
    buffer_load_dwordx4 v5, s[8:11], s41 offen lds
    s_add_u32 s40, s40, 4096
    s_add_u32 s41, s41, 131072
    s_mov_b32 m0, s40
    s_nop 0
    buffer_load_dwordx4 v5, s[8:11], s41 offen lds
    s_add_u32 s40, s40, 4096
    s_add_u32 s41, s41, 131072
    s_mov_b32 m0, s40
    s_nop 0
    buffer_load_dwordx4 v5, s[8:11], s41 offen lds
    s_add_u32 s40, s40, 4096
    s_add_u32 s41, s41, 131072
    s_mov_b32 m0, s40
    s_nop 0
    buffer_load_dwordx4 v5, s[8:11], s41 offen lds
    s_add_u32 s40, s40, 4096
    s_add_u32 s41, s41, 131072
    s_mov_b32 m0, s40
    s_nop 0
    buffer_load_dwordx4 v5, s[8:11], s41 offen lds
    s_add_u32 s40, s40, 4096
    s_add_u32 s41, s41, 131072
    s_mov_b32 m0, s40
    s_nop 0
    buffer_load_dwordx4 v5, s[8:11], s41 offen lds
    s_add_u32 s40, s40, 4096
    s_add_u32 s41, s41, 131072
    s_mov_b32 m0, s40
    s_nop 0
    buffer_load_dwordx4 v5, s[8:11], s41 offen lds
    s_add_u32 s40, s40, 4096
    s_add_u32 s41, s41, 131072
    s_mov_b32 m0, s40
    s_nop 0
    buffer_load_dwordx4 v5, s[8:11], s41 offen lds
    s_add_u32 s40, s40, 4096
    s_add_u32 s41, s41, 131072
    s_mov_b32 m0, s40
    s_nop 0
    buffer_load_dwordx4 v5, s[8:11], s41 offen lds
    s_add_u32 s40, s40, 4096
    s_add_u32 s41, s41, 131072
    s_mov_b32 m0, s40
    s_nop 0
    buffer_load_dwordx4 v5, s[8:11], s41 offen lds
    v_lshrrev_b32 v48, 4, v1
    v_bfe_u32 v49, v1, 2, 2
    v_and_b32 v52, 3, v1
    v_add_u32 v50, s47, v52
    v_mov_b32 v51, 0
    v_and_b32 v53, 1, v48
    v_lshl_or_b32 v53, v53, 2, v49
    v_lshlrev_b32 v53, 1, v53
    v_xor_b32 v50, v50, v53
    v_lshlrev_b32 v50, 4, v50
    v_lshl_add_u32 v50, v51, 3, v50
    v_lshl_add_u32 v50, v49, 8, v50
    v_lshl_add_u32 v6, v48, 11, v50
    v_lshrrev_b32 v48, 4, v1
    v_bfe_u32 v49, v1, 2, 2
    v_and_b32 v52, 3, v1
    v_add_u32 v50, s47, v52
    v_mov_b32 v51, 1
    v_and_b32 v53, 1, v48
    v_lshl_or_b32 v53, v53, 2, v49
    v_lshlrev_b32 v53, 1, v53
    v_xor_b32 v50, v50, v53
    v_lshlrev_b32 v50, 4, v50
    v_lshl_add_u32 v50, v51, 3, v50
    v_lshl_add_u32 v50, v49, 8, v50
    v_lshl_add_u32 v7, v48, 11, v50
    v_add_u32 v54, 0x10000, v6
    v_add_u32 v55, 0x10000, v7
    v_add_u32 v56, 0x20000, v6
    v_add_u32 v57, 0x20000, v7
    s_waitcnt vmcnt(0)
    s_barrier
    ds_read_b64_tr_b16 a[0:1], v6 offset:0
    ds_read_b64_tr_b16 a[2:3], v6 offset:1024
    ds_read_b64_tr_b16 a[80:81], v7 offset:0
    ds_read_b64_tr_b16 a[82:83], v7 offset:1024
    ds_read_b64_tr_b16 a[4:5], v6 offset:8192
    ds_read_b64_tr_b16 a[6:7], v6 offset:9216
    ds_read_b64_tr_b16 a[84:85], v7 offset:8192
    ds_read_b64_tr_b16 a[86:87], v7 offset:9216
    ds_read_b64_tr_b16 a[8:9], v6 offset:16384
    ds_read_b64_tr_b16 a[10:11], v6 offset:17408
    ds_read_b64_tr_b16 a[88:89], v7 offset:16384
    ds_read_b64_tr_b16 a[90:91], v7 offset:17408
    ds_read_b64_tr_b16 a[12:13], v6 offset:24576
    ds_read_b64_tr_b16 a[14:15], v6 offset:25600
    ds_read_b64_tr_b16 a[92:93], v7 offset:24576
    ds_read_b64_tr_b16 a[94:95], v7 offset:25600
    s_waitcnt lgkmcnt(0)
    ds_read_b64_tr_b16 a[16:17], v6 offset:32768
    ds_read_b64_tr_b16 a[18:19], v6 offset:33792
    ds_read_b64_tr_b16 a[96:97], v7 offset:32768
    ds_read_b64_tr_b16 a[98:99], v7 offset:33792
    ds_read_b64_tr_b16 a[20:21], v6 offset:40960
    ds_read_b64_tr_b16 a[22:23], v6 offset:41984
    ds_read_b64_tr_b16 a[100:101], v7 offset:40960
    ds_read_b64_tr_b16 a[102:103], v7 offset:41984
    ds_read_b64_tr_b16 a[24:25], v6 offset:49152
    ds_read_b64_tr_b16 a[26:27], v6 offset:50176
    ds_read_b64_tr_b16 a[104:105], v7 offset:49152
    ds_read_b64_tr_b16 a[106:107], v7 offset:50176
    ds_read_b64_tr_b16 a[28:29], v6 offset:57344
    ds_read_b64_tr_b16 a[30:31], v6 offset:58368
    ds_read_b64_tr_b16 a[108:109], v7 offset:57344
    ds_read_b64_tr_b16 a[110:111], v7 offset:58368
    s_waitcnt lgkmcnt(0)
    ds_read_b64_tr_b16 a[32:33], v54 offset:0
    ds_read_b64_tr_b16 a[34:35], v54 offset:1024
    ds_read_b64_tr_b16 a[112:113], v55 offset:0
    ds_read_b64_tr_b16 a[114:115], v55 offset:1024
    ds_read_b64_tr_b16 a[36:37], v54 offset:8192
    ds_read_b64_tr_b16 a[38:39], v54 offset:9216
    ds_read_b64_tr_b16 a[116:117], v55 offset:8192
    ds_read_b64_tr_b16 a[118:119], v55 offset:9216
    ds_read_b64_tr_b16 a[40:41], v54 offset:16384
    ds_read_b64_tr_b16 a[42:43], v54 offset:17408
    ds_read_b64_tr_b16 a[120:121], v55 offset:16384
    ds_read_b64_tr_b16 a[122:123], v55 offset:17408
    ds_read_b64_tr_b16 a[44:45], v54 offset:24576
    ds_read_b64_tr_b16 a[46:47], v54 offset:25600
    ds_read_b64_tr_b16 a[124:125], v55 offset:24576
    ds_read_b64_tr_b16 a[126:127], v55 offset:25600
    s_waitcnt lgkmcnt(0)
    ds_read_b64_tr_b16 a[48:49], v54 offset:32768
    ds_read_b64_tr_b16 a[50:51], v54 offset:33792
    ds_read_b64_tr_b16 a[128:129], v55 offset:32768
    ds_read_b64_tr_b16 a[130:131], v55 offset:33792
    ds_read_b64_tr_b16 a[52:53], v54 offset:40960
    ds_read_b64_tr_b16 a[54:55], v54 offset:41984
    ds_read_b64_tr_b16 a[132:133], v55 offset:40960
    ds_read_b64_tr_b16 a[134:135], v55 offset:41984
    ds_read_b64_tr_b16 a[56:57], v54 offset:49152
    ds_read_b64_tr_b16 a[58:59], v54 offset:50176
    ds_read_b64_tr_b16 a[136:137], v55 offset:49152
    ds_read_b64_tr_b16 a[138:139], v55 offset:50176
    ds_read_b64_tr_b16 a[60:61], v54 offset:57344
    ds_read_b64_tr_b16 a[62:63], v54 offset:58368
    ds_read_b64_tr_b16 a[140:141], v55 offset:57344
    ds_read_b64_tr_b16 a[142:143], v55 offset:58368
    s_waitcnt lgkmcnt(0)
    ds_read_b64_tr_b16 a[64:65], v56 offset:0
    ds_read_b64_tr_b16 a[66:67], v56 offset:1024
    ds_read_b64_tr_b16 a[144:145], v57 offset:0
    ds_read_b64_tr_b16 a[146:147], v57 offset:1024
    ds_read_b64_tr_b16 a[68:69], v56 offset:8192
    ds_read_b64_tr_b16 a[70:71], v56 offset:9216
    ds_read_b64_tr_b16 a[148:149], v57 offset:8192
    ds_read_b64_tr_b16 a[150:151], v57 offset:9216
    ds_read_b64_tr_b16 a[72:73], v56 offset:16384
    ds_read_b64_tr_b16 a[74:75], v56 offset:17408
    ds_read_b64_tr_b16 a[152:153], v57 offset:16384
    ds_read_b64_tr_b16 a[154:155], v57 offset:17408
    ds_read_b64_tr_b16 a[76:77], v56 offset:24576
    ds_read_b64_tr_b16 a[78:79], v56 offset:25600
    ds_read_b64_tr_b16 a[156:157], v57 offset:24576
    ds_read_b64_tr_b16 a[158:159], v57 offset:25600
    s_waitcnt lgkmcnt(0)
    s_waitcnt lgkmcnt(0)
    s_barrier
    s_cmp_lg_u32 s28, 0
    s_cbranch_scc1 wd_39
    v_mov_b32 v48, 1
    v_mov_b32 v49, 128
    s_mov_b64 exec, 1
    buffer_atomic_add v48, v49, s[16:19], 0 offen sc1
    s_mov_b64 exec, -1
wd_39:
    v_lshlrev_b32 v2, 4, v1
    v_lshrrev_b32 v3, 4, v1
    v_lshlrev_b32 v3, 9, v3
    v_and_b32 v4, 15, v1
    v_lshl_add_u32 v3, v4, 4, v3
    s_lshl_b32 s34, s28, 11
    v_add_u32 v59, s34, v2
    s_cmp_lg_u32 s28, 0
    s_cbranch_scc1 w0_40
    v_mov_b32 v49, 192
    v_mov_b32 v50, 1
    v_mov_b32 v51, 64
    v_cmp_eq_u32 vcc, 1, v1
    v_cndmask_b32 v49, v49, v51, vcc
    v_mov_b32 v51, 36
    v_cmp_eq_u32 vcc, 0, v1
    v_cndmask_b32 v49, v49, v51, vcc
    v_mov_b32 v51, 192
    v_cndmask_b32 v50, v50, v51, vcc
fw_41:
    buffer_load_dword v48, v49, s[16:19], 0 offen sc1
    s_waitcnt vmcnt(0)
    v_cmp_gt_u32 vcc, v50, v48
    s_sub_u32 s33, s33, 1
    s_cbranch_scc1 END
    s_cbranch_vccz fd_42
    s_sleep 2
    s_branch fw_41
fd_42:
w0_40:
    s_barrier
    s_mov_b32 s31, 0
    s_mov_b32 s50, 0
    s_mul_i32 s41, s31, 40960
    s_mul_i32 s34, s28, 10240
    s_add_u32 s41, s41, s34
    s_add_u32 s40, s50, s34
    s_mov_b32 m0, s40
    s_nop 0
    buffer_load_dwordx4 v2, s[4:7], s41 offen sc1 lds
    s_add_u32 s40, s40, 1024
    s_add_u32 s41, s41, 1024
    s_mov_b32 m0, s40
    s_nop 0
    buffer_load_dwordx4 v2, s[4:7], s41 offen sc1 lds
    s_add_u32 s40, s40, 1024
    s_add_u32 s41, s41, 1024
    s_mov_b32 m0, s40
    s_nop 0
    buffer_load_dwordx4 v2, s[4:7], s41 offen sc1 lds
    s_add_u32 s40, s40, 1024
    s_add_u32 s41, s41, 1024
    s_mov_b32 m0, s40
    s_nop 0
    buffer_load_dwordx4 v2, s[4:7], s41 offen sc1 lds
    s_add_u32 s40, s40, 1024
    s_add_u32 s41, s41, 1024
    s_mov_b32 m0, s40
    s_nop 0
    buffer_load_dwordx4 v2, s[4:7], s41 offen sc1 lds
    s_add_u32 s40, s40, 1024
    s_add_u32 s41, s41, 1024
    s_mov_b32 m0, s40
    s_nop 0
    buffer_load_dwordx4 v2, s[4:7], s41 offen sc1 lds
    s_add_u32 s40, s40, 1024
    s_add_u32 s41, s41, 1024
    s_mov_b32 m0, s40
    s_nop 0
    buffer_load_dwordx4 v2, s[4:7], s41 offen sc1 lds
    s_add_u32 s40, s40, 1024
    s_add_u32 s41, s41, 1024
    s_mov_b32 m0, s40
    s_nop 0
    buffer_load_dwordx4 v2, s[4:7], s41 offen sc1 lds
    s_add_u32 s40, s40, 1024
    s_add_u32 s41, s41, 1024
    s_mov_b32 m0, s40
    s_nop 0
    buffer_load_dwordx4 v2, s[4:7], s41 offen sc1 lds
    s_add_u32 s40, s40, 1024
    s_add_u32 s41, s41, 1024
    s_mov_b32 m0, s40
    s_nop 0
    buffer_load_dwordx4 v2, s[4:7], s41 offen sc1 lds
    s_waitcnt vmcnt(0)
    s_barrier
K_43:
    s_cmp_lg_u32 s31, 1
    s_cbranch_scc1 lnw_44
    s_cmp_lg_u32 s28, 0
    s_cbranch_scc1 w0_45
    v_and_b32 v49, 63, v1
    v_lshlrev_b32 v49, 7, v49
    v_add_u32 v49, 0x6460040, v49
fw_46:
    buffer_load_dword v48, v49, s[4:7], 0 offen sc1
    s_waitcnt vmcnt(0)
    v_cmp_gt_u32 vcc, s31, v48
    s_sub_u32 s33, s33, 1
    s_cbranch_scc1 END
    s_cbranch_vccz fd_47
    s_sleep 2
    s_branch fw_46
fd_47:
w0_45:
    s_barrier
lnw_44:
    s_add_u32 s51, s31, 1
    s_min_u32 s39, s51, 63
    s_xor_b32 s52, s50, 40960
    s_mul_i32 s41, s39, 40960
    s_mul_i32 s34, s28, 10240
    s_add_u32 s41, s41, s34
    s_add_u32 s40, s52, s34
    s_mov_b32 m0, s40
    s_nop 0
    buffer_load_dwordx4 v2, s[4:7], s41 offen sc1 lds
    s_add_u32 s40, s40, 1024
    s_add_u32 s41, s41, 1024
    s_mov_b32 m0, s40
    s_nop 0
    buffer_load_dwordx4 v2, s[4:7], s41 offen sc1 lds
    s_add_u32 s40, s40, 1024
    s_add_u32 s41, s41, 1024
    s_mov_b32 m0, s40
    s_nop 0
    buffer_load_dwordx4 v2, s[4:7], s41 offen sc1 lds
    s_add_u32 s40, s40, 1024
    s_add_u32 s41, s41, 1024
    s_mov_b32 m0, s40
    s_nop 0
    buffer_load_dwordx4 v2, s[4:7], s41 offen sc1 lds
    s_add_u32 s40, s40, 1024
    s_add_u32 s41, s41, 1024
    s_mov_b32 m0, s40
    s_nop 0
    buffer_load_dwordx4 v2, s[4:7], s41 offen sc1 lds
    s_add_u32 s40, s40, 1024
    s_add_u32 s41, s41, 1024
    s_mov_b32 m0, s40
    s_nop 0
    buffer_load_dwordx4 v2, s[4:7], s41 offen sc1 lds
    s_add_u32 s40, s40, 1024
    s_add_u32 s41, s41, 1024
    s_mov_b32 m0, s40
    s_nop 0
    buffer_load_dwordx4 v2, s[4:7], s41 offen sc1 lds
    s_add_u32 s40, s40, 1024
    s_add_u32 s41, s41, 1024
    s_mov_b32 m0, s40
    s_nop 0
    buffer_load_dwordx4 v2, s[4:7], s41 offen sc1 lds
    s_add_u32 s40, s40, 1024
    s_add_u32 s41, s41, 1024
    s_mov_b32 m0, s40
    s_nop 0
    buffer_load_dwordx4 v2, s[4:7], s41 offen sc1 lds
    s_add_u32 s40, s40, 1024
    s_add_u32 s41, s41, 1024
    s_mov_b32 m0, s40
    s_nop 0
    buffer_load_dwordx4 v2, s[4:7], s41 offen sc1 lds
    v_add_u32 v58, s50, v3
    ds_read_b128 v[24:27], v58 offset:0
    ds_read_b128 v[28:31], v58 offset:256
    ds_read_b128 v[32:35], v58 offset:2048
    ds_read_b128 v[36:39], v58 offset:2304
    ds_read_b128 v[40:43], v58 offset:4096
    ds_read_b128 v[44:47], v58 offset:4352
    s_waitcnt lgkmcnt(4)
    v_mfma_f32_16x16x32_bf16 v[8:11], a[0:3], v[24:27], 0
    v_mfma_f32_16x16x32_bf16 v[16:19], a[80:83], v[24:27], 0
    v_mfma_f32_16x16x32_bf16 v[12:15], a[0:3], v[28:31], 0
    v_mfma_f32_16x16x32_bf16 v[20:23], a[80:83], v[28:31], 0
    ds_read_b128 v[24:27], v58 offset:6144
    ds_read_b128 v[28:31], v58 offset:6400
    s_waitcnt lgkmcnt(4)
    v_mfma_f32_16x16x32_bf16 v[8:11], a[4:7], v[32:35], v[8:11]
    v_mfma_f32_16x16x32_bf16 v[16:19], a[84:87], v[32:35], v[16:19]
    v_mfma_f32_16x16x32_bf16 v[12:15], a[4:7], v[36:39], v[12:15]
    v_mfma_f32_16x16x32_bf16 v[20:23], a[84:87], v[36:39], v[20:23]
    ds_read_b128 v[32:35], v58 offset:8192
    ds_read_b128 v[36:39], v58 offset:8448
    s_waitcnt lgkmcnt(4)
    v_mfma_f32_16x16x32_bf16 v[8:11], a[8:11], v[40:43], v[8:11]
    v_mfma_f32_16x16x32_bf16 v[16:19], a[88:91], v[40:43], v[16:19]
    v_mfma_f32_16x16x32_bf16 v[12:15], a[8:11], v[44:47], v[12:15]
    v_mfma_f32_16x16x32_bf16 v[20:23], a[88:91], v[44:47], v[20:23]
    ds_read_b128 v[40:43], v58 offset:10240
    ds_read_b128 v[44:47], v58 offset:10496
    s_waitcnt lgkmcnt(4)
    v_mfma_f32_16x16x32_bf16 v[8:11], a[12:15], v[24:27], v[8:11]
    v_mfma_f32_16x16x32_bf16 v[16:19], a[92:95], v[24:27], v[16:19]
    v_mfma_f32_16x16x32_bf16 v[12:15], a[12:15], v[28:31], v[12:15]
    v_mfma_f32_16x16x32_bf16 v[20:23], a[92:95], v[28:31], v[20:23]
    ds_read_b128 v[24:27], v58 offset:12288
    ds_read_b128 v[28:31], v58 offset:12544
    s_waitcnt lgkmcnt(4)
    v_mfma_f32_16x16x32_bf16 v[8:11], a[16:19], v[32:35], v[8:11]
    v_mfma_f32_16x16x32_bf16 v[16:19], a[96:99], v[32:35], v[16:19]
    v_mfma_f32_16x16x32_bf16 v[12:15], a[16:19], v[36:39], v[12:15]
    v_mfma_f32_16x16x32_bf16 v[20:23], a[96:99], v[36:39], v[20:23]
    ds_read_b128 v[32:35], v58 offset:14336
    ds_read_b128 v[36:39], v58 offset:14592
    s_waitcnt lgkmcnt(4)
    v_mfma_f32_16x16x32_bf16 v[8:11], a[20:23], v[40:43], v[8:11]
    v_mfma_f32_16x16x32_bf16 v[16:19], a[100:103], v[40:43], v[16:19]
    v_mfma_f32_16x16x32_bf16 v[12:15], a[20:23], v[44:47], v[12:15]
    v_mfma_f32_16x16x32_bf16 v[20:23], a[100:103], v[44:47], v[20:23]
    ds_read_b128 v[40:43], v58 offset:16384
    ds_read_b128 v[44:47], v58 offset:16640
    s_waitcnt lgkmcnt(4)
    v_mfma_f32_16x16x32_bf16 v[8:11], a[24:27], v[24:27], v[8:11]
    v_mfma_f32_16x16x32_bf16 v[16:19], a[104:107], v[24:27], v[16:19]
    v_mfma_f32_16x16x32_bf16 v[12:15], a[24:27], v[28:31], v[12:15]
    v_mfma_f32_16x16x32_bf16 v[20:23], a[104:107], v[28:31], v[20:23]
    ds_read_b128 v[24:27], v58 offset:18432
    ds_read_b128 v[28:31], v58 offset:18688
    s_waitcnt lgkmcnt(4)
    v_mfma_f32_16x16x32_bf16 v[8:11], a[28:31], v[32:35], v[8:11]
    v_mfma_f32_16x16x32_bf16 v[16:19], a[108:111], v[32:35], v[16:19]
    v_mfma_f32_16x16x32_bf16 v[12:15], a[28:31], v[36:39], v[12:15]
    v_mfma_f32_16x16x32_bf16 v[20:23], a[108:111], v[36:39], v[20:23]
    ds_read_b128 v[32:35], v58 offset:20480
    ds_read_b128 v[36:39], v58 offset:20736
    s_waitcnt lgkmcnt(4)
    v_mfma_f32_16x16x32_bf16 v[8:11], a[32:35], v[40:43], v[8:11]
    v_mfma_f32_16x16x32_bf16 v[16:19], a[112:115], v[40:43], v[16:19]
    v_mfma_f32_16x16x32_bf16 v[12:15], a[32:35], v[44:47], v[12:15]
    v_mfma_f32_16x16x32_bf16 v[20:23], a[112:115], v[44:47], v[20:23]
    ds_read_b128 v[40:43], v58 offset:22528
    ds_read_b128 v[44:47], v58 offset:22784
    s_waitcnt lgkmcnt(4)
    v_mfma_f32_16x16x32_bf16 v[8:11], a[36:39], v[24:27], v[8:11]
    v_mfma_f32_16x16x32_bf16 v[16:19], a[116:119], v[24:27], v[16:19]
    v_mfma_f32_16x16x32_bf16 v[12:15], a[36:39], v[28:31], v[12:15]
    v_mfma_f32_16x16x32_bf16 v[20:23], a[116:119], v[28:31], v[20:23]
    ds_read_b128 v[24:27], v58 offset:24576
    ds_read_b128 v[28:31], v58 offset:24832
    s_waitcnt lgkmcnt(4)
    v_mfma_f32_16x16x32_bf16 v[8:11], a[40:43], v[32:35], v[8:11]
    v_mfma_f32_16x16x32_bf16 v[16:19], a[120:123], v[32:35], v[16:19]
    v_mfma_f32_16x16x32_bf16 v[12:15], a[40:43], v[36:39], v[12:15]
    v_mfma_f32_16x16x32_bf16 v[20:23], a[120:123], v[36:39], v[20:23]
    ds_read_b128 v[32:35], v58 offset:26624
    ds_read_b128 v[36:39], v58 offset:26880
    s_waitcnt lgkmcnt(4)
    v_mfma_f32_16x16x32_bf16 v[8:11], a[44:47], v[40:43], v[8:11]
    v_mfma_f32_16x16x32_bf16 v[16:19], a[124:127], v[40:43], v[16:19]
    v_mfma_f32_16x16x32_bf16 v[12:15], a[44:47], v[44:47], v[12:15]
    v_mfma_f32_16x16x32_bf16 v[20:23], a[124:127], v[44:47], v[20:23]
    ds_read_b128 v[40:43], v58 offset:28672
    ds_read_b128 v[44:47], v58 offset:28928
    s_waitcnt lgkmcnt(4)
    v_mfma_f32_16x16x32_bf16 v[8:11], a[48:51], v[24:27], v[8:11]
    v_mfma_f32_16x16x32_bf16 v[16:19], a[128:131], v[24:27], v[16:19]
    v_mfma_f32_16x16x32_bf16 v[12:15], a[48:51], v[28:31], v[12:15]
    v_mfma_f32_16x16x32_bf16 v[20:23], a[128:131], v[28:31], v[20:23]
    ds_read_b128 v[24:27], v58 offset:30720
    ds_read_b128 v[28:31], v58 offset:30976
    s_waitcnt lgkmcnt(4)
    v_mfma_f32_16x16x32_bf16 v[8:11], a[52:55], v[32:35], v[8:11]
    v_mfma_f32_16x16x32_bf16 v[16:19], a[132:135], v[32:35], v[16:19]
    v_mfma_f32_16x16x32_bf16 v[12:15], a[52:55], v[36:39], v[12:15]
    v_mfma_f32_16x16x32_bf16 v[20:23], a[132:135], v[36:39], v[20:23]
    ds_read_b128 v[32:35], v58 offset:32768
    ds_read_b128 v[36:39], v58 offset:33024
    s_waitcnt lgkmcnt(4)
    v_mfma_f32_16x16x32_bf16 v[8:11], a[56:59], v[40:43], v[8:11]
    v_mfma_f32_16x16x32_bf16 v[16:19], a[136:139], v[40:43], v[16:19]
    v_mfma_f32_16x16x32_bf16 v[12:15], a[56:59], v[44:47], v[12:15]
    v_mfma_f32_16x16x32_bf16 v[20:23], a[136:139], v[44:47], v[20:23]
    ds_read_b128 v[40:43], v58 offset:34816
    ds_read_b128 v[44:47], v58 offset:35072
    s_waitcnt lgkmcnt(4)
    v_mfma_f32_16x16x32_bf16 v[8:11], a[60:63], v[24:27], v[8:11]
    v_mfma_f32_16x16x32_bf16 v[16:19], a[140:143], v[24:27], v[16:19]
    v_mfma_f32_16x16x32_bf16 v[12:15], a[60:63], v[28:31], v[12:15]
    v_mfma_f32_16x16x32_bf16 v[20:23], a[140:143], v[28:31], v[20:23]
    ds_read_b128 v[24:27], v58 offset:36864
    ds_read_b128 v[28:31], v58 offset:37120
    s_waitcnt lgkmcnt(4)
    v_mfma_f32_16x16x32_bf16 v[8:11], a[64:67], v[32:35], v[8:11]
    v_mfma_f32_16x16x32_bf16 v[16:19], a[144:147], v[32:35], v[16:19]
    v_mfma_f32_16x16x32_bf16 v[12:15], a[64:67], v[36:39], v[12:15]
    v_mfma_f32_16x16x32_bf16 v[20:23], a[144:147], v[36:39], v[20:23]
    ds_read_b128 v[32:35], v58 offset:38912
    ds_read_b128 v[36:39], v58 offset:39168
    s_waitcnt lgkmcnt(4)
    v_mfma_f32_16x16x32_bf16 v[8:11], a[68:71], v[40:43], v[8:11]
    v_mfma_f32_16x16x32_bf16 v[16:19], a[148:151], v[40:43], v[16:19]
    v_mfma_f32_16x16x32_bf16 v[12:15], a[68:71], v[44:47], v[12:15]
    v_mfma_f32_16x16x32_bf16 v[20:23], a[148:151], v[44:47], v[20:23]
    s_waitcnt lgkmcnt(2)
    v_mfma_f32_16x16x32_bf16 v[8:11], a[72:75], v[24:27], v[8:11]
    v_mfma_f32_16x16x32_bf16 v[16:19], a[152:155], v[24:27], v[16:19]
    v_mfma_f32_16x16x32_bf16 v[12:15], a[72:75], v[28:31], v[12:15]
    v_mfma_f32_16x16x32_bf16 v[20:23], a[152:155], v[28:31], v[20:23]
    s_waitcnt lgkmcnt(0)
    v_mfma_f32_16x16x32_bf16 v[8:11], a[76:79], v[32:35], v[8:11]
    v_mfma_f32_16x16x32_bf16 v[16:19], a[156:159], v[32:35], v[16:19]
    v_mfma_f32_16x16x32_bf16 v[12:15], a[76:79], v[36:39], v[12:15]
    v_mfma_f32_16x16x32_bf16 v[20:23], a[156:159], v[36:39], v[20:23]
    s_lshl_b32 s48, s31, 18
    s_lshl_b32 s49, s42, 13
    s_add_u32 s48, s48, s49
    s_add_u32 s48, s48, 0x400000
    s_nop 7
    v_cvt_pk_bf16_f32 v48, v8, v9
    v_cvt_pk_bf16_f32 v49, v10, v11
    v_cvt_pk_bf16_f32 v50, v16, v17
    v_cvt_pk_bf16_f32 v51, v18, v19
    buffer_store_dwordx4 v[48:51], v59, s[4:7], s48 offen offset:0 sc1
    v_cvt_pk_bf16_f32 v52, v12, v13
    v_cvt_pk_bf16_f32 v53, v14, v15
    v_cvt_pk_bf16_f32 v54, v20, v21
    v_cvt_pk_bf16_f32 v55, v22, v23
    buffer_store_dwordx4 v[52:55], v59, s[4:7], s48 offen offset:1024 sc1
    s_waitcnt vmcnt(0)
    s_barrier
    s_cmp_lg_u32 s28, 0
    s_cbranch_scc1 fp_48
    s_lshl_b32 s34, s29, 7
    s_add_u32 s34, s34, 0x6460000
    v_mov_b32 v48, s51
    v_mov_b32 v49, 0
    s_mov_b64 exec, 1
    buffer_store_dword v48, v49, s[4:7], s34 offen sc1
    s_mov_b64 exec, -1
fp_48:
    s_mov_b32 s31, s51
    s_mov_b32 s50, s52
    s_cmp_lt_u32 s31, 64
    s_cbranch_scc1 K_43
    s_branch END
ROLE_V:
    s_load_dwordx2 s[8:9], s[0:1], 32
    s_mov_b32 s10, 0x500000
    s_mov_b32 s11, 0x20000
    s_waitcnt lgkmcnt(0)
    s_sub_u32 s42, s29, 96
    s_lshl_b32 s46, s42, 8
    s_lshl_b32 s47, s28, 2
    s_add_u32 s48, s47, 2
    v_lshrrev_b32 v48, 4, v1
    v_and_b32 v49, 15, v1
    v_lshlrev_b32 v50, 1, v48
    v_xor_b32 v49, v49, v50
    s_lshr_b32 s34, s28, 1
    s_lshl_b32 s34, s34, 3
    v_xor_b32 v49, s34, v49
    s_mov_b32 s34, 8192
    v_mul_lo_u32 v48, v48, s34
    v_lshlrev_b32 v49, 4, v49
    v_add_u32 v5, v48, v49
    s_mul_i32 s41, s28, 32768
    s_add_u32 s41, s41, s46
    s_lshl_b32 s40, s28, 10
    s_add_u32 s40, s40, 0
    s_mov_b32 m0, s40
    s_nop 0
    buffer_load_dwordx4 v5, s[8:11], s41 offen lds
    s_add_u32 s40, s40, 4096
    s_add_u32 s41, s41, 131072
    s_mov_b32 m0, s40
    s_nop 0
    buffer_load_dwordx4 v5, s[8:11], s41 offen lds
    s_add_u32 s40, s40, 4096
    s_add_u32 s41, s41, 131072
    s_mov_b32 m0, s40
    s_nop 0
    buffer_load_dwordx4 v5, s[8:11], s41 offen lds
    s_add_u32 s40, s40, 4096
    s_add_u32 s41, s41, 131072
    s_mov_b32 m0, s40
    s_nop 0
    buffer_load_dwordx4 v5, s[8:11], s41 offen lds
    s_add_u32 s40, s40, 4096
    s_add_u32 s41, s41, 131072
    s_mov_b32 m0, s40
    s_nop 0
    buffer_load_dwordx4 v5, s[8:11], s41 offen lds
    s_add_u32 s40, s40, 4096
    s_add_u32 s41, s41, 131072
    s_mov_b32 m0, s40
    s_nop 0
    buffer_load_dwordx4 v5, s[8:11], s41 offen lds
    s_add_u32 s40, s40, 4096
    s_add_u32 s41, s41, 131072
    s_mov_b32 m0, s40
    s_nop 0
    buffer_load_dwordx4 v5, s[8:11], s41 offen lds
    s_add_u32 s40, s40, 4096
    s_add_u32 s41, s41, 131072
    s_mov_b32 m0, s40
    s_nop 0
    buffer_load_dwordx4 v5, s[8:11], s41 offen lds
    s_add_u32 s40, s40, 4096
    s_add_u32 s41, s41, 131072
    s_mov_b32 m0, s40
    s_nop 0
    buffer_load_dwordx4 v5, s[8:11], s41 offen lds
    s_add_u32 s40, s40, 4096
    s_add_u32 s41, s41, 131072
    s_mov_b32 m0, s40
    s_nop 0
    buffer_load_dwordx4 v5, s[8:11], s41 offen lds
    s_add_u32 s40, s40, 4096
    s_add_u32 s41, s41, 131072
    s_mov_b32 m0, s40
    s_nop 0
    buffer_load_dwordx4 v5, s[8:11], s41 offen lds
    s_add_u32 s40, s40, 4096
    s_add_u32 s41, s41, 131072
    s_mov_b32 m0, s40
    s_nop 0
    buffer_load_dwordx4 v5, s[8:11], s41 offen lds
    s_add_u32 s40, s40, 4096
    s_add_u32 s41, s41, 131072
    s_mov_b32 m0, s40
    s_nop 0
    buffer_load_dwordx4 v5, s[8:11], s41 offen lds
    s_add_u32 s40, s40, 4096
    s_add_u32 s41, s41, 131072
    s_mov_b32 m0, s40
    s_nop 0
    buffer_load_dwordx4 v5, s[8:11], s41 offen lds
    s_add_u32 s40, s40, 4096
    s_add_u32 s41, s41, 131072
    s_mov_b32 m0, s40
    s_nop 0
    buffer_load_dwordx4 v5, s[8:11], s41 offen lds
    s_add_u32 s40, s40, 4096
    s_add_u32 s41, s41, 131072
    s_mov_b32 m0, s40
    s_nop 0
    buffer_load_dwordx4 v5, s[8:11], s41 offen lds
    s_add_u32 s40, s40, 4096
    s_add_u32 s41, s41, 131072
    s_mov_b32 m0, s40
    s_nop 0
    buffer_load_dwordx4 v5, s[8:11], s41 offen lds
    s_add_u32 s40, s40, 4096
    s_add_u32 s41, s41, 131072
    s_mov_b32 m0, s40
    s_nop 0
    buffer_load_dwordx4 v5, s[8:11], s41 offen lds
    s_add_u32 s40, s40, 4096
    s_add_u32 s41, s41, 131072
    s_mov_b32 m0, s40
    s_nop 0
    buffer_load_dwordx4 v5, s[8:11], s41 offen lds
    s_add_u32 s40, s40, 4096
    s_add_u32 s41, s41, 131072
    s_mov_b32 m0, s40
    s_nop 0
    buffer_load_dwordx4 v5, s[8:11], s41 offen lds
    s_add_u32 s40, s40, 4096
    s_add_u32 s41, s41, 131072
    s_mov_b32 m0, s40
    s_nop 0
    buffer_load_dwordx4 v5, s[8:11], s41 offen lds
    s_add_u32 s40, s40, 4096
    s_add_u32 s41, s41, 131072
    s_mov_b32 m0, s40
    s_nop 0
    buffer_load_dwordx4 v5, s[8:11], s41 offen lds
    s_add_u32 s40, s40, 4096
    s_add_u32 s41, s41, 131072
    s_mov_b32 m0, s40
    s_nop 0
    buffer_load_dwordx4 v5, s[8:11], s41 offen lds
    s_add_u32 s40, s40, 4096
    s_add_u32 s41, s41, 131072
    s_mov_b32 m0, s40
    s_nop 0
    buffer_load_dwordx4 v5, s[8:11], s41 offen lds
    s_add_u32 s40, s40, 4096
    s_add_u32 s41, s41, 131072
    s_mov_b32 m0, s40
    s_nop 0
    buffer_load_dwordx4 v5, s[8:11], s41 offen lds
    s_add_u32 s40, s40, 4096
    s_add_u32 s41, s41, 131072
    s_mov_b32 m0, s40
    s_nop 0
    buffer_load_dwordx4 v5, s[8:11], s41 offen lds
    s_add_u32 s40, s40, 4096
    s_add_u32 s41, s41, 131072
    s_mov_b32 m0, s40
    s_nop 0
    buffer_load_dwordx4 v5, s[8:11], s41 offen lds
    s_add_u32 s40, s40, 4096
    s_add_u32 s41, s41, 131072
    s_mov_b32 m0, s40
    s_nop 0
    buffer_load_dwordx4 v5, s[8:11], s41 offen lds
    s_add_u32 s40, s40, 4096
    s_add_u32 s41, s41, 131072
    s_mov_b32 m0, s40
    s_nop 0
    buffer_load_dwordx4 v5, s[8:11], s41 offen lds
    s_add_u32 s40, s40, 4096
    s_add_u32 s41, s41, 131072
    s_mov_b32 m0, s40
    s_nop 0
    buffer_load_dwordx4 v5, s[8:11], s41 offen lds
    s_add_u32 s40, s40, 4096
    s_add_u32 s41, s41, 131072
    s_mov_b32 m0, s40
    s_nop 0
    buffer_load_dwordx4 v5, s[8:11], s41 offen lds
    s_add_u32 s40, s40, 4096
    s_add_u32 s41, s41, 131072
    s_mov_b32 m0, s40
    s_nop 0
    buffer_load_dwordx4 v5, s[8:11], s41 offen lds
    s_add_u32 s40, s40, 4096
    s_add_u32 s41, s41, 131072
    s_mov_b32 m0, s40
    s_nop 0
    buffer_load_dwordx4 v5, s[8:11], s41 offen lds
    s_add_u32 s40, s40, 4096
    s_add_u32 s41, s41, 131072
    s_mov_b32 m0, s40
    s_nop 0
    buffer_load_dwordx4 v5, s[8:11], s41 offen lds
    s_add_u32 s40, s40, 4096
    s_add_u32 s41, s41, 131072
    s_mov_b32 m0, s40
    s_nop 0
    buffer_load_dwordx4 v5, s[8:11], s41 offen lds
    s_add_u32 s40, s40, 4096
    s_add_u32 s41, s41, 131072
    s_mov_b32 m0, s40
    s_nop 0
    buffer_load_dwordx4 v5, s[8:11], s41 offen lds
    s_add_u32 s40, s40, 4096
    s_add_u32 s41, s41, 131072
    s_mov_b32 m0, s40
    s_nop 0
    buffer_load_dwordx4 v5, s[8:11], s41 offen lds
    s_add_u32 s40, s40, 4096
    s_add_u32 s41, s41, 131072
    s_mov_b32 m0, s40
    s_nop 0
    buffer_load_dwordx4 v5, s[8:11], s41 offen lds
    s_add_u32 s40, s40, 4096
    s_add_u32 s41, s41, 131072
    s_mov_b32 m0, s40
    s_nop 0
    buffer_load_dwordx4 v5, s[8:11], s41 offen lds
    s_add_u32 s40, s40, 4096
    s_add_u32 s41, s41, 131072
    s_mov_b32 m0, s40
    s_nop 0
    buffer_load_dwordx4 v5, s[8:11], s41 offen lds
    v_lshrrev_b32 v48, 4, v1
    v_bfe_u32 v49, v1, 2, 2
    v_and_b32 v52, 3, v1
    v_lshrrev_b32 v50, 1, v52
    v_add_u32 v50, s47, v50
    v_and_b32 v51, 1, v52
    v_and_b32 v53, 1, v48
    v_lshl_or_b32 v53, v53, 2, v49
    v_lshlrev_b32 v53, 1, v53
    v_xor_b32 v50, v50, v53
    v_lshlrev_b32 v50, 4, v50
    v_lshl_add_u32 v50, v51, 3, v50
    v_lshl_add_u32 v50, v49, 8, v50
    v_lshl_add_u32 v6, v48, 11, v50
    v_lshrrev_b32 v48, 4, v1
    v_bfe_u32 v49, v1, 2, 2
    v_and_b32 v52, 3, v1
    v_lshrrev_b32 v50, 1, v52
    v_add_u32 v50, s48, v50
    v_and_b32 v51, 1, v52
    v_and_b32 v53, 1, v48
    v_lshl_or_b32 v53, v53, 2, v49
    v_lshlrev_b32 v53, 1, v53
    v_xor_b32 v50, v50, v53
    v_lshlrev_b32 v50, 4, v50
    v_lshl_add_u32 v50, v51, 3, v50
    v_lshl_add_u32 v50, v49, 8, v50
    v_lshl_add_u32 v7, v48, 11, v50
    v_add_u32 v54, 0x10000, v6
    v_add_u32 v55, 0x10000, v7
    v_add_u32 v56, 0x20000, v6
    v_add_u32 v57, 0x20000, v7
    s_waitcnt vmcnt(0)
    s_barrier
    ds_read_b64_tr_b16 a[0:1], v6 offset:0
    ds_read_b64_tr_b16 a[2:3], v6 offset:1024
    ds_read_b64_tr_b16 a[80:81], v7 offset:0
    ds_read_b64_tr_b16 a[82:83], v7 offset:1024
    ds_read_b64_tr_b16 a[4:5], v6 offset:8192
    ds_read_b64_tr_b16 a[6:7], v6 offset:9216
    ds_read_b64_tr_b16 a[84:85], v7 offset:8192
    ds_read_b64_tr_b16 a[86:87], v7 offset:9216
    ds_read_b64_tr_b16 a[8:9], v6 offset:16384
    ds_read_b64_tr_b16 a[10:11], v6 offset:17408
    ds_read_b64_tr_b16 a[88:89], v7 offset:16384
    ds_read_b64_tr_b16 a[90:91], v7 offset:17408
    ds_read_b64_tr_b16 a[12:13], v6 offset:24576
    ds_read_b64_tr_b16 a[14:15], v6 offset:25600
    ds_read_b64_tr_b16 a[92:93], v7 offset:24576
    ds_read_b64_tr_b16 a[94:95], v7 offset:25600
    s_waitcnt lgkmcnt(0)
    ds_read_b64_tr_b16 a[16:17], v6 offset:32768
    ds_read_b64_tr_b16 a[18:19], v6 offset:33792
    ds_read_b64_tr_b16 a[96:97], v7 offset:32768
    ds_read_b64_tr_b16 a[98:99], v7 offset:33792
    ds_read_b64_tr_b16 a[20:21], v6 offset:40960
    ds_read_b64_tr_b16 a[22:23], v6 offset:41984
    ds_read_b64_tr_b16 a[100:101], v7 offset:40960
    ds_read_b64_tr_b16 a[102:103], v7 offset:41984
    ds_read_b64_tr_b16 a[24:25], v6 offset:49152
    ds_read_b64_tr_b16 a[26:27], v6 offset:50176
    ds_read_b64_tr_b16 a[104:105], v7 offset:49152
    ds_read_b64_tr_b16 a[106:107], v7 offset:50176
    ds_read_b64_tr_b16 a[28:29], v6 offset:57344
    ds_read_b64_tr_b16 a[30:31], v6 offset:58368
    ds_read_b64_tr_b16 a[108:109], v7 offset:57344
    ds_read_b64_tr_b16 a[110:111], v7 offset:58368
    s_waitcnt lgkmcnt(0)
    ds_read_b64_tr_b16 a[32:33], v54 offset:0
    ds_read_b64_tr_b16 a[34:35], v54 offset:1024
    ds_read_b64_tr_b16 a[112:113], v55 offset:0
    ds_read_b64_tr_b16 a[114:115], v55 offset:1024
    ds_read_b64_tr_b16 a[36:37], v54 offset:8192
    ds_read_b64_tr_b16 a[38:39], v54 offset:9216
    ds_read_b64_tr_b16 a[116:117], v55 offset:8192
    ds_read_b64_tr_b16 a[118:119], v55 offset:9216
    ds_read_b64_tr_b16 a[40:41], v54 offset:16384
    ds_read_b64_tr_b16 a[42:43], v54 offset:17408
    ds_read_b64_tr_b16 a[120:121], v55 offset:16384
    ds_read_b64_tr_b16 a[122:123], v55 offset:17408
    ds_read_b64_tr_b16 a[44:45], v54 offset:24576
    ds_read_b64_tr_b16 a[46:47], v54 offset:25600
    ds_read_b64_tr_b16 a[124:125], v55 offset:24576
    ds_read_b64_tr_b16 a[126:127], v55 offset:25600
    s_waitcnt lgkmcnt(0)
    ds_read_b64_tr_b16 a[48:49], v54 offset:32768
    ds_read_b64_tr_b16 a[50:51], v54 offset:33792
    ds_read_b64_tr_b16 a[128:129], v55 offset:32768
    ds_read_b64_tr_b16 a[130:131], v55 offset:33792
    ds_read_b64_tr_b16 a[52:53], v54 offset:40960
    ds_read_b64_tr_b16 a[54:55], v54 offset:41984
    ds_read_b64_tr_b16 a[132:133], v55 offset:40960
    ds_read_b64_tr_b16 a[134:135], v55 offset:41984
    ds_read_b64_tr_b16 a[56:57], v54 offset:49152
    ds_read_b64_tr_b16 a[58:59], v54 offset:50176
    ds_read_b64_tr_b16 a[136:137], v55 offset:49152
    ds_read_b64_tr_b16 a[138:139], v55 offset:50176
    ds_read_b64_tr_b16 a[60:61], v54 offset:57344
    ds_read_b64_tr_b16 a[62:63], v54 offset:58368
    ds_read_b64_tr_b16 a[140:141], v55 offset:57344
    ds_read_b64_tr_b16 a[142:143], v55 offset:58368
    s_waitcnt lgkmcnt(0)
    ds_read_b64_tr_b16 a[64:65], v56 offset:0
    ds_read_b64_tr_b16 a[66:67], v56 offset:1024
    ds_read_b64_tr_b16 a[144:145], v57 offset:0
    ds_read_b64_tr_b16 a[146:147], v57 offset:1024
    ds_read_b64_tr_b16 a[68:69], v56 offset:8192
    ds_read_b64_tr_b16 a[70:71], v56 offset:9216
    ds_read_b64_tr_b16 a[148:149], v57 offset:8192
    ds_read_b64_tr_b16 a[150:151], v57 offset:9216
    ds_read_b64_tr_b16 a[72:73], v56 offset:16384
    ds_read_b64_tr_b16 a[74:75], v56 offset:17408
    ds_read_b64_tr_b16 a[152:153], v57 offset:16384
    ds_read_b64_tr_b16 a[154:155], v57 offset:17408
    ds_read_b64_tr_b16 a[76:77], v56 offset:24576
    ds_read_b64_tr_b16 a[78:79], v56 offset:25600
    ds_read_b64_tr_b16 a[156:157], v57 offset:24576
    ds_read_b64_tr_b16 a[158:159], v57 offset:25600
    s_waitcnt lgkmcnt(0)
    s_waitcnt lgkmcnt(0)
    s_barrier
    s_cmp_lg_u32 s28, 0
    s_cbranch_scc1 wd_49
    v_mov_b32 v48, 1
    v_mov_b32 v49, 128
    s_mov_b64 exec, 1
    buffer_atomic_add v48, v49, s[16:19], 0 offen sc1
    s_mov_b64 exec, -1
wd_49:
    v_lshlrev_b32 v2, 4, v1
    v_lshrrev_b32 v3, 4, v1
    v_lshlrev_b32 v3, 9, v3
    v_and_b32 v4, 15, v1
    v_lshl_add_u32 v3, v4, 4, v3
    v_and_b32 v59, 15, v1
    v_lshlrev_b32 v59, 6, v59
    v_lshrrev_b32 v48, 4, v1
    v_lshl_add_u32 v59, v48, 4, v59
    s_lshl_b32 s34, s28, 11
    v_add_u32 v59, s34, v59
    s_cmp_lg_u32 s28, 0
    s_cbranch_scc1 w0_50
    v_mov_b32 v49, 192
    v_mov_b32 v50, 1
    v_mov_b32 v51, 64
    v_cmp_eq_u32 vcc, 1, v1
    v_cndmask_b32 v49, v49, v51, vcc
    v_mov_b32 v51, 36
    v_cmp_eq_u32 vcc, 0, v1
    v_cndmask_b32 v49, v49, v51, vcc
    v_mov_b32 v51, 192
    v_cndmask_b32 v50, v50, v51, vcc
fw_51:
    buffer_load_dword v48, v49, s[16:19], 0 offen sc1
    s_waitcnt vmcnt(0)
    v_cmp_gt_u32 vcc, v50, v48
    s_sub_u32 s33, s33, 1
    s_cbranch_scc1 END
    s_cbranch_vccz fd_52
    s_sleep 2
    s_branch fw_51
fd_52:
w0_50:
    s_barrier
    s_mov_b32 s31, 0
    s_mov_b32 s50, 0
    s_mul_i32 s41, s31, 40960
    s_mul_i32 s34, s28, 10240
    s_add_u32 s41, s41, s34
    s_add_u32 s40, s50, s34
    s_mov_b32 m0, s40
    s_nop 0
    buffer_load_dwordx4 v2, s[4:7], s41 offen sc1 lds
    s_add_u32 s40, s40, 1024
    s_add_u32 s41, s41, 1024
    s_mov_b32 m0, s40
    s_nop 0
    buffer_load_dwordx4 v2, s[4:7], s41 offen sc1 lds
    s_add_u32 s40, s40, 1024
    s_add_u32 s41, s41, 1024
    s_mov_b32 m0, s40
    s_nop 0
    buffer_load_dwordx4 v2, s[4:7], s41 offen sc1 lds
    s_add_u32 s40, s40, 1024
    s_add_u32 s41, s41, 1024
    s_mov_b32 m0, s40
    s_nop 0
    buffer_load_dwordx4 v2, s[4:7], s41 offen sc1 lds
    s_add_u32 s40, s40, 1024
    s_add_u32 s41, s41, 1024
    s_mov_b32 m0, s40
    s_nop 0
    buffer_load_dwordx4 v2, s[4:7], s41 offen sc1 lds
    s_add_u32 s40, s40, 1024
    s_add_u32 s41, s41, 1024
    s_mov_b32 m0, s40
    s_nop 0
    buffer_load_dwordx4 v2, s[4:7], s41 offen sc1 lds
    s_add_u32 s40, s40, 1024
    s_add_u32 s41, s41, 1024
    s_mov_b32 m0, s40
    s_nop 0
    buffer_load_dwordx4 v2, s[4:7], s41 offen sc1 lds
    s_add_u32 s40, s40, 1024
    s_add_u32 s41, s41, 1024
    s_mov_b32 m0, s40
    s_nop 0
    buffer_load_dwordx4 v2, s[4:7], s41 offen sc1 lds
    s_add_u32 s40, s40, 1024
    s_add_u32 s41, s41, 1024
    s_mov_b32 m0, s40
    s_nop 0
    buffer_load_dwordx4 v2, s[4:7], s41 offen sc1 lds
    s_add_u32 s40, s40, 1024
    s_add_u32 s41, s41, 1024
    s_mov_b32 m0, s40
    s_nop 0
    buffer_load_dwordx4 v2, s[4:7], s41 offen sc1 lds
    s_waitcnt vmcnt(0)
    s_barrier
V_53:
    s_cmp_lg_u32 s31, 1
    s_cbranch_scc1 lnw_54
    s_cmp_lg_u32 s28, 0
    s_cbranch_scc1 w0_55
    v_and_b32 v49, 63, v1
    v_lshlrev_b32 v49, 7, v49
    v_add_u32 v49, 0x6460040, v49
fw_56:
    buffer_load_dword v48, v49, s[4:7], 0 offen sc1
    s_waitcnt vmcnt(0)
    v_cmp_gt_u32 vcc, s31, v48
    s_sub_u32 s33, s33, 1
    s_cbranch_scc1 END
    s_cbranch_vccz fd_57
    s_sleep 2
    s_branch fw_56
fd_57:
w0_55:
    s_barrier
lnw_54:
    s_add_u32 s51, s31, 1
    s_min_u32 s39, s51, 63
    s_xor_b32 s52, s50, 40960
    s_mul_i32 s41, s39, 40960
    s_mul_i32 s34, s28, 10240
    s_add_u32 s41, s41, s34
    s_add_u32 s40, s52, s34
    s_mov_b32 m0, s40
    s_nop 0
    buffer_load_dwordx4 v2, s[4:7], s41 offen sc1 lds
    s_add_u32 s40, s40, 1024
    s_add_u32 s41, s41, 1024
    s_mov_b32 m0, s40
    s_nop 0
    buffer_load_dwordx4 v2, s[4:7], s41 offen sc1 lds
    s_add_u32 s40, s40, 1024
    s_add_u32 s41, s41, 1024
    s_mov_b32 m0, s40
    s_nop 0
    buffer_load_dwordx4 v2, s[4:7], s41 offen sc1 lds
    s_add_u32 s40, s40, 1024
    s_add_u32 s41, s41, 1024
    s_mov_b32 m0, s40
    s_nop 0
    buffer_load_dwordx4 v2, s[4:7], s41 offen sc1 lds
    s_add_u32 s40, s40, 1024
    s_add_u32 s41, s41, 1024
    s_mov_b32 m0, s40
    s_nop 0
    buffer_load_dwordx4 v2, s[4:7], s41 offen sc1 lds
    s_add_u32 s40, s40, 1024
    s_add_u32 s41, s41, 1024
    s_mov_b32 m0, s40
    s_nop 0
    buffer_load_dwordx4 v2, s[4:7], s41 offen sc1 lds
    s_add_u32 s40, s40, 1024
    s_add_u32 s41, s41, 1024
    s_mov_b32 m0, s40
    s_nop 0
    buffer_load_dwordx4 v2, s[4:7], s41 offen sc1 lds
    s_add_u32 s40, s40, 1024
    s_add_u32 s41, s41, 1024
    s_mov_b32 m0, s40
    s_nop 0
    buffer_load_dwordx4 v2, s[4:7], s41 offen sc1 lds
    s_add_u32 s40, s40, 1024
    s_add_u32 s41, s41, 1024
    s_mov_b32 m0, s40
    s_nop 0
    buffer_load_dwordx4 v2, s[4:7], s41 offen sc1 lds
    s_add_u32 s40, s40, 1024
    s_add_u32 s41, s41, 1024
    s_mov_b32 m0, s40
    s_nop 0
    buffer_load_dwordx4 v2, s[4:7], s41 offen sc1 lds
    v_add_u32 v58, s50, v3
    ds_read_b128 v[24:27], v58 offset:0
    ds_read_b128 v[28:31], v58 offset:256
    ds_read_b128 v[32:35], v58 offset:2048
    ds_read_b128 v[36:39], v58 offset:2304
    ds_read_b128 v[40:43], v58 offset:4096
    ds_read_b128 v[44:47], v58 offset:4352
    s_waitcnt lgkmcnt(4)
    v_mfma_f32_16x16x32_bf16 v[8:11], v[24:27], a[0:3], 0
    v_mfma_f32_16x16x32_bf16 v[16:19], v[24:27], a[80:83], 0
    v_mfma_f32_16x16x32_bf16 v[12:15], v[28:31], a[0:3], 0
    v_mfma_f32_16x16x32_bf16 v[20:23], v[28:31], a[80:83], 0
    ds_read_b128 v[24:27], v58 offset:6144
    ds_read_b128 v[28:31], v58 offset:6400
    s_waitcnt lgkmcnt(4)
    v_mfma_f32_16x16x32_bf16 v[8:11], v[32:35], a[4:7], v[8:11]
    v_mfma_f32_16x16x32_bf16 v[16:19], v[32:35], a[84:87], v[16:19]
    v_mfma_f32_16x16x32_bf16 v[12:15], v[36:39], a[4:7], v[12:15]
    v_mfma_f32_16x16x32_bf16 v[20:23], v[36:39], a[84:87], v[20:23]
    ds_read_b128 v[32:35], v58 offset:8192
    ds_read_b128 v[36:39], v58 offset:8448
    s_waitcnt lgkmcnt(4)
    v_mfma_f32_16x16x32_bf16 v[8:11], v[40:43], a[8:11], v[8:11]
    v_mfma_f32_16x16x32_bf16 v[16:19], v[40:43], a[88:91], v[16:19]
    v_mfma_f32_16x16x32_bf16 v[12:15], v[44:47], a[8:11], v[12:15]
    v_mfma_f32_16x16x32_bf16 v[20:23], v[44:47], a[88:91], v[20:23]
    ds_read_b128 v[40:43], v58 offset:10240
    ds_read_b128 v[44:47], v58 offset:10496
    s_waitcnt lgkmcnt(4)
    v_mfma_f32_16x16x32_bf16 v[8:11], v[24:27], a[12:15], v[8:11]
    v_mfma_f32_16x16x32_bf16 v[16:19], v[24:27], a[92:95], v[16:19]
    v_mfma_f32_16x16x32_bf16 v[12:15], v[28:31], a[12:15], v[12:15]
    v_mfma_f32_16x16x32_bf16 v[20:23], v[28:31], a[92:95], v[20:23]
    ds_read_b128 v[24:27], v58 offset:12288
    ds_read_b128 v[28:31], v58 offset:12544
    s_waitcnt lgkmcnt(4)
    v_mfma_f32_16x16x32_bf16 v[8:11], v[32:35], a[16:19], v[8:11]
    v_mfma_f32_16x16x32_bf16 v[16:19], v[32:35], a[96:99], v[16:19]
    v_mfma_f32_16x16x32_bf16 v[12:15], v[36:39], a[16:19], v[12:15]
    v_mfma_f32_16x16x32_bf16 v[20:23], v[36:39], a[96:99], v[20:23]
    ds_read_b128 v[32:35], v58 offset:14336
    ds_read_b128 v[36:39], v58 offset:14592
    s_waitcnt lgkmcnt(4)
    v_mfma_f32_16x16x32_bf16 v[8:11], v[40:43], a[20:23], v[8:11]
    v_mfma_f32_16x16x32_bf16 v[16:19], v[40:43], a[100:103], v[16:19]
    v_mfma_f32_16x16x32_bf16 v[12:15], v[44:47], a[20:23], v[12:15]
    v_mfma_f32_16x16x32_bf16 v[20:23], v[44:47], a[100:103], v[20:23]
    ds_read_b128 v[40:43], v58 offset:16384
    ds_read_b128 v[44:47], v58 offset:16640
    s_waitcnt lgkmcnt(4)
    v_mfma_f32_16x16x32_bf16 v[8:11], v[24:27], a[24:27], v[8:11]
    v_mfma_f32_16x16x32_bf16 v[16:19], v[24:27], a[104:107], v[16:19]
    v_mfma_f32_16x16x32_bf16 v[12:15], v[28:31], a[24:27], v[12:15]
    v_mfma_f32_16x16x32_bf16 v[20:23], v[28:31], a[104:107], v[20:23]
    ds_read_b128 v[24:27], v58 offset:18432
    ds_read_b128 v[28:31], v58 offset:18688
    s_waitcnt lgkmcnt(4)
    v_mfma_f32_16x16x32_bf16 v[8:11], v[32:35], a[28:31], v[8:11]
    v_mfma_f32_16x16x32_bf16 v[16:19], v[32:35], a[108:111], v[16:19]
    v_mfma_f32_16x16x32_bf16 v[12:15], v[36:39], a[28:31], v[12:15]
    v_mfma_f32_16x16x32_bf16 v[20:23], v[36:39], a[108:111], v[20:23]
    ds_read_b128 v[32:35], v58 offset:20480
    ds_read_b128 v[36:39], v58 offset:20736
    s_waitcnt lgkmcnt(4)
    v_mfma_f32_16x16x32_bf16 v[8:11], v[40:43], a[32:35], v[8:11]
    v_mfma_f32_16x16x32_bf16 v[16:19], v[40:43], a[112:115], v[16:19]
    v_mfma_f32_16x16x32_bf16 v[12:15], v[44:47], a[32:35], v[12:15]
    v_mfma_f32_16x16x32_bf16 v[20:23], v[44:47], a[112:115], v[20:23]
    ds_read_b128 v[40:43], v58 offset:22528
    ds_read_b128 v[44:47], v58 offset:22784
    s_waitcnt lgkmcnt(4)
    v_mfma_f32_16x16x32_bf16 v[8:11], v[24:27], a[36:39], v[8:11]
    v_mfma_f32_16x16x32_bf16 v[16:19], v[24:27], a[116:119], v[16:19]
    v_mfma_f32_16x16x32_bf16 v[12:15], v[28:31], a[36:39], v[12:15]
    v_mfma_f32_16x16x32_bf16 v[20:23], v[28:31], a[116:119], v[20:23]
    ds_read_b128 v[24:27], v58 offset:24576
    ds_read_b128 v[28:31], v58 offset:24832
    s_waitcnt lgkmcnt(4)
    v_mfma_f32_16x16x32_bf16 v[8:11], v[32:35], a[40:43], v[8:11]
    v_mfma_f32_16x16x32_bf16 v[16:19], v[32:35], a[120:123], v[16:19]
    v_mfma_f32_16x16x32_bf16 v[12:15], v[36:39], a[40:43], v[12:15]
    v_mfma_f32_16x16x32_bf16 v[20:23], v[36:39], a[120:123], v[20:23]
    ds_read_b128 v[32:35], v58 offset:26624
    ds_read_b128 v[36:39], v58 offset:26880
    s_waitcnt lgkmcnt(4)
    v_mfma_f32_16x16x32_bf16 v[8:11], v[40:43], a[44:47], v[8:11]
    v_mfma_f32_16x16x32_bf16 v[16:19], v[40:43], a[124:127], v[16:19]
    v_mfma_f32_16x16x32_bf16 v[12:15], v[44:47], a[44:47], v[12:15]
    v_mfma_f32_16x16x32_bf16 v[20:23], v[44:47], a[124:127], v[20:23]
    ds_read_b128 v[40:43], v58 offset:28672
    ds_read_b128 v[44:47], v58 offset:28928
    s_waitcnt lgkmcnt(4)
    v_mfma_f32_16x16x32_bf16 v[8:11], v[24:27], a[48:51], v[8:11]
    v_mfma_f32_16x16x32_bf16 v[16:19], v[24:27], a[128:131], v[16:19]
    v_mfma_f32_16x16x32_bf16 v[12:15], v[28:31], a[48:51], v[12:15]
    v_mfma_f32_16x16x32_bf16 v[20:23], v[28:31], a[128:131], v[20:23]
    ds_read_b128 v[24:27], v58 offset:30720
    ds_read_b128 v[28:31], v58 offset:30976
    s_waitcnt lgkmcnt(4)
    v_mfma_f32_16x16x32_bf16 v[8:11], v[32:35], a[52:55], v[8:11]
    v_mfma_f32_16x16x32_bf16 v[16:19], v[32:35], a[132:135], v[16:19]
    v_mfma_f32_16x16x32_bf16 v[12:15], v[36:39], a[52:55], v[12:15]
    v_mfma_f32_16x16x32_bf16 v[20:23], v[36:39], a[132:135], v[20:23]
    ds_read_b128 v[32:35], v58 offset:32768
    ds_read_b128 v[36:39], v58 offset:33024
    s_waitcnt lgkmcnt(4)
    v_mfma_f32_16x16x32_bf16 v[8:11], v[40:43], a[56:59], v[8:11]
    v_mfma_f32_16x16x32_bf16 v[16:19], v[40:43], a[136:139], v[16:19]
    v_mfma_f32_16x16x32_bf16 v[12:15], v[44:47], a[56:59], v[12:15]
    v_mfma_f32_16x16x32_bf16 v[20:23], v[44:47], a[136:139], v[20:23]
    ds_read_b128 v[40:43], v58 offset:34816
    ds_read_b128 v[44:47], v58 offset:35072
    s_waitcnt lgkmcnt(4)
    v_mfma_f32_16x16x32_bf16 v[8:11], v[24:27], a[60:63], v[8:11]
    v_mfma_f32_16x16x32_bf16 v[16:19], v[24:27], a[140:143], v[16:19]
    v_mfma_f32_16x16x32_bf16 v[12:15], v[28:31], a[60:63], v[12:15]
    v_mfma_f32_16x16x32_bf16 v[20:23], v[28:31], a[140:143], v[20:23]
    ds_read_b128 v[24:27], v58 offset:36864
    ds_read_b128 v[28:31], v58 offset:37120
    s_waitcnt lgkmcnt(4)
    v_mfma_f32_16x16x32_bf16 v[8:11], v[32:35], a[64:67], v[8:11]
    v_mfma_f32_16x16x32_bf16 v[16:19], v[32:35], a[144:147], v[16:19]
    v_mfma_f32_16x16x32_bf16 v[12:15], v[36:39], a[64:67], v[12:15]
    v_mfma_f32_16x16x32_bf16 v[20:23], v[36:39], a[144:147], v[20:23]
    ds_read_b128 v[32:35], v58 offset:38912
    ds_read_b128 v[36:39], v58 offset:39168
    s_waitcnt lgkmcnt(4)
    v_mfma_f32_16x16x32_bf16 v[8:11], v[40:43], a[68:71], v[8:11]
    v_mfma_f32_16x16x32_bf16 v[16:19], v[40:43], a[148:151], v[16:19]
    v_mfma_f32_16x16x32_bf16 v[12:15], v[44:47], a[68:71], v[12:15]
    v_mfma_f32_16x16x32_bf16 v[20:23], v[44:47], a[148:151], v[20:23]
    s_waitcnt lgkmcnt(2)
    v_mfma_f32_16x16x32_bf16 v[8:11], v[24:27], a[72:75], v[8:11]
    v_mfma_f32_16x16x32_bf16 v[16:19], v[24:27], a[152:155], v[16:19]
    v_mfma_f32_16x16x32_bf16 v[12:15], v[28:31], a[72:75], v[12:15]
    v_mfma_f32_16x16x32_bf16 v[20:23], v[28:31], a[152:155], v[20:23]
    s_waitcnt lgkmcnt(0)
    v_mfma_f32_16x16x32_bf16 v[8:11], v[32:35], a[76:79], v[8:11]
    v_mfma_f32_16x16x32_bf16 v[16:19], v[32:35], a[156:159], v[16:19]
    v_mfma_f32_16x16x32_bf16 v[12:15], v[36:39], a[76:79], v[12:15]
    v_mfma_f32_16x16x32_bf16 v[20:23], v[36:39], a[156:159], v[20:23]
    s_lshl_b32 s48, s31, 18
    s_lshl_b32 s49, s42, 13
    s_add_u32 s48, s48, s49
    s_add_u32 s48, s48, 0x1400000
    s_nop 7
    v_cvt_pk_bf16_f32 v48, v8, v9
    v_cvt_pk_bf16_f32 v49, v10, v11
    v_cvt_pk_bf16_f32 v50, v12, v13
    v_cvt_pk_bf16_f32 v51, v14, v15
    buffer_store_dwordx4 v[48:51], v59, s[4:7], s48 offen offset:0 sc1
    v_cvt_pk_bf16_f32 v52, v16, v17
    v_cvt_pk_bf16_f32 v53, v18, v19
    v_cvt_pk_bf16_f32 v54, v20, v21
    v_cvt_pk_bf16_f32 v55, v22, v23
    buffer_store_dwordx4 v[52:55], v59, s[4:7], s48 offen offset:1024 sc1
    s_waitcnt vmcnt(0)
    s_barrier
    s_cmp_lg_u32 s28, 0
    s_cbranch_scc1 fp_58
    s_lshl_b32 s34, s29, 7
    s_add_u32 s34, s34, 0x6460000
    v_mov_b32 v48, s51
    v_mov_b32 v49, 0
    s_mov_b64 exec, 1
    buffer_store_dword v48, v49, s[4:7], s34 offen sc1
    s_mov_b64 exec, -1
fp_58:
    s_mov_b32 s31, s51
    s_mov_b32 s50, s52
    s_cmp_lt_u32 s31, 64
    s_cbranch_scc1 V_53
    s_branch END
ROLE_QA:
    s_sub_u32 s42, s29, 128
    s_load_dwordx2 s[20:21], s[0:1], 0
    s_mov_b32 s22, 0x280000
    s_mov_b32 s23, 0x20000
    s_load_dwordx2 s[8:9], s[0:1], 16
    s_mov_b32 s10, 0x500000
    s_mov_b32 s11, 0x20000
    s_waitcnt lgkmcnt(0)
    v_lshrrev_b32 v2, 3, v0
    v_and_b32 v3, 7, v0
    v_bfe_u32 v4, v2, 2, 2
    v_lshlrev_b32 v4, 3, v4
    v_lshrrev_b32 v5, 4, v2
    v_lshl_add_u32 v4, v5, 2, v4
    v_and_b32 v5, 3, v2
    v_add_u32 v4, v4, v5
    s_mul_i32 s35, s42, 40960
    s_mov_b32 s34, 1280
    v_mul_lo_u32 v4, v4, s34
    v_lshl_add_u32 v4, v3, 4, v4
    buffer_load_dwordx4 v[8:11], v4, s[20:23], s35 offen offset:0
    buffer_load_dwordx4 v[12:15], v4, s[20:23], s35 offen offset:128
    buffer_load_dwordx4 v[16:19], v4, s[20:23], s35 offen offset:256
    buffer_load_dwordx4 v[20:23], v4, s[20:23], s35 offen offset:384
    buffer_load_dwordx4 v[24:27], v4, s[20:23], s35 offen offset:512
    buffer_load_dwordx4 v[28:31], v4, s[20:23], s35 offen offset:640
    buffer_load_dwordx4 v[32:35], v4, s[20:23], s35 offen offset:768
    buffer_load_dwordx4 v[36:39], v4, s[20:23], s35 offen offset:896
    buffer_load_dwordx4 v[40:43], v4, s[20:23], s35 offen offset:1024
    buffer_load_dwordx4 v[44:47], v4, s[20:23], s35 offen offset:1152
    v_lshlrev_b32 v5, 9, v3
    v_lshl_add_u32 v5, v2, 4, v5
    s_add_u32 s35, s35, 0x0
    s_waitcnt vmcnt(0)
    v_and_b32 v49, 0xffff0000, v8
    v_lshlrev_b32 v48, 16, v8
    v_and_b32 v51, 0xffff0000, v9
    v_lshlrev_b32 v50, 16, v9
    v_and_b32 v53, 0xffff0000, v10
    v_lshlrev_b32 v52, 16, v10
    v_and_b32 v55, 0xffff0000, v11
    v_lshlrev_b32 v54, 16, v11
    v_and_b32 v57, 0xffff0000, v12
    v_lshlrev_b32 v56, 16, v12
    v_and_b32 v59, 0xffff0000, v13
    v_lshlrev_b32 v58, 16, v13
    v_and_b32 v61, 0xffff0000, v14
    v_lshlrev_b32 v60, 16, v14
    v_and_b32 v63, 0xffff0000, v15
    v_lshlrev_b32 v62, 16, v15
    v_and_b32 v65, 0xffff0000, v16
    v_lshlrev_b32 v64, 16, v16
    v_and_b32 v67, 0xffff0000, v17
    v_lshlrev_b32 v66, 16, v17
    v_and_b32 v69, 0xffff0000, v18
    v_lshlrev_b32 v68, 16, v18
    v_and_b32 v71, 0xffff0000, v19
    v_lshlrev_b32 v70, 16, v19
    v_and_b32 v73, 0xffff0000, v20
    v_lshlrev_b32 v72, 16, v20
    v_and_b32 v75, 0xffff0000, v21
    v_lshlrev_b32 v74, 16, v21
    v_and_b32 v77, 0xffff0000, v22
    v_lshlrev_b32 v76, 16, v22
    v_and_b32 v79, 0xffff0000, v23
    v_lshlrev_b32 v78, 16, v23
    v_and_b32 v81, 0xffff0000, v24
    v_lshlrev_b32 v80, 16, v24
    v_and_b32 v83, 0xffff0000, v25
    v_lshlrev_b32 v82, 16, v25
    v_and_b32 v85, 0xffff0000, v26
    v_lshlrev_b32 v84, 16, v26
    v_and_b32 v87, 0xffff0000, v27
    v_lshlrev_b32 v86, 16, v27
    v_and_b32 v89, 0xffff0000, v28
    v_lshlrev_b32 v88, 16, v28
    v_and_b32 v91, 0xffff0000, v29
    v_lshlrev_b32 v90, 16, v29
    v_and_b32 v93, 0xffff0000, v30
    v_lshlrev_b32 v92, 16, v30
    v_and_b32 v95, 0xffff0000, v31
    v_lshlrev_b32 v94, 16, v31
    v_and_b32 v97, 0xffff0000, v32
    v_lshlrev_b32 v96, 16, v32
    v_and_b32 v99, 0xffff0000, v33
    v_lshlrev_b32 v98, 16, v33
    v_and_b32 v101, 0xffff0000, v34
    v_lshlrev_b32 v100, 16, v34
    v_and_b32 v103, 0xffff0000, v35
    v_lshlrev_b32 v102, 16, v35
    v_and_b32 v105, 0xffff0000, v36
    v_lshlrev_b32 v104, 16, v36
    v_and_b32 v107, 0xffff0000, v37
    v_lshlrev_b32 v106, 16, v37
    v_and_b32 v109, 0xffff0000, v38
    v_lshlrev_b32 v108, 16, v38
    v_and_b32 v111, 0xffff0000, v39
    v_lshlrev_b32 v110, 16, v39
    v_and_b32 v113, 0xffff0000, v40
    v_lshlrev_b32 v112, 16, v40
    v_and_b32 v115, 0xffff0000, v41
    v_lshlrev_b32 v114, 16, v41
    v_and_b32 v117, 0xffff0000, v42
    v_lshlrev_b32 v116, 16, v42
    v_and_b32 v119, 0xffff0000, v43
    v_lshlrev_b32 v118, 16, v43
    v_and_b32 v121, 0xffff0000, v44
    v_lshlrev_b32 v120, 16, v44
    v_and_b32 v123, 0xffff0000, v45
    v_lshlrev_b32 v122, 16, v45
    v_and_b32 v125, 0xffff0000, v46
    v_lshlrev_b32 v124, 16, v46
    v_and_b32 v127, 0xffff0000, v47
    v_lshlrev_b32 v126, 16, v47
    v_add_f32 v128, v48, v52
    v_add_f32 v129, v49, v53
    v_add_f32 v130, v50, v54
    v_add_f32 v131, v51, v55
    v_add_f32 v128, v128, v56
    v_add_f32 v129, v129, v57
    v_add_f32 v130, v130, v58
    v_add_f32 v131, v131, v59
    v_add_f32 v128, v128, v60
    v_add_f32 v129, v129, v61
    v_add_f32 v130, v130, v62
    v_add_f32 v131, v131, v63
    v_add_f32 v128, v128, v64
    v_add_f32 v129, v129, v65
    v_add_f32 v130, v130, v66
    v_add_f32 v131, v131, v67
    v_add_f32 v128, v128, v68
    v_add_f32 v129, v129, v69
    v_add_f32 v130, v130, v70
    v_add_f32 v131, v131, v71
    v_add_f32 v128, v128, v72
    v_add_f32 v129, v129, v73
    v_add_f32 v130, v130, v74
    v_add_f32 v131, v131, v75
    v_add_f32 v128, v128, v76
    v_add_f32 v129, v129, v77
    v_add_f32 v130, v130, v78
    v_add_f32 v131, v131, v79
    v_add_f32 v128, v128, v80
    v_add_f32 v129, v129, v81
    v_add_f32 v130, v130, v82
    v_add_f32 v131, v131, v83
    v_add_f32 v128, v128, v84
    v_add_f32 v129, v129, v85
    v_add_f32 v130, v130, v86
    v_add_f32 v131, v131, v87
    v_add_f32 v128, v128, v88
    v_add_f32 v129, v129, v89
    v_add_f32 v130, v130, v90
    v_add_f32 v131, v131, v91
    v_add_f32 v128, v128, v92
    v_add_f32 v129, v129, v93
    v_add_f32 v130, v130, v94
    v_add_f32 v131, v131, v95
    v_add_f32 v128, v128, v96
    v_add_f32 v129, v129, v97
    v_add_f32 v130, v130, v98
    v_add_f32 v131, v131, v99
    v_add_f32 v128, v128, v100
    v_add_f32 v129, v129, v101
    v_add_f32 v130, v130, v102
    v_add_f32 v131, v131, v103
    v_add_f32 v128, v128, v104
    v_add_f32 v129, v129, v105
    v_add_f32 v130, v130, v106
    v_add_f32 v131, v131, v107
    v_add_f32 v128, v128, v108
    v_add_f32 v129, v129, v109
    v_add_f32 v130, v130, v110
    v_add_f32 v131, v131, v111
    v_add_f32 v128, v128, v112
    v_add_f32 v129, v129, v113
    v_add_f32 v130, v130, v114
    v_add_f32 v131, v131, v115
    v_add_f32 v128, v128, v116
    v_add_f32 v129, v129, v117
    v_add_f32 v130, v130, v118
    v_add_f32 v131, v131, v119
    v_add_f32 v128, v128, v120
    v_add_f32 v129, v129, v121
    v_add_f32 v130, v130, v122
    v_add_f32 v131, v131, v123
    v_add_f32 v128, v128, v124
    v_add_f32 v129, v129, v125
    v_add_f32 v130, v130, v126
    v_add_f32 v131, v131, v127
    v_add_f32 v128, v128, v129
    v_add_f32 v130, v130, v131
    v_add_f32 v128, v128, v130
    s_nop 1
    v_add_f32_dpp v128, v128, v128 quad_perm:[1,0,3,2] row_mask:0xf bank_mask:0xf
    s_nop 1
    v_add_f32_dpp v128, v128, v128 quad_perm:[2,3,0,1] row_mask:0xf bank_mask:0xf
    s_nop 1
    v_add_f32_dpp v128, v128, v128 row_half_mirror row_mask:0xf bank_mask:0xf
    s_nop 1
    s_mov_b32 s36, 0x3acccccd
    v_mul_f32 v128, s36, v128
    v_sub_f32 v133, v48, v128
    v_mul_f32 v129, v133, v133
    v_sub_f32 v133, v49, v128
    v_mul_f32 v130, v133, v133
    v_sub_f32 v133, v50, v128
    v_mul_f32 v131, v133, v133
    v_sub_f32 v133, v51, v128
    v_mul_f32 v132, v133, v133
    v_sub_f32 v133, v52, v128
    v_fmac_f32 v129, v133, v133
    v_sub_f32 v133, v53, v128
    v_fmac_f32 v130, v133, v133
    v_sub_f32 v133, v54, v128
    v_fmac_f32 v131, v133, v133
    v_sub_f32 v133, v55, v128
    v_fmac_f32 v132, v133, v133
    v_sub_f32 v133, v56, v128
    v_fmac_f32 v129, v133, v133
    v_sub_f32 v133, v57, v128
    v_fmac_f32 v130, v133, v133
    v_sub_f32 v133, v58, v128
    v_fmac_f32 v131, v133, v133
    v_sub_f32 v133, v59, v128
    v_fmac_f32 v132, v133, v133
    v_sub_f32 v133, v60, v128
    v_fmac_f32 v129, v133, v133
    v_sub_f32 v133, v61, v128
    v_fmac_f32 v130, v133, v133
    v_sub_f32 v133, v62, v128
    v_fmac_f32 v131, v133, v133
    v_sub_f32 v133, v63, v128
    v_fmac_f32 v132, v133, v133
    v_sub_f32 v133, v64, v128
    v_fmac_f32 v129, v133, v133
    v_sub_f32 v133, v65, v128
    v_fmac_f32 v130, v133, v133
    v_sub_f32 v133, v66, v128
    v_fmac_f32 v131, v133, v133
    v_sub_f32 v133, v67, v128
    v_fmac_f32 v132, v133, v133
    v_sub_f32 v133, v68, v128
    v_fmac_f32 v129, v133, v133
    v_sub_f32 v133, v69, v128
    v_fmac_f32 v130, v133, v133
    v_sub_f32 v133, v70, v128
    v_fmac_f32 v131, v133, v133
    v_sub_f32 v133, v71, v128
    v_fmac_f32 v132, v133, v133
    v_sub_f32 v133, v72, v128
    v_fmac_f32 v129, v133, v133
    v_sub_f32 v133, v73, v128
    v_fmac_f32 v130, v133, v133
    v_sub_f32 v133, v74, v128
    v_fmac_f32 v131, v133, v133
    v_sub_f32 v133, v75, v128
    v_fmac_f32 v132, v133, v133
    v_sub_f32 v133, v76, v128
    v_fmac_f32 v129, v133, v133
    v_sub_f32 v133, v77, v128
    v_fmac_f32 v130, v133, v133
    v_sub_f32 v133, v78, v128
    v_fmac_f32 v131, v133, v133
    v_sub_f32 v133, v79, v128
    v_fmac_f32 v132, v133, v133
    v_sub_f32 v133, v80, v128
    v_fmac_f32 v129, v133, v133
    v_sub_f32 v133, v81, v128
    v_fmac_f32 v130, v133, v133
    v_sub_f32 v133, v82, v128
    v_fmac_f32 v131, v133, v133
    v_sub_f32 v133, v83, v128
    v_fmac_f32 v132, v133, v133
    v_sub_f32 v133, v84, v128
    v_fmac_f32 v129, v133, v133
    v_sub_f32 v133, v85, v128
    v_fmac_f32 v130, v133, v133
    v_sub_f32 v133, v86, v128
    v_fmac_f32 v131, v133, v133
    v_sub_f32 v133, v87, v128
    v_fmac_f32 v132, v133, v133
    v_sub_f32 v133, v88, v128
    v_fmac_f32 v129, v133, v133
    v_sub_f32 v133, v89, v128
    v_fmac_f32 v130, v133, v133
    v_sub_f32 v133, v90, v128
    v_fmac_f32 v131, v133, v133
    v_sub_f32 v133, v91, v128
    v_fmac_f32 v132, v133, v133
    v_sub_f32 v133, v92, v128
    v_fmac_f32 v129, v133, v133
    v_sub_f32 v133, v93, v128
    v_fmac_f32 v130, v133, v133
    v_sub_f32 v133, v94, v128
    v_fmac_f32 v131, v133, v133
    v_sub_f32 v133, v95, v128
    v_fmac_f32 v132, v133, v133
    v_sub_f32 v133, v96, v128
    v_fmac_f32 v129, v133, v133
    v_sub_f32 v133, v97, v128
    v_fmac_f32 v130, v133, v133
    v_sub_f32 v133, v98, v128
    v_fmac_f32 v131, v133, v133
    v_sub_f32 v133, v99, v128
    v_fmac_f32 v132, v133, v133
    v_sub_f32 v133, v100, v128
    v_fmac_f32 v129, v133, v133
    v_sub_f32 v133, v101, v128
    v_fmac_f32 v130, v133, v133
    v_sub_f32 v133, v102, v128
    v_fmac_f32 v131, v133, v133
    v_sub_f32 v133, v103, v128
    v_fmac_f32 v132, v133, v133
    v_sub_f32 v133, v104, v128
    v_fmac_f32 v129, v133, v133
    v_sub_f32 v133, v105, v128
    v_fmac_f32 v130, v133, v133
    v_sub_f32 v133, v106, v128
    v_fmac_f32 v131, v133, v133
    v_sub_f32 v133, v107, v128
    v_fmac_f32 v132, v133, v133
    v_sub_f32 v133, v108, v128
    v_fmac_f32 v129, v133, v133
    v_sub_f32 v133, v109, v128
    v_fmac_f32 v130, v133, v133
    v_sub_f32 v133, v110, v128
    v_fmac_f32 v131, v133, v133
    v_sub_f32 v133, v111, v128
    v_fmac_f32 v132, v133, v133
    v_sub_f32 v133, v112, v128
    v_fmac_f32 v129, v133, v133
    v_sub_f32 v133, v113, v128
    v_fmac_f32 v130, v133, v133
    v_sub_f32 v133, v114, v128
    v_fmac_f32 v131, v133, v133
    v_sub_f32 v133, v115, v128
    v_fmac_f32 v132, v133, v133
    v_sub_f32 v133, v116, v128
    v_fmac_f32 v129, v133, v133
    v_sub_f32 v133, v117, v128
    v_fmac_f32 v130, v133, v133
    v_sub_f32 v133, v118, v128
    v_fmac_f32 v131, v133, v133
    v_sub_f32 v133, v119, v128
    v_fmac_f32 v132, v133, v133
    v_sub_f32 v133, v120, v128
    v_fmac_f32 v129, v133, v133
    v_sub_f32 v133, v121, v128
    v_fmac_f32 v130, v133, v133
    v_sub_f32 v133, v122, v128
    v_fmac_f32 v131, v133, v133
    v_sub_f32 v133, v123, v128
    v_fmac_f32 v132, v133, v133
    v_sub_f32 v133, v124, v128
    v_fmac_f32 v129, v133, v133
    v_sub_f32 v133, v125, v128
    v_fmac_f32 v130, v133, v133
    v_sub_f32 v133, v126, v128
    v_fmac_f32 v131, v133, v133
    v_sub_f32 v133, v127, v128
    v_fmac_f32 v132, v133, v133
    v_add_f32 v129, v129, v130
    v_add_f32 v131, v131, v132
    v_add_f32 v129, v129, v131
    s_nop 1
    v_add_f32_dpp v129, v129, v129 quad_perm:[1,0,3,2] row_mask:0xf bank_mask:0xf
    s_nop 1
    v_add_f32_dpp v129, v129, v129 quad_perm:[2,3,0,1] row_mask:0xf bank_mask:0xf
    s_nop 1
    v_add_f32_dpp v129, v129, v129 row_half_mirror row_mask:0xf bank_mask:0xf
    s_nop 1
    v_mul_f32 v129, s36, v129
    v_cvt_pk_bf16_f32 v130, v128, v129
    v_and_b32 v129, 0xffff0000, v130
    v_lshlrev_b32 v128, 16, v130
    v_add_f32 v129, 0x3727c5ac, v129
    v_cvt_pk_bf16_f32 v129, v129, v129
    v_lshlrev_b32 v129, 16, v129
    v_sqrt_f32 v129, v129
    s_nop 0
    v_cvt_pk_bf16_f32 v129, v129, v129
    v_lshlrev_b32 v129, 16, v129
    v_rcp_f32 v129, v129
    s_nop 0
    v_sub_f32 v48, v48, v128
    v_sub_f32 v49, v49, v128
    v_cvt_pk_bf16_f32 v131, v48, v49
    v_and_b32 v49, 0xffff0000, v131
    v_lshlrev_b32 v48, 16, v131
    v_mul_f32 v48, v48, v129
    v_mul_f32 v49, v49, v129
    v_cvt_pk_bf16_f32 v8, v48, v49
    v_sub_f32 v50, v50, v128
    v_sub_f32 v51, v51, v128
    v_cvt_pk_bf16_f32 v131, v50, v51
    v_and_b32 v51, 0xffff0000, v131
    v_lshlrev_b32 v50, 16, v131
    v_mul_f32 v50, v50, v129
    v_mul_f32 v51, v51, v129
    v_cvt_pk_bf16_f32 v9, v50, v51
    v_sub_f32 v52, v52, v128
    v_sub_f32 v53, v53, v128
    v_cvt_pk_bf16_f32 v131, v52, v53
    v_and_b32 v53, 0xffff0000, v131
    v_lshlrev_b32 v52, 16, v131
    v_mul_f32 v52, v52, v129
    v_mul_f32 v53, v53, v129
    v_cvt_pk_bf16_f32 v10, v52, v53
    v_sub_f32 v54, v54, v128
    v_sub_f32 v55, v55, v128
    v_cvt_pk_bf16_f32 v131, v54, v55
    v_and_b32 v55, 0xffff0000, v131
    v_lshlrev_b32 v54, 16, v131
    v_mul_f32 v54, v54, v129
    v_mul_f32 v55, v55, v129
    v_cvt_pk_bf16_f32 v11, v54, v55
    v_sub_f32 v56, v56, v128
    v_sub_f32 v57, v57, v128
    v_cvt_pk_bf16_f32 v131, v56, v57
    v_and_b32 v57, 0xffff0000, v131
    v_lshlrev_b32 v56, 16, v131
    v_mul_f32 v56, v56, v129
    v_mul_f32 v57, v57, v129
    v_cvt_pk_bf16_f32 v12, v56, v57
    v_sub_f32 v58, v58, v128
    v_sub_f32 v59, v59, v128
    v_cvt_pk_bf16_f32 v131, v58, v59
    v_and_b32 v59, 0xffff0000, v131
    v_lshlrev_b32 v58, 16, v131
    v_mul_f32 v58, v58, v129
    v_mul_f32 v59, v59, v129
    v_cvt_pk_bf16_f32 v13, v58, v59
    v_sub_f32 v60, v60, v128
    v_sub_f32 v61, v61, v128
    v_cvt_pk_bf16_f32 v131, v60, v61
    v_and_b32 v61, 0xffff0000, v131
    v_lshlrev_b32 v60, 16, v131
    v_mul_f32 v60, v60, v129
    v_mul_f32 v61, v61, v129
    v_cvt_pk_bf16_f32 v14, v60, v61
    v_sub_f32 v62, v62, v128
    v_sub_f32 v63, v63, v128
    v_cvt_pk_bf16_f32 v131, v62, v63
    v_and_b32 v63, 0xffff0000, v131
    v_lshlrev_b32 v62, 16, v131
    v_mul_f32 v62, v62, v129
    v_mul_f32 v63, v63, v129
    v_cvt_pk_bf16_f32 v15, v62, v63
    v_sub_f32 v64, v64, v128
    v_sub_f32 v65, v65, v128
    v_cvt_pk_bf16_f32 v131, v64, v65
    v_and_b32 v65, 0xffff0000, v131
    v_lshlrev_b32 v64, 16, v131
    v_mul_f32 v64, v64, v129
    v_mul_f32 v65, v65, v129
    v_cvt_pk_bf16_f32 v16, v64, v65
    v_sub_f32 v66, v66, v128
    v_sub_f32 v67, v67, v128
    v_cvt_pk_bf16_f32 v131, v66, v67
    v_and_b32 v67, 0xffff0000, v131
    v_lshlrev_b32 v66, 16, v131
    v_mul_f32 v66, v66, v129
    v_mul_f32 v67, v67, v129
    v_cvt_pk_bf16_f32 v17, v66, v67
    v_sub_f32 v68, v68, v128
    v_sub_f32 v69, v69, v128
    v_cvt_pk_bf16_f32 v131, v68, v69
    v_and_b32 v69, 0xffff0000, v131
    v_lshlrev_b32 v68, 16, v131
    v_mul_f32 v68, v68, v129
    v_mul_f32 v69, v69, v129
    v_cvt_pk_bf16_f32 v18, v68, v69
    v_sub_f32 v70, v70, v128
    v_sub_f32 v71, v71, v128
    v_cvt_pk_bf16_f32 v131, v70, v71
    v_and_b32 v71, 0xffff0000, v131
    v_lshlrev_b32 v70, 16, v131
    v_mul_f32 v70, v70, v129
    v_mul_f32 v71, v71, v129
    v_cvt_pk_bf16_f32 v19, v70, v71
    v_sub_f32 v72, v72, v128
    v_sub_f32 v73, v73, v128
    v_cvt_pk_bf16_f32 v131, v72, v73
    v_and_b32 v73, 0xffff0000, v131
    v_lshlrev_b32 v72, 16, v131
    v_mul_f32 v72, v72, v129
    v_mul_f32 v73, v73, v129
    v_cvt_pk_bf16_f32 v20, v72, v73
    v_sub_f32 v74, v74, v128
    v_sub_f32 v75, v75, v128
    v_cvt_pk_bf16_f32 v131, v74, v75
    v_and_b32 v75, 0xffff0000, v131
    v_lshlrev_b32 v74, 16, v131
    v_mul_f32 v74, v74, v129
    v_mul_f32 v75, v75, v129
    v_cvt_pk_bf16_f32 v21, v74, v75
    v_sub_f32 v76, v76, v128
    v_sub_f32 v77, v77, v128
    v_cvt_pk_bf16_f32 v131, v76, v77
    v_and_b32 v77, 0xffff0000, v131
    v_lshlrev_b32 v76, 16, v131
    v_mul_f32 v76, v76, v129
    v_mul_f32 v77, v77, v129
    v_cvt_pk_bf16_f32 v22, v76, v77
    v_sub_f32 v78, v78, v128
    v_sub_f32 v79, v79, v128
    v_cvt_pk_bf16_f32 v131, v78, v79
    v_and_b32 v79, 0xffff0000, v131
    v_lshlrev_b32 v78, 16, v131
    v_mul_f32 v78, v78, v129
    v_mul_f32 v79, v79, v129
    v_cvt_pk_bf16_f32 v23, v78, v79
    v_sub_f32 v80, v80, v128
    v_sub_f32 v81, v81, v128
    v_cvt_pk_bf16_f32 v131, v80, v81
    v_and_b32 v81, 0xffff0000, v131
    v_lshlrev_b32 v80, 16, v131
    v_mul_f32 v80, v80, v129
    v_mul_f32 v81, v81, v129
    v_cvt_pk_bf16_f32 v24, v80, v81
    v_sub_f32 v82, v82, v128
    v_sub_f32 v83, v83, v128
    v_cvt_pk_bf16_f32 v131, v82, v83
    v_and_b32 v83, 0xffff0000, v131
    v_lshlrev_b32 v82, 16, v131
    v_mul_f32 v82, v82, v129
    v_mul_f32 v83, v83, v129
    v_cvt_pk_bf16_f32 v25, v82, v83
    v_sub_f32 v84, v84, v128
    v_sub_f32 v85, v85, v128
    v_cvt_pk_bf16_f32 v131, v84, v85
    v_and_b32 v85, 0xffff0000, v131
    v_lshlrev_b32 v84, 16, v131
    v_mul_f32 v84, v84, v129
    v_mul_f32 v85, v85, v129
    v_cvt_pk_bf16_f32 v26, v84, v85
    v_sub_f32 v86, v86, v128
    v_sub_f32 v87, v87, v128
    v_cvt_pk_bf16_f32 v131, v86, v87
    v_and_b32 v87, 0xffff0000, v131
    v_lshlrev_b32 v86, 16, v131
    v_mul_f32 v86, v86, v129
    v_mul_f32 v87, v87, v129
    v_cvt_pk_bf16_f32 v27, v86, v87
    v_sub_f32 v88, v88, v128
    v_sub_f32 v89, v89, v128
    v_cvt_pk_bf16_f32 v131, v88, v89
    v_and_b32 v89, 0xffff0000, v131
    v_lshlrev_b32 v88, 16, v131
    v_mul_f32 v88, v88, v129
    v_mul_f32 v89, v89, v129
    v_cvt_pk_bf16_f32 v28, v88, v89
    v_sub_f32 v90, v90, v128
    v_sub_f32 v91, v91, v128
    v_cvt_pk_bf16_f32 v131, v90, v91
    v_and_b32 v91, 0xffff0000, v131
    v_lshlrev_b32 v90, 16, v131
    v_mul_f32 v90, v90, v129
    v_mul_f32 v91, v91, v129
    v_cvt_pk_bf16_f32 v29, v90, v91
    v_sub_f32 v92, v92, v128
    v_sub_f32 v93, v93, v128
    v_cvt_pk_bf16_f32 v131, v92, v93
    v_and_b32 v93, 0xffff0000, v131
    v_lshlrev_b32 v92, 16, v131
    v_mul_f32 v92, v92, v129
    v_mul_f32 v93, v93, v129
    v_cvt_pk_bf16_f32 v30, v92, v93
    v_sub_f32 v94, v94, v128
    v_sub_f32 v95, v95, v128
    v_cvt_pk_bf16_f32 v131, v94, v95
    v_and_b32 v95, 0xffff0000, v131
    v_lshlrev_b32 v94, 16, v131
    v_mul_f32 v94, v94, v129
    v_mul_f32 v95, v95, v129
    v_cvt_pk_bf16_f32 v31, v94, v95
    v_sub_f32 v96, v96, v128
    v_sub_f32 v97, v97, v128
    v_cvt_pk_bf16_f32 v131, v96, v97
    v_and_b32 v97, 0xffff0000, v131
    v_lshlrev_b32 v96, 16, v131
    v_mul_f32 v96, v96, v129
    v_mul_f32 v97, v97, v129
    v_cvt_pk_bf16_f32 v32, v96, v97
    v_sub_f32 v98, v98, v128
    v_sub_f32 v99, v99, v128
    v_cvt_pk_bf16_f32 v131, v98, v99
    v_and_b32 v99, 0xffff0000, v131
    v_lshlrev_b32 v98, 16, v131
    v_mul_f32 v98, v98, v129
    v_mul_f32 v99, v99, v129
    v_cvt_pk_bf16_f32 v33, v98, v99
    v_sub_f32 v100, v100, v128
    v_sub_f32 v101, v101, v128
    v_cvt_pk_bf16_f32 v131, v100, v101
    v_and_b32 v101, 0xffff0000, v131
    v_lshlrev_b32 v100, 16, v131
    v_mul_f32 v100, v100, v129
    v_mul_f32 v101, v101, v129
    v_cvt_pk_bf16_f32 v34, v100, v101
    v_sub_f32 v102, v102, v128
    v_sub_f32 v103, v103, v128
    v_cvt_pk_bf16_f32 v131, v102, v103
    v_and_b32 v103, 0xffff0000, v131
    v_lshlrev_b32 v102, 16, v131
    v_mul_f32 v102, v102, v129
    v_mul_f32 v103, v103, v129
    v_cvt_pk_bf16_f32 v35, v102, v103
    v_sub_f32 v104, v104, v128
    v_sub_f32 v105, v105, v128
    v_cvt_pk_bf16_f32 v131, v104, v105
    v_and_b32 v105, 0xffff0000, v131
    v_lshlrev_b32 v104, 16, v131
    v_mul_f32 v104, v104, v129
    v_mul_f32 v105, v105, v129
    v_cvt_pk_bf16_f32 v36, v104, v105
    v_sub_f32 v106, v106, v128
    v_sub_f32 v107, v107, v128
    v_cvt_pk_bf16_f32 v131, v106, v107
    v_and_b32 v107, 0xffff0000, v131
    v_lshlrev_b32 v106, 16, v131
    v_mul_f32 v106, v106, v129
    v_mul_f32 v107, v107, v129
    v_cvt_pk_bf16_f32 v37, v106, v107
    v_sub_f32 v108, v108, v128
    v_sub_f32 v109, v109, v128
    v_cvt_pk_bf16_f32 v131, v108, v109
    v_and_b32 v109, 0xffff0000, v131
    v_lshlrev_b32 v108, 16, v131
    v_mul_f32 v108, v108, v129
    v_mul_f32 v109, v109, v129
    v_cvt_pk_bf16_f32 v38, v108, v109
    v_sub_f32 v110, v110, v128
    v_sub_f32 v111, v111, v128
    v_cvt_pk_bf16_f32 v131, v110, v111
    v_and_b32 v111, 0xffff0000, v131
    v_lshlrev_b32 v110, 16, v131
    v_mul_f32 v110, v110, v129
    v_mul_f32 v111, v111, v129
    v_cvt_pk_bf16_f32 v39, v110, v111
    v_sub_f32 v112, v112, v128
    v_sub_f32 v113, v113, v128
    v_cvt_pk_bf16_f32 v131, v112, v113
    v_and_b32 v113, 0xffff0000, v131
    v_lshlrev_b32 v112, 16, v131
    v_mul_f32 v112, v112, v129
    v_mul_f32 v113, v113, v129
    v_cvt_pk_bf16_f32 v40, v112, v113
    v_sub_f32 v114, v114, v128
    v_sub_f32 v115, v115, v128
    v_cvt_pk_bf16_f32 v131, v114, v115
    v_and_b32 v115, 0xffff0000, v131
    v_lshlrev_b32 v114, 16, v131
    v_mul_f32 v114, v114, v129
    v_mul_f32 v115, v115, v129
    v_cvt_pk_bf16_f32 v41, v114, v115
    v_sub_f32 v116, v116, v128
    v_sub_f32 v117, v117, v128
    v_cvt_pk_bf16_f32 v131, v116, v117
    v_and_b32 v117, 0xffff0000, v131
    v_lshlrev_b32 v116, 16, v131
    v_mul_f32 v116, v116, v129
    v_mul_f32 v117, v117, v129
    v_cvt_pk_bf16_f32 v42, v116, v117
    v_sub_f32 v118, v118, v128
    v_sub_f32 v119, v119, v128
    v_cvt_pk_bf16_f32 v131, v118, v119
    v_and_b32 v119, 0xffff0000, v131
    v_lshlrev_b32 v118, 16, v131
    v_mul_f32 v118, v118, v129
    v_mul_f32 v119, v119, v129
    v_cvt_pk_bf16_f32 v43, v118, v119
    v_sub_f32 v120, v120, v128
    v_sub_f32 v121, v121, v128
    v_cvt_pk_bf16_f32 v131, v120, v121
    v_and_b32 v121, 0xffff0000, v131
    v_lshlrev_b32 v120, 16, v131
    v_mul_f32 v120, v120, v129
    v_mul_f32 v121, v121, v129
    v_cvt_pk_bf16_f32 v44, v120, v121
    v_sub_f32 v122, v122, v128
    v_sub_f32 v123, v123, v128
    v_cvt_pk_bf16_f32 v131, v122, v123
    v_and_b32 v123, 0xffff0000, v131
    v_lshlrev_b32 v122, 16, v131
    v_mul_f32 v122, v122, v129
    v_mul_f32 v123, v123, v129
    v_cvt_pk_bf16_f32 v45, v122, v123
    v_sub_f32 v124, v124, v128
    v_sub_f32 v125, v125, v128
    v_cvt_pk_bf16_f32 v131, v124, v125
    v_and_b32 v125, 0xffff0000, v131
    v_lshlrev_b32 v124, 16, v131
    v_mul_f32 v124, v124, v129
    v_mul_f32 v125, v125, v129
    v_cvt_pk_bf16_f32 v46, v124, v125
    v_sub_f32 v126, v126, v128
    v_sub_f32 v127, v127, v128
    v_cvt_pk_bf16_f32 v131, v126, v127
    v_and_b32 v127, 0xffff0000, v131
    v_lshlrev_b32 v126, 16, v131
    v_mul_f32 v126, v126, v129
    v_mul_f32 v127, v127, v129
    v_cvt_pk_bf16_f32 v47, v126, v127
    buffer_store_dwordx4 v[8:11], v5, s[4:7], s35 offen sc1
    s_add_u32 s35, s35, 4096
    buffer_store_dwordx4 v[12:15], v5, s[4:7], s35 offen sc1
    s_add_u32 s35, s35, 4096
    buffer_store_dwordx4 v[16:19], v5, s[4:7], s35 offen sc1
    s_add_u32 s35, s35, 4096
    buffer_store_dwordx4 v[20:23], v5, s[4:7], s35 offen sc1
    s_add_u32 s35, s35, 4096
    buffer_store_dwordx4 v[24:27], v5, s[4:7], s35 offen sc1
    s_add_u32 s35, s35, 4096
    buffer_store_dwordx4 v[28:31], v5, s[4:7], s35 offen sc1
    s_add_u32 s35, s35, 4096
    buffer_store_dwordx4 v[32:35], v5, s[4:7], s35 offen sc1
    s_add_u32 s35, s35, 4096
    buffer_store_dwordx4 v[36:39], v5, s[4:7], s35 offen sc1
    s_add_u32 s35, s35, 4096
    buffer_store_dwordx4 v[40:43], v5, s[4:7], s35 offen sc1
    s_add_u32 s35, s35, 4096
    buffer_store_dwordx4 v[44:47], v5, s[4:7], s35 offen sc1
    s_waitcnt vmcnt(0)
    s_barrier
    s_cmp_lg_u32 s28, 0
    s_cbranch_scc1 ln_59
    s_cmp_ge_u32 s42, 2
    s_cbranch_scc1 ln_60
    s_lshl_b32 s34, s42, 7
    s_add_u32 s34, s34, 64
    v_mov_b32 v6, 1
    v_mov_b32 v7, 0
    s_mov_b64 exec, 1
    buffer_store_dword v6, v7, s[16:19], s34 offen sc1
    s_mov_b64 exec, -1
ln_60:
    v_mov_b32 v129, 36
dw_61:
    buffer_load_dword v128, v129, s[16:19], 0 offen sc1
    s_waitcnt vmcnt(0)
    v_readfirstlane_b32 s34, v128
    s_sub_u32 s33, s33, 1
    s_cbranch_scc1 END
    s_sleep 2
    s_cmp_lt_u32 s34, 192
    s_cbranch_scc1 dw_61
    s_lshl_b32 s34, s42, 7
    s_add_u32 s34, s34, 0x6460040
    v_mov_b32 v6, 1
    v_mov_b32 v7, 0
    s_mov_b64 exec, 1
    buffer_store_dword v6, v7, s[4:7], s34 offen sc1
    s_mov_b64 exec, -1
ln_59:
    s_cmp_lg_u32 s28, 0
    s_cbranch_scc1 w0_62
    v_mov_b32 v49, 128
dw_63:
    buffer_load_dword v48, v49, s[16:19], 0 offen sc1
    s_waitcnt vmcnt(0)
    v_readfirstlane_b32 s34, v48
    s_sub_u32 s33, s33, 1
    s_cbranch_scc1 END
    s_sleep 8
    s_cmp_lt_u32 s34, 64
    s_cbranch_scc1 dw_63
w0_62:
    s_barrier
    s_lshl_b32 s46, s42, 8
    s_lshl_b32 s47, s28, 2
    v_lshrrev_b32 v48, 4, v1
    v_and_b32 v49, 15, v1
    v_lshlrev_b32 v50, 1, v48
    v_xor_b32 v49, v49, v50
    s_lshr_b32 s34, s28, 1
    s_lshl_b32 s34, s34, 3
    v_xor_b32 v49, s34, v49
    s_mov_b32 s34, 8192
    v_mul_lo_u32 v48, v48, s34
    v_lshlrev_b32 v49, 4, v49
    v_add_u32 v5, v48, v49
    s_mul_i32 s41, s28, 32768
    s_add_u32 s41, s41, s46
    s_lshl_b32 s40, s28, 10
    s_add_u32 s40, s40, 0
    s_mov_b32 m0, s40
    s_nop 0
    buffer_load_dwordx4 v5, s[8:11], s41 offen lds
    s_add_u32 s40, s40, 4096
    s_add_u32 s41, s41, 131072
    s_mov_b32 m0, s40
    s_nop 0
    buffer_load_dwordx4 v5, s[8:11], s41 offen lds
    s_add_u32 s40, s40, 4096
    s_add_u32 s41, s41, 131072
    s_mov_b32 m0, s40
    s_nop 0
    buffer_load_dwordx4 v5, s[8:11], s41 offen lds
    s_add_u32 s40, s40, 4096
    s_add_u32 s41, s41, 131072
    s_mov_b32 m0, s40
    s_nop 0
    buffer_load_dwordx4 v5, s[8:11], s41 offen lds
    s_add_u32 s40, s40, 4096
    s_add_u32 s41, s41, 131072
    s_mov_b32 m0, s40
    s_nop 0
    buffer_load_dwordx4 v5, s[8:11], s41 offen lds
    s_add_u32 s40, s40, 4096
    s_add_u32 s41, s41, 131072
    s_mov_b32 m0, s40
    s_nop 0
    buffer_load_dwordx4 v5, s[8:11], s41 offen lds
    s_add_u32 s40, s40, 4096
    s_add_u32 s41, s41, 131072
    s_mov_b32 m0, s40
    s_nop 0
    buffer_load_dwordx4 v5, s[8:11], s41 offen lds
    s_add_u32 s40, s40, 4096
    s_add_u32 s41, s41, 131072
    s_mov_b32 m0, s40
    s_nop 0
    buffer_load_dwordx4 v5, s[8:11], s41 offen lds
    s_add_u32 s40, s40, 4096
    s_add_u32 s41, s41, 131072
    s_mov_b32 m0, s40
    s_nop 0
    buffer_load_dwordx4 v5, s[8:11], s41 offen lds
    s_add_u32 s40, s40, 4096
    s_add_u32 s41, s41, 131072
    s_mov_b32 m0, s40
    s_nop 0
    buffer_load_dwordx4 v5, s[8:11], s41 offen lds
    s_add_u32 s40, s40, 4096
    s_add_u32 s41, s41, 131072
    s_mov_b32 m0, s40
    s_nop 0
    buffer_load_dwordx4 v5, s[8:11], s41 offen lds
    s_add_u32 s40, s40, 4096
    s_add_u32 s41, s41, 131072
    s_mov_b32 m0, s40
    s_nop 0
    buffer_load_dwordx4 v5, s[8:11], s41 offen lds
    s_add_u32 s40, s40, 4096
    s_add_u32 s41, s41, 131072
    s_mov_b32 m0, s40
    s_nop 0
    buffer_load_dwordx4 v5, s[8:11], s41 offen lds
    s_add_u32 s40, s40, 4096
    s_add_u32 s41, s41, 131072
    s_mov_b32 m0, s40
    s_nop 0
    buffer_load_dwordx4 v5, s[8:11], s41 offen lds
    s_add_u32 s40, s40, 4096
    s_add_u32 s41, s41, 131072
    s_mov_b32 m0, s40
    s_nop 0
    buffer_load_dwordx4 v5, s[8:11], s41 offen lds
    s_add_u32 s40, s40, 4096
    s_add_u32 s41, s41, 131072
    s_mov_b32 m0, s40
    s_nop 0
    buffer_load_dwordx4 v5, s[8:11], s41 offen lds
    s_add_u32 s40, s40, 4096
    s_add_u32 s41, s41, 131072
    s_mov_b32 m0, s40
    s_nop 0
    buffer_load_dwordx4 v5, s[8:11], s41 offen lds
    s_add_u32 s40, s40, 4096
    s_add_u32 s41, s41, 131072
    s_mov_b32 m0, s40
    s_nop 0
    buffer_load_dwordx4 v5, s[8:11], s41 offen lds
    s_add_u32 s40, s40, 4096
    s_add_u32 s41, s41, 131072
    s_mov_b32 m0, s40
    s_nop 0
    buffer_load_dwordx4 v5, s[8:11], s41 offen lds
    s_add_u32 s40, s40, 4096
    s_add_u32 s41, s41, 131072
    s_mov_b32 m0, s40
    s_nop 0
    buffer_load_dwordx4 v5, s[8:11], s41 offen lds
    s_add_u32 s40, s40, 4096
    s_add_u32 s41, s41, 131072
    s_mov_b32 m0, s40
    s_nop 0
    buffer_load_dwordx4 v5, s[8:11], s41 offen lds
    s_add_u32 s40, s40, 4096
    s_add_u32 s41, s41, 131072
    s_mov_b32 m0, s40
    s_nop 0
    buffer_load_dwordx4 v5, s[8:11], s41 offen lds
    s_add_u32 s40, s40, 4096
    s_add_u32 s41, s41, 131072
    s_mov_b32 m0, s40
    s_nop 0
    buffer_load_dwordx4 v5, s[8:11], s41 offen lds
    s_add_u32 s40, s40, 4096
    s_add_u32 s41, s41, 131072
    s_mov_b32 m0, s40
    s_nop 0
    buffer_load_dwordx4 v5, s[8:11], s41 offen lds
    s_add_u32 s40, s40, 4096
    s_add_u32 s41, s41, 131072
    s_mov_b32 m0, s40
    s_nop 0
    buffer_load_dwordx4 v5, s[8:11], s41 offen lds
    s_add_u32 s40, s40, 4096
    s_add_u32 s41, s41, 131072
    s_mov_b32 m0, s40
    s_nop 0
    buffer_load_dwordx4 v5, s[8:11], s41 offen lds
    s_add_u32 s40, s40, 4096
    s_add_u32 s41, s41, 131072
    s_mov_b32 m0, s40
    s_nop 0
    buffer_load_dwordx4 v5, s[8:11], s41 offen lds
    s_add_u32 s40, s40, 4096
    s_add_u32 s41, s41, 131072
    s_mov_b32 m0, s40
    s_nop 0
    buffer_load_dwordx4 v5, s[8:11], s41 offen lds
    s_add_u32 s40, s40, 4096
    s_add_u32 s41, s41, 131072
    s_mov_b32 m0, s40
    s_nop 0
    buffer_load_dwordx4 v5, s[8:11], s41 offen lds
    s_add_u32 s40, s40, 4096
    s_add_u32 s41, s41, 131072
    s_mov_b32 m0, s40
    s_nop 0
    buffer_load_dwordx4 v5, s[8:11], s41 offen lds
    s_add_u32 s40, s40, 4096
    s_add_u32 s41, s41, 131072
    s_mov_b32 m0, s40
    s_nop 0
    buffer_load_dwordx4 v5, s[8:11], s41 offen lds
    s_add_u32 s40, s40, 4096
    s_add_u32 s41, s41, 131072
    s_mov_b32 m0, s40
    s_nop 0
    buffer_load_dwordx4 v5, s[8:11], s41 offen lds
    s_add_u32 s40, s40, 4096
    s_add_u32 s41, s41, 131072
    s_mov_b32 m0, s40
    s_nop 0
    buffer_load_dwordx4 v5, s[8:11], s41 offen lds
    s_add_u32 s40, s40, 4096
    s_add_u32 s41, s41, 131072
    s_mov_b32 m0, s40
    s_nop 0
    buffer_load_dwordx4 v5, s[8:11], s41 offen lds
    s_add_u32 s40, s40, 4096
    s_add_u32 s41, s41, 131072
    s_mov_b32 m0, s40
    s_nop 0
    buffer_load_dwordx4 v5, s[8:11], s41 offen lds
    s_add_u32 s40, s40, 4096
    s_add_u32 s41, s41, 131072
    s_mov_b32 m0, s40
    s_nop 0
    buffer_load_dwordx4 v5, s[8:11], s41 offen lds
    s_add_u32 s40, s40, 4096
    s_add_u32 s41, s41, 131072
    s_mov_b32 m0, s40
    s_nop 0
    buffer_load_dwordx4 v5, s[8:11], s41 offen lds
    s_add_u32 s40, s40, 4096
    s_add_u32 s41, s41, 131072
    s_mov_b32 m0, s40
    s_nop 0
    buffer_load_dwordx4 v5, s[8:11], s41 offen lds
    s_add_u32 s40, s40, 4096
    s_add_u32 s41, s41, 131072
    s_mov_b32 m0, s40
    s_nop 0
    buffer_load_dwordx4 v5, s[8:11], s41 offen lds
    s_add_u32 s40, s40, 4096
    s_add_u32 s41, s41, 131072
    s_mov_b32 m0, s40
    s_nop 0
    buffer_load_dwordx4 v5, s[8:11], s41 offen lds
    v_lshrrev_b32 v48, 4, v1
    v_bfe_u32 v49, v1, 2, 2
    v_and_b32 v52, 3, v1
    v_add_u32 v50, s47, v52
    v_mov_b32 v51, 0
    v_and_b32 v53, 1, v48
    v_lshl_or_b32 v53, v53, 2, v49
    v_lshlrev_b32 v53, 1, v53
    v_xor_b32 v50, v50, v53
    v_lshlrev_b32 v50, 4, v50
    v_lshl_add_u32 v50, v51, 3, v50
    v_lshl_add_u32 v50, v49, 8, v50
    v_lshl_add_u32 v6, v48, 11, v50
    v_lshrrev_b32 v48, 4, v1
    v_bfe_u32 v49, v1, 2, 2
    v_and_b32 v52, 3, v1
    v_add_u32 v50, s47, v52
    v_mov_b32 v51, 1
    v_and_b32 v53, 1, v48
    v_lshl_or_b32 v53, v53, 2, v49
    v_lshlrev_b32 v53, 1, v53
    v_xor_b32 v50, v50, v53
    v_lshlrev_b32 v50, 4, v50
    v_lshl_add_u32 v50, v51, 3, v50
    v_lshl_add_u32 v50, v49, 8, v50
    v_lshl_add_u32 v7, v48, 11, v50
    v_add_u32 v54, 0x10000, v6
    v_add_u32 v55, 0x10000, v7
    v_add_u32 v56, 0x20000, v6
    v_add_u32 v57, 0x20000, v7
    s_waitcnt vmcnt(0)
    s_barrier
    ds_read_b64_tr_b16 a[0:1], v6 offset:0
    ds_read_b64_tr_b16 a[2:3], v6 offset:1024
    ds_read_b64_tr_b16 a[80:81], v7 offset:0
    ds_read_b64_tr_b16 a[82:83], v7 offset:1024
    ds_read_b64_tr_b16 a[4:5], v6 offset:8192
    ds_read_b64_tr_b16 a[6:7], v6 offset:9216
    ds_read_b64_tr_b16 a[84:85], v7 offset:8192
    ds_read_b64_tr_b16 a[86:87], v7 offset:9216
    ds_read_b64_tr_b16 a[8:9], v6 offset:16384
    ds_read_b64_tr_b16 a[10:11], v6 offset:17408
    ds_read_b64_tr_b16 a[88:89], v7 offset:16384
    ds_read_b64_tr_b16 a[90:91], v7 offset:17408
    ds_read_b64_tr_b16 a[12:13], v6 offset:24576
    ds_read_b64_tr_b16 a[14:15], v6 offset:25600
    ds_read_b64_tr_b16 a[92:93], v7 offset:24576
    ds_read_b64_tr_b16 a[94:95], v7 offset:25600
    s_waitcnt lgkmcnt(0)
    ds_read_b64_tr_b16 a[16:17], v6 offset:32768
    ds_read_b64_tr_b16 a[18:19], v6 offset:33792
    ds_read_b64_tr_b16 a[96:97], v7 offset:32768
    ds_read_b64_tr_b16 a[98:99], v7 offset:33792
    ds_read_b64_tr_b16 a[20:21], v6 offset:40960
    ds_read_b64_tr_b16 a[22:23], v6 offset:41984
    ds_read_b64_tr_b16 a[100:101], v7 offset:40960
    ds_read_b64_tr_b16 a[102:103], v7 offset:41984
    ds_read_b64_tr_b16 a[24:25], v6 offset:49152
    ds_read_b64_tr_b16 a[26:27], v6 offset:50176
    ds_read_b64_tr_b16 a[104:105], v7 offset:49152
    ds_read_b64_tr_b16 a[106:107], v7 offset:50176
    ds_read_b64_tr_b16 a[28:29], v6 offset:57344
    ds_read_b64_tr_b16 a[30:31], v6 offset:58368
    ds_read_b64_tr_b16 a[108:109], v7 offset:57344
    ds_read_b64_tr_b16 a[110:111], v7 offset:58368
    s_waitcnt lgkmcnt(0)
    ds_read_b64_tr_b16 a[32:33], v54 offset:0
    ds_read_b64_tr_b16 a[34:35], v54 offset:1024
    ds_read_b64_tr_b16 a[112:113], v55 offset:0
    ds_read_b64_tr_b16 a[114:115], v55 offset:1024
    ds_read_b64_tr_b16 a[36:37], v54 offset:8192
    ds_read_b64_tr_b16 a[38:39], v54 offset:9216
    ds_read_b64_tr_b16 a[116:117], v55 offset:8192
    ds_read_b64_tr_b16 a[118:119], v55 offset:9216
    ds_read_b64_tr_b16 a[40:41], v54 offset:16384
    ds_read_b64_tr_b16 a[42:43], v54 offset:17408
    ds_read_b64_tr_b16 a[120:121], v55 offset:16384
    ds_read_b64_tr_b16 a[122:123], v55 offset:17408
    ds_read_b64_tr_b16 a[44:45], v54 offset:24576
    ds_read_b64_tr_b16 a[46:47], v54 offset:25600
    ds_read_b64_tr_b16 a[124:125], v55 offset:24576
    ds_read_b64_tr_b16 a[126:127], v55 offset:25600
    s_waitcnt lgkmcnt(0)
    ds_read_b64_tr_b16 a[48:49], v54 offset:32768
    ds_read_b64_tr_b16 a[50:51], v54 offset:33792
    ds_read_b64_tr_b16 a[128:129], v55 offset:32768
    ds_read_b64_tr_b16 a[130:131], v55 offset:33792
    ds_read_b64_tr_b16 a[52:53], v54 offset:40960
    ds_read_b64_tr_b16 a[54:55], v54 offset:41984
    ds_read_b64_tr_b16 a[132:133], v55 offset:40960
    ds_read_b64_tr_b16 a[134:135], v55 offset:41984
    ds_read_b64_tr_b16 a[56:57], v54 offset:49152
    ds_read_b64_tr_b16 a[58:59], v54 offset:50176
    ds_read_b64_tr_b16 a[136:137], v55 offset:49152
    ds_read_b64_tr_b16 a[138:139], v55 offset:50176
    ds_read_b64_tr_b16 a[60:61], v54 offset:57344
    ds_read_b64_tr_b16 a[62:63], v54 offset:58368
    ds_read_b64_tr_b16 a[140:141], v55 offset:57344
    ds_read_b64_tr_b16 a[142:143], v55 offset:58368
    s_waitcnt lgkmcnt(0)
    ds_read_b64_tr_b16 a[64:65], v56 offset:0
    ds_read_b64_tr_b16 a[66:67], v56 offset:1024
    ds_read_b64_tr_b16 a[144:145], v57 offset:0
    ds_read_b64_tr_b16 a[146:147], v57 offset:1024
    ds_read_b64_tr_b16 a[68:69], v56 offset:8192
    ds_read_b64_tr_b16 a[70:71], v56 offset:9216
    ds_read_b64_tr_b16 a[148:149], v57 offset:8192
    ds_read_b64_tr_b16 a[150:151], v57 offset:9216
    ds_read_b64_tr_b16 a[72:73], v56 offset:16384
    ds_read_b64_tr_b16 a[74:75], v56 offset:17408
    ds_read_b64_tr_b16 a[152:153], v57 offset:16384
    ds_read_b64_tr_b16 a[154:155], v57 offset:17408
    ds_read_b64_tr_b16 a[76:77], v56 offset:24576
    ds_read_b64_tr_b16 a[78:79], v56 offset:25600
    ds_read_b64_tr_b16 a[156:157], v57 offset:24576
    ds_read_b64_tr_b16 a[158:159], v57 offset:25600
    s_waitcnt lgkmcnt(0)
    s_waitcnt lgkmcnt(0)
    s_barrier
    v_lshlrev_b32 v2, 4, v1
    v_lshrrev_b32 v3, 4, v1
    v_lshlrev_b32 v3, 9, v3
    v_and_b32 v4, 15, v1
    v_lshl_add_u32 v3, v4, 4, v3
    s_and_b32 s53, s28, 1
    s_lshr_b32 s54, s28, 1
    s_mov_b32 s55, 0x3e0293ee
    s_mov_b32 s56, -1
    s_mov_b32 s57, 0
    s_lshl_b32 s34, s28, 11
    s_add_u32 s34, s34, 81920
    v_add_u32 v59, s34, v2
    s_lshl_b32 s34, s53, 10
    s_add_u32 s34, s34, 81920
    v_add_u32 v60, s34, v2
    v_and_b32 v48, 15, v1
    v_lshrrev_b32 v49, 4, v1
    v_and_b32 v61, 7, v1
    v_lshlrev_b32 v61, 4, v61
    v_lshl_add_u32 v61, v49, 7, v61
    v_lshrrev_b32 v50, 2, v48
    v_lshlrev_b32 v50, 3, v50
    v_and_b32 v51, 3, v48
    v_add_u32 v50, v50, v51
    s_lshl_b32 s34, s54, 6
    v_add_u32 v50, s34, v50
    v_lshlrev_b32 v62, 6, v50
    v_lshl_add_u32 v62, v49, 4, v62
    v_and_b32 v51, 1, v49
    v_lshlrev_b32 v63, 4, v50
    v_lshl_add_u32 v63, v51, 3, v63
    s_lshl_b32 s34, s54, 12
    s_lshl_b32 s35, s53, 8
    s_add_u32 s34, s34, s35
    v_add_u32 v64, s34, v3
    v_and_b32 v50, 3, v1
    s_lshl_b32 s34, s42, 1
    s_sub_u32 s34, s34, 2
    v_add_u32 v65, s34, v50
    s_add_u32 s34, s42, 64
    v_mov_b32 v51, s34
    v_cmp_eq_u32 vcc, 0, v50
    v_cndmask_b32 v65, v65, v51, vcc
    s_add_u32 s34, s42, 96
    v_mov_b32 v51, s34
    v_cmp_eq_u32 vcc, 1, v50
    v_cndmask_b32 v65, v65, v51, vcc
    v_lshlrev_b32 v65, 7, v65
    v_add_u32 v65, 0x6460000, v65
    v_lshrrev_b32 v50, 2, v48
    v_lshlrev_b32 v50, 3, v50
    v_and_b32 v51, 3, v48
    v_add_u32 v50, v50, v51
    s_lshl_b32 s34, s53, 2
    v_add_u32 v50, s34, v50
    v_lshlrev_b32 v51, 3, v49
    v_sub_u32 v50, v50, v51
    v_cmp_le_i32 s[60:61], 0, v50
    v_cmp_le_i32 s[62:63], 1, v50
    v_cmp_le_i32 s[64:65], 2, v50
    v_cmp_le_i32 s[66:67], 3, v50
    v_cmp_le_i32 s[68:69], 4, v50
    v_cmp_le_i32 s[70:71], 5, v50
    v_cmp_le_i32 s[72:73], 6, v50
    v_cmp_le_i32 s[74:75], 7, v50
    v_mov_b32 v66, 0xf149f2ca
    s_mov_b32 s58, 0
    s_cmp_lg_u32 s28, 0
    s_cbranch_scc1 w0_64
    v_mov_b32 v49, 192
    v_mov_b32 v50, 1
    v_mov_b32 v51, 64
    v_cmp_eq_u32 vcc, 1, v1
    v_cndmask_b32 v49, v49, v51, vcc
    v_mov_b32 v51, 36
    v_cmp_eq_u32 vcc, 0, v1
    v_cndmask_b32 v49, v49, v51, vcc
    v_mov_b32 v51, 192
    v_cndmask_b32 v50, v50, v51, vcc
fw_65:
    buffer_load_dword v48, v49, s[16:19], 0 offen sc1
    s_waitcnt vmcnt(0)
    v_cmp_gt_u32 vcc, v50, v48
    s_sub_u32 s33, s33, 1
    s_cbranch_scc1 END
    s_cbranch_vccz fd_66
    s_sleep 2
    s_branch fw_65
fd_66:
w0_64:
    s_barrier
    s_mov_b32 s31, 0
    s_mov_b32 s50, 0
    s_mul_i32 s41, s31, 40960
    s_mul_i32 s34, s28, 10240
    s_add_u32 s41, s41, s34
    s_add_u32 s40, s50, s34
    s_mov_b32 m0, s40
    s_nop 0
    buffer_load_dwordx4 v2, s[4:7], s41 offen sc1 lds
    s_add_u32 s40, s40, 1024
    s_add_u32 s41, s41, 1024
    s_mov_b32 m0, s40
    s_nop 0
    buffer_load_dwordx4 v2, s[4:7], s41 offen sc1 lds
    s_add_u32 s40, s40, 1024
    s_add_u32 s41, s41, 1024
    s_mov_b32 m0, s40
    s_nop 0
    buffer_load_dwordx4 v2, s[4:7], s41 offen sc1 lds
    s_add_u32 s40, s40, 1024
    s_add_u32 s41, s41, 1024
    s_mov_b32 m0, s40
    s_nop 0
    buffer_load_dwordx4 v2, s[4:7], s41 offen sc1 lds
    s_add_u32 s40, s40, 1024
    s_add_u32 s41, s41, 1024
    s_mov_b32 m0, s40
    s_nop 0
    buffer_load_dwordx4 v2, s[4:7], s41 offen sc1 lds
    s_add_u32 s40, s40, 1024
    s_add_u32 s41, s41, 1024
    s_mov_b32 m0, s40
    s_nop 0
    buffer_load_dwordx4 v2, s[4:7], s41 offen sc1 lds
    s_add_u32 s40, s40, 1024
    s_add_u32 s41, s41, 1024
    s_mov_b32 m0, s40
    s_nop 0
    buffer_load_dwordx4 v2, s[4:7], s41 offen sc1 lds
    s_add_u32 s40, s40, 1024
    s_add_u32 s41, s41, 1024
    s_mov_b32 m0, s40
    s_nop 0
    buffer_load_dwordx4 v2, s[4:7], s41 offen sc1 lds
    s_add_u32 s40, s40, 1024
    s_add_u32 s41, s41, 1024
    s_mov_b32 m0, s40
    s_nop 0
    buffer_load_dwordx4 v2, s[4:7], s41 offen sc1 lds
    s_add_u32 s40, s40, 1024
    s_add_u32 s41, s41, 1024
    s_mov_b32 m0, s40
    s_nop 0
    buffer_load_dwordx4 v2, s[4:7], s41 offen sc1 lds
    s_waitcnt vmcnt(0)
    s_barrier
QA_67:
    s_cmp_lg_u32 s31, 1
    s_cbranch_scc1 lnw_68
    s_cmp_lg_u32 s28, 0
    s_cbranch_scc1 w0_69
    v_and_b32 v49, 63, v1
    v_lshlrev_b32 v49, 7, v49
    v_add_u32 v49, 0x6460040, v49
fw_70:
    buffer_load_dword v48, v49, s[4:7], 0 offen sc1
    s_waitcnt vmcnt(0)
    v_cmp_gt_u32 vcc, s31, v48
    s_sub_u32 s33, s33, 1
    s_cbranch_scc1 END
    s_cbranch_vccz fd_71
    s_sleep 2
    s_branch fw_70
fd_71:
w0_69:
    s_barrier
lnw_68:
    s_add_u32 s51, s31, 1
    s_min_u32 s39, s51, 63
    s_xor_b32 s52, s50, 40960
    s_mul_i32 s41, s39, 40960
    s_mul_i32 s34, s28, 10240
    s_add_u32 s41, s41, s34
    s_add_u32 s40, s52, s34
    v_add_u32 v58, s50, v3
    s_cmp_ge_u32 s58, s51
    s_cbranch_scc1 cd_73
cw_72:
    buffer_load_dword v48, v65, s[4:7], 0 offen sc1
    s_waitcnt vmcnt(0)
    v_readlane_b32 s58, v48, 0
    v_readlane_b32 s34, v48, 1
    s_min_u32 s58, s58, s34
    s_sub_u32 s33, s33, 1
    s_cbranch_scc1 END
    s_cmp_ge_u32 s58, s51
    s_cbranch_scc1 cd_73
    s_sleep 2
    s_branch cw_72
cd_73:
    s_lshl_b32 s48, s31, 18
    s_lshl_b32 s49, s42, 13
    s_add_u32 s48, s48, s49
    s_add_u32 s35, s48, 0x400000
    s_add_u32 s36, s35, 4096
    s_add_u32 s37, s48, 0x1400000
    ds_read_b128 v[24:27], v58 offset:0
    ds_read_b128 v[28:31], v58 offset:256
    ds_read_b128 v[32:35], v58 offset:2048
    ds_read_b128 v[36:39], v58 offset:2304
    ds_read_b128 v[40:43], v58 offset:4096
    ds_read_b128 v[44:47], v58 offset:4352
    s_waitcnt lgkmcnt(4)
    v_mfma_f32_16x16x32_bf16 v[8:11], a[0:3], v[24:27], 0
    buffer_load_dwordx4 v[68:71], v2, s[4:7], s35 offen offset:0 sc1
    v_mfma_f32_16x16x32_bf16 v[16:19], a[80:83], v[24:27], 0
    v_mfma_f32_16x16x32_bf16 v[12:15], a[0:3], v[28:31], 0
    s_mov_b32 m0, s40
    s_nop 0
    buffer_load_dwordx4 v2, s[4:7], s41 offen sc1 lds
    s_add_u32 s40, s40, 1024
    s_add_u32 s41, s41, 1024
    v_mfma_f32_16x16x32_bf16 v[20:23], a[80:83], v[28:31], 0
    ds_read_b128 v[24:27], v58 offset:6144
    ds_read_b128 v[28:31], v58 offset:6400
    s_waitcnt lgkmcnt(4)
    v_mfma_f32_16x16x32_bf16 v[8:11], a[4:7], v[32:35], v[8:11]
    buffer_load_dwordx4 v[72:75], v2, s[4:7], s35 offen offset:1024 sc1
    v_mfma_f32_16x16x32_bf16 v[16:19], a[84:87], v[32:35], v[16:19]
    v_mfma_f32_16x16x32_bf16 v[12:15], a[4:7], v[36:39], v[12:15]
    v_mfma_f32_16x16x32_bf16 v[20:23], a[84:87], v[36:39], v[20:23]
    ds_read_b128 v[32:35], v58 offset:8192
    ds_read_b128 v[36:39], v58 offset:8448
    s_waitcnt lgkmcnt(4)
    v_mfma_f32_16x16x32_bf16 v[8:11], a[8:11], v[40:43], v[8:11]
    buffer_load_dwordx4 v[76:79], v2, s[4:7], s35 offen offset:2048 sc1
    v_mfma_f32_16x16x32_bf16 v[16:19], a[88:91], v[40:43], v[16:19]
    v_mfma_f32_16x16x32_bf16 v[12:15], a[8:11], v[44:47], v[12:15]
    s_mov_b32 m0, s40
    s_nop 0
    buffer_load_dwordx4 v2, s[4:7], s41 offen sc1 lds
    s_add_u32 s40, s40, 1024
    s_add_u32 s41, s41, 1024
    v_mfma_f32_16x16x32_bf16 v[20:23], a[88:91], v[44:47], v[20:23]
    ds_read_b128 v[40:43], v58 offset:10240
    ds_read_b128 v[44:47], v58 offset:10496
    s_waitcnt lgkmcnt(4)
    v_mfma_f32_16x16x32_bf16 v[8:11], a[12:15], v[24:27], v[8:11]
    buffer_load_dwordx4 v[80:83], v2, s[4:7], s35 offen offset:3072 sc1
    v_mfma_f32_16x16x32_bf16 v[16:19], a[92:95], v[24:27], v[16:19]
    v_mfma_f32_16x16x32_bf16 v[12:15], a[12:15], v[28:31], v[12:15]
    v_mfma_f32_16x16x32_bf16 v[20:23], a[92:95], v[28:31], v[20:23]
    ds_read_b128 v[24:27], v58 offset:12288
    ds_read_b128 v[28:31], v58 offset:12544
    s_waitcnt lgkmcnt(4)
    v_mfma_f32_16x16x32_bf16 v[8:11], a[16:19], v[32:35], v[8:11]
    buffer_load_dwordx4 v[84:87], v2, s[4:7], s36 offen offset:0 sc1
    v_mfma_f32_16x16x32_bf16 v[16:19], a[96:99], v[32:35], v[16:19]
    v_mfma_f32_16x16x32_bf16 v[12:15], a[16:19], v[36:39], v[12:15]
    s_mov_b32 m0, s40
    s_nop 0
    buffer_load_dwordx4 v2, s[4:7], s41 offen sc1 lds
    s_add_u32 s40, s40, 1024
    s_add_u32 s41, s41, 1024
    v_mfma_f32_16x16x32_bf16 v[20:23], a[96:99], v[36:39], v[20:23]
    ds_read_b128 v[32:35], v58 offset:14336
    ds_read_b128 v[36:39], v58 offset:14592
    s_waitcnt lgkmcnt(4)
    v_mfma_f32_16x16x32_bf16 v[8:11], a[20:23], v[40:43], v[8:11]
    buffer_load_dwordx4 v[88:91], v2, s[4:7], s36 offen offset:1024 sc1
    v_mfma_f32_16x16x32_bf16 v[16:19], a[100:103], v[40:43], v[16:19]
    v_mfma_f32_16x16x32_bf16 v[12:15], a[20:23], v[44:47], v[12:15]
    v_mfma_f32_16x16x32_bf16 v[20:23], a[100:103], v[44:47], v[20:23]
    ds_read_b128 v[40:43], v58 offset:16384
    ds_read_b128 v[44:47], v58 offset:16640
    s_waitcnt lgkmcnt(4)
    v_mfma_f32_16x16x32_bf16 v[8:11], a[24:27], v[24:27], v[8:11]
    buffer_load_dwordx4 v[92:95], v2, s[4:7], s36 offen offset:2048 sc1
    v_mfma_f32_16x16x32_bf16 v[16:19], a[104:107], v[24:27], v[16:19]
    v_mfma_f32_16x16x32_bf16 v[12:15], a[24:27], v[28:31], v[12:15]
    s_mov_b32 m0, s40
    s_nop 0
    buffer_load_dwordx4 v2, s[4:7], s41 offen sc1 lds
    s_add_u32 s40, s40, 1024
    s_add_u32 s41, s41, 1024
    v_mfma_f32_16x16x32_bf16 v[20:23], a[104:107], v[28:31], v[20:23]
    ds_read_b128 v[24:27], v58 offset:18432
    ds_read_b128 v[28:31], v58 offset:18688
    s_waitcnt lgkmcnt(4)
    v_mfma_f32_16x16x32_bf16 v[8:11], a[28:31], v[32:35], v[8:11]
    buffer_load_dwordx4 v[96:99], v2, s[4:7], s36 offen offset:3072 sc1
    v_mfma_f32_16x16x32_bf16 v[16:19], a[108:111], v[32:35], v[16:19]
    v_mfma_f32_16x16x32_bf16 v[12:15], a[28:31], v[36:39], v[12:15]
    v_mfma_f32_16x16x32_bf16 v[20:23], a[108:111], v[36:39], v[20:23]
    ds_read_b128 v[32:35], v58 offset:20480
    ds_read_b128 v[36:39], v58 offset:20736
    s_waitcnt lgkmcnt(4)
    v_mfma_f32_16x16x32_bf16 v[8:11], a[32:35], v[40:43], v[8:11]
    buffer_load_dwordx4 v[116:119], v62, s[4:7], s37 offen offset:0 sc1
    v_mfma_f32_16x16x32_bf16 v[16:19], a[112:115], v[40:43], v[16:19]
    v_mfma_f32_16x16x32_bf16 v[12:15], a[32:35], v[44:47], v[12:15]
    s_mov_b32 m0, s40
    s_nop 0
    buffer_load_dwordx4 v2, s[4:7], s41 offen sc1 lds
    s_add_u32 s40, s40, 1024
    s_add_u32 s41, s41, 1024
    v_mfma_f32_16x16x32_bf16 v[20:23], a[112:115], v[44:47], v[20:23]
    ds_read_b128 v[40:43], v58 offset:22528
    ds_read_b128 v[44:47], v58 offset:22784
    s_waitcnt lgkmcnt(4)
    v_mfma_f32_16x16x32_bf16 v[8:11], a[36:39], v[24:27], v[8:11]
    buffer_load_dwordx4 v[120:123], v62, s[4:7], s37 offen offset:256 sc1
    v_mfma_f32_16x16x32_bf16 v[16:19], a[116:119], v[24:27], v[16:19]
    v_mfma_f32_16x16x32_bf16 v[12:15], a[36:39], v[28:31], v[12:15]
    v_mfma_f32_16x16x32_bf16 v[20:23], a[116:119], v[28:31], v[20:23]
    ds_read_b128 v[24:27], v58 offset:24576
    ds_read_b128 v[28:31], v58 offset:24832
    s_waitcnt lgkmcnt(4)
    v_mfma_f32_16x16x32_bf16 v[8:11], a[40:43], v[32:35], v[8:11]
    buffer_load_dwordx4 v[124:127], v62, s[4:7], s37 offen offset:2048 sc1
    v_mfma_f32_16x16x32_bf16 v[16:19], a[120:123], v[32:35], v[16:19]
    v_mfma_f32_16x16x32_bf16 v[12:15], a[40:43], v[36:39], v[12:15]
    s_mov_b32 m0, s40
    s_nop 0
    buffer_load_dwordx4 v2, s[4:7], s41 offen sc1 lds
    s_add_u32 s40, s40, 1024
    s_add_u32 s41, s41, 1024
    v_mfma_f32_16x16x32_bf16 v[20:23], a[120:123], v[36:39], v[20:23]
    ds_read_b128 v[32:35], v58 offset:26624
    ds_read_b128 v[36:39], v58 offset:26880
    s_waitcnt lgkmcnt(4)
    v_mfma_f32_16x16x32_bf16 v[8:11], a[44:47], v[40:43], v[8:11]
    buffer_load_dwordx4 v[128:131], v62, s[4:7], s37 offen offset:2304 sc1
    v_mfma_f32_16x16x32_bf16 v[16:19], a[124:127], v[40:43], v[16:19]
    v_mfma_f32_16x16x32_bf16 v[12:15], a[44:47], v[44:47], v[12:15]
    v_mfma_f32_16x16x32_bf16 v[20:23], a[124:127], v[44:47], v[20:23]
    ds_read_b128 v[40:43], v58 offset:28672
    ds_read_b128 v[44:47], v58 offset:28928
    s_waitcnt lgkmcnt(4)
    v_mfma_f32_16x16x32_bf16 v[8:11], a[48:51], v[24:27], v[8:11]
    v_mfma_f32_16x16x32_bf16 v[16:19], a[128:131], v[24:27], v[16:19]
    v_mfma_f32_16x16x32_bf16 v[12:15], a[48:51], v[28:31], v[12:15]
    s_mov_b32 m0, s40
    s_nop 0
    buffer_load_dwordx4 v2, s[4:7], s41 offen sc1 lds
    s_add_u32 s40, s40, 1024
    s_add_u32 s41, s41, 1024
    v_mfma_f32_16x16x32_bf16 v[20:23], a[128:131], v[28:31], v[20:23]
    ds_read_b128 v[24:27], v58 offset:30720
    ds_read_b128 v[28:31], v58 offset:30976
    s_waitcnt lgkmcnt(4)
    v_mfma_f32_16x16x32_bf16 v[8:11], a[52:55], v[32:35], v[8:11]
    v_mfma_f32_16x16x32_bf16 v[16:19], a[132:135], v[32:35], v[16:19]
    v_mfma_f32_16x16x32_bf16 v[12:15], a[52:55], v[36:39], v[12:15]
    v_mfma_f32_16x16x32_bf16 v[20:23], a[132:135], v[36:39], v[20:23]
    ds_read_b128 v[32:35], v58 offset:32768
    ds_read_b128 v[36:39], v58 offset:33024
    s_waitcnt lgkmcnt(4)
    v_mfma_f32_16x16x32_bf16 v[8:11], a[56:59], v[40:43], v[8:11]
    v_mfma_f32_16x16x32_bf16 v[16:19], a[136:139], v[40:43], v[16:19]
    v_mfma_f32_16x16x32_bf16 v[12:15], a[56:59], v[44:47], v[12:15]
    s_mov_b32 m0, s40
    s_nop 0
    buffer_load_dwordx4 v2, s[4:7], s41 offen sc1 lds
    s_add_u32 s40, s40, 1024
    s_add_u32 s41, s41, 1024
    v_mfma_f32_16x16x32_bf16 v[20:23], a[136:139], v[44:47], v[20:23]
    ds_read_b128 v[40:43], v58 offset:34816
    ds_read_b128 v[44:47], v58 offset:35072
    s_waitcnt lgkmcnt(4)
    v_mfma_f32_16x16x32_bf16 v[8:11], a[60:63], v[24:27], v[8:11]
    v_mfma_f32_16x16x32_bf16 v[16:19], a[140:143], v[24:27], v[16:19]
    v_mfma_f32_16x16x32_bf16 v[12:15], a[60:63], v[28:31], v[12:15]
    v_mfma_f32_16x16x32_bf16 v[20:23], a[140:143], v[28:31], v[20:23]
    ds_read_b128 v[24:27], v58 offset:36864
    ds_read_b128 v[28:31], v58 offset:37120
    s_waitcnt lgkmcnt(4)
    v_mfma_f32_16x16x32_bf16 v[8:11], a[64:67], v[32:35], v[8:11]
    v_mfma_f32_16x16x32_bf16 v[16:19], a[144:147], v[32:35], v[16:19]
    v_mfma_f32_16x16x32_bf16 v[12:15], a[64:67], v[36:39], v[12:15]
    s_mov_b32 m0, s40
    s_nop 0
    buffer_load_dwordx4 v2, s[4:7], s41 offen sc1 lds
    s_add_u32 s40, s40, 1024
    s_add_u32 s41, s41, 1024
    v_mfma_f32_16x16x32_bf16 v[20:23], a[144:147], v[36:39], v[20:23]
    ds_read_b128 v[32:35], v58 offset:38912
    ds_read_b128 v[36:39], v58 offset:39168
    s_waitcnt lgkmcnt(4)
    v_mfma_f32_16x16x32_bf16 v[8:11], a[68:71], v[40:43], v[8:11]
    v_mfma_f32_16x16x32_bf16 v[16:19], a[148:151], v[40:43], v[16:19]
    v_mfma_f32_16x16x32_bf16 v[12:15], a[68:71], v[44:47], v[12:15]
    v_mfma_f32_16x16x32_bf16 v[20:23], a[148:151], v[44:47], v[20:23]
    s_waitcnt lgkmcnt(2)
    v_mfma_f32_16x16x32_bf16 v[8:11], a[72:75], v[24:27], v[8:11]
    v_mfma_f32_16x16x32_bf16 v[16:19], a[152:155], v[24:27], v[16:19]
    v_mfma_f32_16x16x32_bf16 v[12:15], a[72:75], v[28:31], v[12:15]
    s_mov_b32 m0, s40
    s_nop 0
    buffer_load_dwordx4 v2, s[4:7], s41 offen sc1 lds
    v_mfma_f32_16x16x32_bf16 v[20:23], a[152:155], v[28:31], v[20:23]
    s_waitcnt lgkmcnt(0)
    v_mfma_f32_16x16x32_bf16 v[8:11], a[76:79], v[32:35], v[8:11]
    v_mfma_f32_16x16x32_bf16 v[16:19], a[156:159], v[32:35], v[16:19]
    v_mfma_f32_16x16x32_bf16 v[12:15], a[76:79], v[36:39], v[12:15]
    v_mfma_f32_16x16x32_bf16 v[20:23], a[156:159], v[36:39], v[20:23]
    s_nop 7
    v_cvt_pk_bf16_f32 v48, v8, v9
    v_cvt_pk_bf16_f32 v49, v10, v11
    v_cvt_pk_bf16_f32 v50, v16, v17
    v_cvt_pk_bf16_f32 v51, v18, v19
    ds_write_b128 v59, v[48:51] offset:0
    v_cvt_pk_bf16_f32 v52, v12, v13
    v_cvt_pk_bf16_f32 v53, v14, v15
    v_cvt_pk_bf16_f32 v54, v20, v21
    v_cvt_pk_bf16_f32 v55, v22, v23
    ds_write_b128 v59, v[52:55] offset:1024
    s_waitcnt vmcnt(0) lgkmcnt(0)
    s_barrier
    s_cmp_lg_u32 s28, 0
    s_cbranch_scc1 fp_74
    s_lshl_b32 s34, s29, 7
    s_add_u32 s34, s34, 0x6460000
    v_mov_b32 v48, s31
    v_mov_b32 v49, 0
    s_mov_b64 exec, 1
    buffer_store_dword v48, v49, s[4:7], s34 offen sc1
    s_mov_b64 exec, -1
fp_74:
    ds_read_b128 v[140:143], v60 offset:0
    ds_read_b128 v[144:147], v60 offset:2048
    ds_read_b128 v[148:151], v60 offset:4096
    ds_read_b128 v[152:155], v60 offset:6144
fw_75:
    buffer_load_dword v48, v65, s[4:7], 0 offen sc1
    s_waitcnt vmcnt(0)
    v_cmp_gt_u32 vcc, s51, v48
    s_sub_u32 s33, s33, 1
    s_cbranch_scc1 END
    s_cbranch_vccz fd_76
    s_sleep 1
    s_branch fw_75
fd_76:
    s_lshr_b32 s36, s48, 2
    s_add_u32 s35, s36, 0x5800000
    buffer_load_dwordx4 v[100:103], v61, s[4:7], s35 offen offset:0 sc1
    buffer_load_dwordx4 v[104:107], v61, s[4:7], s35 offen offset:512 sc1
    buffer_load_dwordx4 v[108:111], v61, s[4:7], s35 offen offset:1024 sc1
    buffer_load_dwordx4 v[112:115], v61, s[4:7], s35 offen offset:1536 sc1
    s_add_u32 s35, s36, 0x5c00000
    buffer_load_dwordx2 v[132:133], v63, s[4:7], s35 offen offset:0 sc1
    buffer_load_dwordx2 v[134:135], v63, s[4:7], s35 offen offset:64 sc1
    buffer_load_dwordx2 v[136:137], v63, s[4:7], s35 offen offset:512 sc1
    buffer_load_dwordx2 v[138:139], v63, s[4:7], s35 offen offset:576 sc1
    s_waitcnt vmcnt(0) lgkmcnt(0)
    v_mfma_f32_16x16x32_bf16 v[160:163], v[100:103], v[140:143], 0
    v_mfma_f32_16x16x32_bf16 v[164:167], v[68:71], v[140:143], 0
    v_mfma_f32_16x16x32_bf16 v[168:171], v[72:75], v[140:143], 0
    v_mfma_f32_16x16x32_bf16 v[160:163], v[104:107], v[144:147], v[160:163]
    v_mfma_f32_16x16x32_bf16 v[164:167], v[76:79], v[144:147], v[164:167]
    v_mfma_f32_16x16x32_bf16 v[168:171], v[80:83], v[144:147], v[168:171]
    v_mfma_f32_16x16x32_bf16 v[160:163], v[108:111], v[148:151], v[160:163]
    v_mfma_f32_16x16x32_bf16 v[164:167], v[84:87], v[148:151], v[164:167]
    v_mfma_f32_16x16x32_bf16 v[168:171], v[88:91], v[148:151], v[168:171]
    v_mfma_f32_16x16x32_bf16 v[160:163], v[112:115], v[152:155], v[160:163]
    v_mfma_f32_16x16x32_bf16 v[164:167], v[92:95], v[152:155], v[164:167]
    v_mfma_f32_16x16x32_bf16 v[168:171], v[96:99], v[152:155], v[168:171]
    s_nop 7
    v_cndmask_b32 v164, v66, v164, s[60:61]
    v_cndmask_b32 v165, v66, v165, s[62:63]
    v_cndmask_b32 v166, v66, v166, s[64:65]
    v_cndmask_b32 v167, v66, v167, s[66:67]
    v_cndmask_b32 v168, v66, v168, s[68:69]
    v_cndmask_b32 v169, v66, v169, s[70:71]
    v_cndmask_b32 v170, v66, v170, s[72:73]
    v_cndmask_b32 v171, v66, v171, s[74:75]
    v_max3_f32 v180, v160, v161, v162
    v_max3_f32 v181, v163, v164, v165
    v_max3_f32 v182, v166, v167, v168
    v_max3_f32 v183, v169, v170, v171
    v_max3_f32 v180, v180, v181, v182
    v_max_f32 v180, v180, v183
    v_mov_b32 v181, v180
    s_nop 1
    v_permlane16_swap_b32 v180, v181
    s_nop 0
    v_max_f32 v180, v180, v181
    v_mov_b32 v181, v180
    s_nop 1
    v_permlane32_swap_b32 v180, v181
    s_nop 0
    v_max_f32 v180, v180, v181
    v_mul_f32 v180, s55, v180
    v_fma_f32 v160, v160, s55, -v180
    v_fma_f32 v161, v161, s55, -v180
    v_fma_f32 v162, v162, s55, -v180
    v_fma_f32 v163, v163, s55, -v180
    v_fma_f32 v164, v164, s55, -v180
    v_fma_f32 v165, v165, s55, -v180
    v_fma_f32 v166, v166, s55, -v180
    v_fma_f32 v167, v167, s55, -v180
    v_fma_f32 v168, v168, s55, -v180
    v_fma_f32 v169, v169, s55, -v180
    v_fma_f32 v170, v170, s55, -v180
    v_fma_f32 v171, v171, s55, -v180
    v_exp_f32 v160, v160
    v_exp_f32 v161, v161
    v_exp_f32 v162, v162
    v_exp_f32 v163, v163
    v_exp_f32 v164, v164
    v_exp_f32 v165, v165
    v_exp_f32 v166, v166
    v_exp_f32 v167, v167
    v_exp_f32 v168, v168
    v_exp_f32 v169, v169
    v_exp_f32 v170, v170
    v_exp_f32 v171, v171
    s_nop 0
    v_cndmask_b32 v160, 0, v160, s[56:57]
    v_cndmask_b32 v161, 0, v161, s[56:57]
    v_cndmask_b32 v162, 0, v162, s[56:57]
    v_cndmask_b32 v163, 0, v163, s[56:57]
    v_cvt_pk_bf16_f32 v176, v164, v165
    v_cvt_pk_bf16_f32 v177, v166, v167
    v_cvt_pk_bf16_f32 v178, v168, v169
    v_cvt_pk_bf16_f32 v179, v170, v171
    v_cvt_pk_bf16_f32 v172, v160, v161
    v_cvt_pk_bf16_f32 v173, v162, v163
    s_nop 1
    v_mfma_f32_16x16x32_bf16 v[184:187], v[116:119], v[176:179], 0
    v_mfma_f32_16x16x32_bf16 v[188:191], v[120:123], v[176:179], 0
    v_mfma_f32_16x16x32_bf16 v[192:195], v[124:127], v[176:179], 0
    v_mfma_f32_16x16x32_bf16 v[196:199], v[128:131], v[176:179], 0
    v_add_f32 v181, v160, v161
    v_add_f32 v182, v162, v163
    v_add_f32 v183, v164, v165
    v_add_f32 v180, v166, v167
    v_add_f32 v181, v181, v182
    v_add_f32 v183, v183, v180
    v_add_f32 v182, v168, v169
    v_add_f32 v180, v170, v171
    v_add_f32 v181, v181, v183
    v_add_f32 v182, v182, v180
    v_add_f32 v181, v181, v182
    v_mov_b32 v180, v181
    s_nop 1
    v_permlane16_swap_b32 v181, v180
    s_nop 0
    v_add_f32 v181, v181, v180
    v_mov_b32 v180, v181
    s_nop 1
    v_permlane32_swap_b32 v181, v180
    s_nop 0
    v_add_f32 v181, v181, v180
    v_rcp_f32 v181, v181
    v_mfma_f32_16x16x16_bf16 v[184:187], v[132:133], v[172:173], v[184:187]
    v_mfma_f32_16x16x16_bf16 v[188:191], v[134:135], v[172:173], v[188:191]
    v_mfma_f32_16x16x16_bf16 v[192:195], v[136:137], v[172:173], v[192:195]
    v_mfma_f32_16x16x16_bf16 v[196:199], v[138:139], v[172:173], v[196:199]
    s_add_u32 s35, s48, 0x2400000
    s_nop 7
    v_mul_f32 v184, v184, v181
    v_mul_f32 v185, v185, v181
    v_mul_f32 v186, v186, v181
    v_mul_f32 v187, v187, v181
    v_mul_f32 v188, v188, v181
    v_mul_f32 v189, v189, v181
    v_mul_f32 v190, v190, v181
    v_mul_f32 v191, v191, v181
    v_mul_f32 v192, v192, v181
    v_mul_f32 v193, v193, v181
    v_mul_f32 v194, v194, v181
    v_mul_f32 v195, v195, v181
    v_mul_f32 v196, v196, v181
    v_mul_f32 v197, v197, v181
    v_mul_f32 v198, v198, v181
    v_mul_f32 v199, v199, v181
    v_cvt_pk_bf16_f32 v48, v184, v185
    v_cvt_pk_bf16_f32 v49, v186, v187
    v_cvt_pk_bf16_f32 v50, v188, v189
    v_cvt_pk_bf16_f32 v51, v190, v191
    buffer_store_dwordx4 v[48:51], v64, s[4:7], s35 offen offset:0 sc1
    v_cvt_pk_bf16_f32 v52, v192, v193
    v_cvt_pk_bf16_f32 v53, v194, v195
    v_cvt_pk_bf16_f32 v54, v196, v197
    v_cvt_pk_bf16_f32 v55, v198, v199
    buffer_store_dwordx4 v[52:55], v64, s[4:7], s35 offen offset:2048 sc1
    s_barrier
    s_mov_b32 s31, s51
    s_mov_b32 s50, s52
    s_cmp_lt_u32 s31, 64
    s_cbranch_scc1 QA_67
    s_waitcnt vmcnt(0)
    s_barrier
    s_cmp_lg_u32 s28, 0
    s_cbranch_scc1 fp_77
    s_lshl_b32 s34, s29, 7
    s_add_u32 s34, s34, 0x6460000
    v_mov_b32 v48, s31
    v_mov_b32 v49, 0
    s_mov_b64 exec, 1
    buffer_store_dword v48, v49, s[4:7], s34 offen sc1
    s_mov_b64 exec, -1
fp_77:
    s_branch END
ROLE_OP:
    s_sub_u32 s42, s29, 160
    s_load_dwordx2 s[20:21], s[0:1], 0
    s_mov_b32 s22, 0x280000
    s_mov_b32 s23, 0x20000
    s_load_dwordx2 s[8:9], s[0:1], 40
    s_mov_b32 s10, 0x500000
    s_mov_b32 s11, 0x20000
    s_waitcnt lgkmcnt(0)
    s_cmp_ge_u32 s42, 32
    s_cbranch_scc1 noln_78
    s_add_u32 s52, s42, 32
    v_lshrrev_b32 v2, 3, v0
    v_and_b32 v3, 7, v0
    v_bfe_u32 v4, v2, 2, 2
    v_lshlrev_b32 v4, 3, v4
    v_lshrrev_b32 v5, 4, v2
    v_lshl_add_u32 v4, v5, 2, v4
    v_and_b32 v5, 3, v2
    v_add_u32 v4, v4, v5
    s_mul_i32 s35, s52, 40960
    s_mov_b32 s34, 1280
    v_mul_lo_u32 v4, v4, s34
    v_lshl_add_u32 v4, v3, 4, v4
    buffer_load_dwordx4 v[8:11], v4, s[20:23], s35 offen offset:0
    buffer_load_dwordx4 v[12:15], v4, s[20:23], s35 offen offset:128
    buffer_load_dwordx4 v[16:19], v4, s[20:23], s35 offen offset:256
    buffer_load_dwordx4 v[20:23], v4, s[20:23], s35 offen offset:384
    buffer_load_dwordx4 v[24:27], v4, s[20:23], s35 offen offset:512
    buffer_load_dwordx4 v[28:31], v4, s[20:23], s35 offen offset:640
    buffer_load_dwordx4 v[32:35], v4, s[20:23], s35 offen offset:768
    buffer_load_dwordx4 v[36:39], v4, s[20:23], s35 offen offset:896
    buffer_load_dwordx4 v[40:43], v4, s[20:23], s35 offen offset:1024
    buffer_load_dwordx4 v[44:47], v4, s[20:23], s35 offen offset:1152
    v_lshlrev_b32 v5, 9, v3
    v_lshl_add_u32 v5, v2, 4, v5
    s_add_u32 s35, s35, 0x0
    s_waitcnt vmcnt(0)
    v_and_b32 v49, 0xffff0000, v8
    v_lshlrev_b32 v48, 16, v8
    v_and_b32 v51, 0xffff0000, v9
    v_lshlrev_b32 v50, 16, v9
    v_and_b32 v53, 0xffff0000, v10
    v_lshlrev_b32 v52, 16, v10
    v_and_b32 v55, 0xffff0000, v11
    v_lshlrev_b32 v54, 16, v11
    v_and_b32 v57, 0xffff0000, v12
    v_lshlrev_b32 v56, 16, v12
    v_and_b32 v59, 0xffff0000, v13
    v_lshlrev_b32 v58, 16, v13
    v_and_b32 v61, 0xffff0000, v14
    v_lshlrev_b32 v60, 16, v14
    v_and_b32 v63, 0xffff0000, v15
    v_lshlrev_b32 v62, 16, v15
    v_and_b32 v65, 0xffff0000, v16
    v_lshlrev_b32 v64, 16, v16
    v_and_b32 v67, 0xffff0000, v17
    v_lshlrev_b32 v66, 16, v17
    v_and_b32 v69, 0xffff0000, v18
    v_lshlrev_b32 v68, 16, v18
    v_and_b32 v71, 0xffff0000, v19
    v_lshlrev_b32 v70, 16, v19
    v_and_b32 v73, 0xffff0000, v20
    v_lshlrev_b32 v72, 16, v20
    v_and_b32 v75, 0xffff0000, v21
    v_lshlrev_b32 v74, 16, v21
    v_and_b32 v77, 0xffff0000, v22
    v_lshlrev_b32 v76, 16, v22
    v_and_b32 v79, 0xffff0000, v23
    v_lshlrev_b32 v78, 16, v23
    v_and_b32 v81, 0xffff0000, v24
    v_lshlrev_b32 v80, 16, v24
    v_and_b32 v83, 0xffff0000, v25
    v_lshlrev_b32 v82, 16, v25
    v_and_b32 v85, 0xffff0000, v26
    v_lshlrev_b32 v84, 16, v26
    v_and_b32 v87, 0xffff0000, v27
    v_lshlrev_b32 v86, 16, v27
    v_and_b32 v89, 0xffff0000, v28
    v_lshlrev_b32 v88, 16, v28
    v_and_b32 v91, 0xffff0000, v29
    v_lshlrev_b32 v90, 16, v29
    v_and_b32 v93, 0xffff0000, v30
    v_lshlrev_b32 v92, 16, v30
    v_and_b32 v95, 0xffff0000, v31
    v_lshlrev_b32 v94, 16, v31
    v_and_b32 v97, 0xffff0000, v32
    v_lshlrev_b32 v96, 16, v32
    v_and_b32 v99, 0xffff0000, v33
    v_lshlrev_b32 v98, 16, v33
    v_and_b32 v101, 0xffff0000, v34
    v_lshlrev_b32 v100, 16, v34
    v_and_b32 v103, 0xffff0000, v35
    v_lshlrev_b32 v102, 16, v35
    v_and_b32 v105, 0xffff0000, v36
    v_lshlrev_b32 v104, 16, v36
    v_and_b32 v107, 0xffff0000, v37
    v_lshlrev_b32 v106, 16, v37
    v_and_b32 v109, 0xffff0000, v38
    v_lshlrev_b32 v108, 16, v38
    v_and_b32 v111, 0xffff0000, v39
    v_lshlrev_b32 v110, 16, v39
    v_and_b32 v113, 0xffff0000, v40
    v_lshlrev_b32 v112, 16, v40
    v_and_b32 v115, 0xffff0000, v41
    v_lshlrev_b32 v114, 16, v41
    v_and_b32 v117, 0xffff0000, v42
    v_lshlrev_b32 v116, 16, v42
    v_and_b32 v119, 0xffff0000, v43
    v_lshlrev_b32 v118, 16, v43
    v_and_b32 v121, 0xffff0000, v44
    v_lshlrev_b32 v120, 16, v44
    v_and_b32 v123, 0xffff0000, v45
    v_lshlrev_b32 v122, 16, v45
    v_and_b32 v125, 0xffff0000, v46
    v_lshlrev_b32 v124, 16, v46
    v_and_b32 v127, 0xffff0000, v47
    v_lshlrev_b32 v126, 16, v47
    v_add_f32 v128, v48, v52
    v_add_f32 v129, v49, v53
    v_add_f32 v130, v50, v54
    v_add_f32 v131, v51, v55
    v_add_f32 v128, v128, v56
    v_add_f32 v129, v129, v57
    v_add_f32 v130, v130, v58
    v_add_f32 v131, v131, v59
    v_add_f32 v128, v128, v60
    v_add_f32 v129, v129, v61
    v_add_f32 v130, v130, v62
    v_add_f32 v131, v131, v63
    v_add_f32 v128, v128, v64
    v_add_f32 v129, v129, v65
    v_add_f32 v130, v130, v66
    v_add_f32 v131, v131, v67
    v_add_f32 v128, v128, v68
    v_add_f32 v129, v129, v69
    v_add_f32 v130, v130, v70
    v_add_f32 v131, v131, v71
    v_add_f32 v128, v128, v72
    v_add_f32 v129, v129, v73
    v_add_f32 v130, v130, v74
    v_add_f32 v131, v131, v75
    v_add_f32 v128, v128, v76
    v_add_f32 v129, v129, v77
    v_add_f32 v130, v130, v78
    v_add_f32 v131, v131, v79
    v_add_f32 v128, v128, v80
    v_add_f32 v129, v129, v81
    v_add_f32 v130, v130, v82
    v_add_f32 v131, v131, v83
    v_add_f32 v128, v128, v84
    v_add_f32 v129, v129, v85
    v_add_f32 v130, v130, v86
    v_add_f32 v131, v131, v87
    v_add_f32 v128, v128, v88
    v_add_f32 v129, v129, v89
    v_add_f32 v130, v130, v90
    v_add_f32 v131, v131, v91
    v_add_f32 v128, v128, v92
    v_add_f32 v129, v129, v93
    v_add_f32 v130, v130, v94
    v_add_f32 v131, v131, v95
    v_add_f32 v128, v128, v96
    v_add_f32 v129, v129, v97
    v_add_f32 v130, v130, v98
    v_add_f32 v131, v131, v99
    v_add_f32 v128, v128, v100
    v_add_f32 v129, v129, v101
    v_add_f32 v130, v130, v102
    v_add_f32 v131, v131, v103
    v_add_f32 v128, v128, v104
    v_add_f32 v129, v129, v105
    v_add_f32 v130, v130, v106
    v_add_f32 v131, v131, v107
    v_add_f32 v128, v128, v108
    v_add_f32 v129, v129, v109
    v_add_f32 v130, v130, v110
    v_add_f32 v131, v131, v111
    v_add_f32 v128, v128, v112
    v_add_f32 v129, v129, v113
    v_add_f32 v130, v130, v114
    v_add_f32 v131, v131, v115
    v_add_f32 v128, v128, v116
    v_add_f32 v129, v129, v117
    v_add_f32 v130, v130, v118
    v_add_f32 v131, v131, v119
    v_add_f32 v128, v128, v120
    v_add_f32 v129, v129, v121
    v_add_f32 v130, v130, v122
    v_add_f32 v131, v131, v123
    v_add_f32 v128, v128, v124
    v_add_f32 v129, v129, v125
    v_add_f32 v130, v130, v126
    v_add_f32 v131, v131, v127
    v_add_f32 v128, v128, v129
    v_add_f32 v130, v130, v131
    v_add_f32 v128, v128, v130
    s_nop 1
    v_add_f32_dpp v128, v128, v128 quad_perm:[1,0,3,2] row_mask:0xf bank_mask:0xf
    s_nop 1
    v_add_f32_dpp v128, v128, v128 quad_perm:[2,3,0,1] row_mask:0xf bank_mask:0xf
    s_nop 1
    v_add_f32_dpp v128, v128, v128 row_half_mirror row_mask:0xf bank_mask:0xf
    s_nop 1
    s_mov_b32 s36, 0x3acccccd
    v_mul_f32 v128, s36, v128
    v_sub_f32 v133, v48, v128
    v_mul_f32 v129, v133, v133
    v_sub_f32 v133, v49, v128
    v_mul_f32 v130, v133, v133
    v_sub_f32 v133, v50, v128
    v_mul_f32 v131, v133, v133
    v_sub_f32 v133, v51, v128
    v_mul_f32 v132, v133, v133
    v_sub_f32 v133, v52, v128
    v_fmac_f32 v129, v133, v133
    v_sub_f32 v133, v53, v128
    v_fmac_f32 v130, v133, v133
    v_sub_f32 v133, v54, v128
    v_fmac_f32 v131, v133, v133
    v_sub_f32 v133, v55, v128
    v_fmac_f32 v132, v133, v133
    v_sub_f32 v133, v56, v128
    v_fmac_f32 v129, v133, v133
    v_sub_f32 v133, v57, v128
    v_fmac_f32 v130, v133, v133
    v_sub_f32 v133, v58, v128
    v_fmac_f32 v131, v133, v133
    v_sub_f32 v133, v59, v128
    v_fmac_f32 v132, v133, v133
    v_sub_f32 v133, v60, v128
    v_fmac_f32 v129, v133, v133
    v_sub_f32 v133, v61, v128
    v_fmac_f32 v130, v133, v133
    v_sub_f32 v133, v62, v128
    v_fmac_f32 v131, v133, v133
    v_sub_f32 v133, v63, v128
    v_fmac_f32 v132, v133, v133
    v_sub_f32 v133, v64, v128
    v_fmac_f32 v129, v133, v133
    v_sub_f32 v133, v65, v128
    v_fmac_f32 v130, v133, v133
    v_sub_f32 v133, v66, v128
    v_fmac_f32 v131, v133, v133
    v_sub_f32 v133, v67, v128
    v_fmac_f32 v132, v133, v133
    v_sub_f32 v133, v68, v128
    v_fmac_f32 v129, v133, v133
    v_sub_f32 v133, v69, v128
    v_fmac_f32 v130, v133, v133
    v_sub_f32 v133, v70, v128
    v_fmac_f32 v131, v133, v133
    v_sub_f32 v133, v71, v128
    v_fmac_f32 v132, v133, v133
    v_sub_f32 v133, v72, v128
    v_fmac_f32 v129, v133, v133
    v_sub_f32 v133, v73, v128
    v_fmac_f32 v130, v133, v133
    v_sub_f32 v133, v74, v128
    v_fmac_f32 v131, v133, v133
    v_sub_f32 v133, v75, v128
    v_fmac_f32 v132, v133, v133
    v_sub_f32 v133, v76, v128
    v_fmac_f32 v129, v133, v133
    v_sub_f32 v133, v77, v128
    v_fmac_f32 v130, v133, v133
    v_sub_f32 v133, v78, v128
    v_fmac_f32 v131, v133, v133
    v_sub_f32 v133, v79, v128
    v_fmac_f32 v132, v133, v133
    v_sub_f32 v133, v80, v128
    v_fmac_f32 v129, v133, v133
    v_sub_f32 v133, v81, v128
    v_fmac_f32 v130, v133, v133
    v_sub_f32 v133, v82, v128
    v_fmac_f32 v131, v133, v133
    v_sub_f32 v133, v83, v128
    v_fmac_f32 v132, v133, v133
    v_sub_f32 v133, v84, v128
    v_fmac_f32 v129, v133, v133
    v_sub_f32 v133, v85, v128
    v_fmac_f32 v130, v133, v133
    v_sub_f32 v133, v86, v128
    v_fmac_f32 v131, v133, v133
    v_sub_f32 v133, v87, v128
    v_fmac_f32 v132, v133, v133
    v_sub_f32 v133, v88, v128
    v_fmac_f32 v129, v133, v133
    v_sub_f32 v133, v89, v128
    v_fmac_f32 v130, v133, v133
    v_sub_f32 v133, v90, v128
    v_fmac_f32 v131, v133, v133
    v_sub_f32 v133, v91, v128
    v_fmac_f32 v132, v133, v133
    v_sub_f32 v133, v92, v128
    v_fmac_f32 v129, v133, v133
    v_sub_f32 v133, v93, v128
    v_fmac_f32 v130, v133, v133
    v_sub_f32 v133, v94, v128
    v_fmac_f32 v131, v133, v133
    v_sub_f32 v133, v95, v128
    v_fmac_f32 v132, v133, v133
    v_sub_f32 v133, v96, v128
    v_fmac_f32 v129, v133, v133
    v_sub_f32 v133, v97, v128
    v_fmac_f32 v130, v133, v133
    v_sub_f32 v133, v98, v128
    v_fmac_f32 v131, v133, v133
    v_sub_f32 v133, v99, v128
    v_fmac_f32 v132, v133, v133
    v_sub_f32 v133, v100, v128
    v_fmac_f32 v129, v133, v133
    v_sub_f32 v133, v101, v128
    v_fmac_f32 v130, v133, v133
    v_sub_f32 v133, v102, v128
    v_fmac_f32 v131, v133, v133
    v_sub_f32 v133, v103, v128
    v_fmac_f32 v132, v133, v133
    v_sub_f32 v133, v104, v128
    v_fmac_f32 v129, v133, v133
    v_sub_f32 v133, v105, v128
    v_fmac_f32 v130, v133, v133
    v_sub_f32 v133, v106, v128
    v_fmac_f32 v131, v133, v133
    v_sub_f32 v133, v107, v128
    v_fmac_f32 v132, v133, v133
    v_sub_f32 v133, v108, v128
    v_fmac_f32 v129, v133, v133
    v_sub_f32 v133, v109, v128
    v_fmac_f32 v130, v133, v133
    v_sub_f32 v133, v110, v128
    v_fmac_f32 v131, v133, v133
    v_sub_f32 v133, v111, v128
    v_fmac_f32 v132, v133, v133
    v_sub_f32 v133, v112, v128
    v_fmac_f32 v129, v133, v133
    v_sub_f32 v133, v113, v128
    v_fmac_f32 v130, v133, v133
    v_sub_f32 v133, v114, v128
    v_fmac_f32 v131, v133, v133
    v_sub_f32 v133, v115, v128
    v_fmac_f32 v132, v133, v133
    v_sub_f32 v133, v116, v128
    v_fmac_f32 v129, v133, v133
    v_sub_f32 v133, v117, v128
    v_fmac_f32 v130, v133, v133
    v_sub_f32 v133, v118, v128
    v_fmac_f32 v131, v133, v133
    v_sub_f32 v133, v119, v128
    v_fmac_f32 v132, v133, v133
    v_sub_f32 v133, v120, v128
    v_fmac_f32 v129, v133, v133
    v_sub_f32 v133, v121, v128
    v_fmac_f32 v130, v133, v133
    v_sub_f32 v133, v122, v128
    v_fmac_f32 v131, v133, v133
    v_sub_f32 v133, v123, v128
    v_fmac_f32 v132, v133, v133
    v_sub_f32 v133, v124, v128
    v_fmac_f32 v129, v133, v133
    v_sub_f32 v133, v125, v128
    v_fmac_f32 v130, v133, v133
    v_sub_f32 v133, v126, v128
    v_fmac_f32 v131, v133, v133
    v_sub_f32 v133, v127, v128
    v_fmac_f32 v132, v133, v133
    v_add_f32 v129, v129, v130
    v_add_f32 v131, v131, v132
    v_add_f32 v129, v129, v131
    s_nop 1
    v_add_f32_dpp v129, v129, v129 quad_perm:[1,0,3,2] row_mask:0xf bank_mask:0xf
    s_nop 1
    v_add_f32_dpp v129, v129, v129 quad_perm:[2,3,0,1] row_mask:0xf bank_mask:0xf
    s_nop 1
    v_add_f32_dpp v129, v129, v129 row_half_mirror row_mask:0xf bank_mask:0xf
    s_nop 1
    v_mul_f32 v129, s36, v129
    v_cvt_pk_bf16_f32 v130, v128, v129
    v_and_b32 v129, 0xffff0000, v130
    v_lshlrev_b32 v128, 16, v130
    v_add_f32 v129, 0x3727c5ac, v129
    v_cvt_pk_bf16_f32 v129, v129, v129
    v_lshlrev_b32 v129, 16, v129
    v_sqrt_f32 v129, v129
    s_nop 0
    v_cvt_pk_bf16_f32 v129, v129, v129
    v_lshlrev_b32 v129, 16, v129
    v_rcp_f32 v129, v129
    s_nop 0
    v_sub_f32 v48, v48, v128
    v_sub_f32 v49, v49, v128
    v_cvt_pk_bf16_f32 v131, v48, v49
    v_and_b32 v49, 0xffff0000, v131
    v_lshlrev_b32 v48, 16, v131
    v_mul_f32 v48, v48, v129
    v_mul_f32 v49, v49, v129
    v_cvt_pk_bf16_f32 v8, v48, v49
    v_sub_f32 v50, v50, v128
    v_sub_f32 v51, v51, v128
    v_cvt_pk_bf16_f32 v131, v50, v51
    v_and_b32 v51, 0xffff0000, v131
    v_lshlrev_b32 v50, 16, v131
    v_mul_f32 v50, v50, v129
    v_mul_f32 v51, v51, v129
    v_cvt_pk_bf16_f32 v9, v50, v51
    v_sub_f32 v52, v52, v128
    v_sub_f32 v53, v53, v128
    v_cvt_pk_bf16_f32 v131, v52, v53
    v_and_b32 v53, 0xffff0000, v131
    v_lshlrev_b32 v52, 16, v131
    v_mul_f32 v52, v52, v129
    v_mul_f32 v53, v53, v129
    v_cvt_pk_bf16_f32 v10, v52, v53
    v_sub_f32 v54, v54, v128
    v_sub_f32 v55, v55, v128
    v_cvt_pk_bf16_f32 v131, v54, v55
    v_and_b32 v55, 0xffff0000, v131
    v_lshlrev_b32 v54, 16, v131
    v_mul_f32 v54, v54, v129
    v_mul_f32 v55, v55, v129
    v_cvt_pk_bf16_f32 v11, v54, v55
    v_sub_f32 v56, v56, v128
    v_sub_f32 v57, v57, v128
    v_cvt_pk_bf16_f32 v131, v56, v57
    v_and_b32 v57, 0xffff0000, v131
    v_lshlrev_b32 v56, 16, v131
    v_mul_f32 v56, v56, v129
    v_mul_f32 v57, v57, v129
    v_cvt_pk_bf16_f32 v12, v56, v57
    v_sub_f32 v58, v58, v128
    v_sub_f32 v59, v59, v128
    v_cvt_pk_bf16_f32 v131, v58, v59
    v_and_b32 v59, 0xffff0000, v131
    v_lshlrev_b32 v58, 16, v131
    v_mul_f32 v58, v58, v129
    v_mul_f32 v59, v59, v129
    v_cvt_pk_bf16_f32 v13, v58, v59
    v_sub_f32 v60, v60, v128
    v_sub_f32 v61, v61, v128
    v_cvt_pk_bf16_f32 v131, v60, v61
    v_and_b32 v61, 0xffff0000, v131
    v_lshlrev_b32 v60, 16, v131
    v_mul_f32 v60, v60, v129
    v_mul_f32 v61, v61, v129
    v_cvt_pk_bf16_f32 v14, v60, v61
    v_sub_f32 v62, v62, v128
    v_sub_f32 v63, v63, v128
    v_cvt_pk_bf16_f32 v131, v62, v63
    v_and_b32 v63, 0xffff0000, v131
    v_lshlrev_b32 v62, 16, v131
    v_mul_f32 v62, v62, v129
    v_mul_f32 v63, v63, v129
    v_cvt_pk_bf16_f32 v15, v62, v63
    v_sub_f32 v64, v64, v128
    v_sub_f32 v65, v65, v128
    v_cvt_pk_bf16_f32 v131, v64, v65
    v_and_b32 v65, 0xffff0000, v131
    v_lshlrev_b32 v64, 16, v131
    v_mul_f32 v64, v64, v129
    v_mul_f32 v65, v65, v129
    v_cvt_pk_bf16_f32 v16, v64, v65
    v_sub_f32 v66, v66, v128
    v_sub_f32 v67, v67, v128
    v_cvt_pk_bf16_f32 v131, v66, v67
    v_and_b32 v67, 0xffff0000, v131
    v_lshlrev_b32 v66, 16, v131
    v_mul_f32 v66, v66, v129
    v_mul_f32 v67, v67, v129
    v_cvt_pk_bf16_f32 v17, v66, v67
    v_sub_f32 v68, v68, v128
    v_sub_f32 v69, v69, v128
    v_cvt_pk_bf16_f32 v131, v68, v69
    v_and_b32 v69, 0xffff0000, v131
    v_lshlrev_b32 v68, 16, v131
    v_mul_f32 v68, v68, v129
    v_mul_f32 v69, v69, v129
    v_cvt_pk_bf16_f32 v18, v68, v69
    v_sub_f32 v70, v70, v128
    v_sub_f32 v71, v71, v128
    v_cvt_pk_bf16_f32 v131, v70, v71
    v_and_b32 v71, 0xffff0000, v131
    v_lshlrev_b32 v70, 16, v131
    v_mul_f32 v70, v70, v129
    v_mul_f32 v71, v71, v129
    v_cvt_pk_bf16_f32 v19, v70, v71
    v_sub_f32 v72, v72, v128
    v_sub_f32 v73, v73, v128
    v_cvt_pk_bf16_f32 v131, v72, v73
    v_and_b32 v73, 0xffff0000, v131
    v_lshlrev_b32 v72, 16, v131
    v_mul_f32 v72, v72, v129
    v_mul_f32 v73, v73, v129
    v_cvt_pk_bf16_f32 v20, v72, v73
    v_sub_f32 v74, v74, v128
    v_sub_f32 v75, v75, v128
    v_cvt_pk_bf16_f32 v131, v74, v75
    v_and_b32 v75, 0xffff0000, v131
    v_lshlrev_b32 v74, 16, v131
    v_mul_f32 v74, v74, v129
    v_mul_f32 v75, v75, v129
    v_cvt_pk_bf16_f32 v21, v74, v75
    v_sub_f32 v76, v76, v128
    v_sub_f32 v77, v77, v128
    v_cvt_pk_bf16_f32 v131, v76, v77
    v_and_b32 v77, 0xffff0000, v131
    v_lshlrev_b32 v76, 16, v131
    v_mul_f32 v76, v76, v129
    v_mul_f32 v77, v77, v129
    v_cvt_pk_bf16_f32 v22, v76, v77
    v_sub_f32 v78, v78, v128
    v_sub_f32 v79, v79, v128
    v_cvt_pk_bf16_f32 v131, v78, v79
    v_and_b32 v79, 0xffff0000, v131
    v_lshlrev_b32 v78, 16, v131
    v_mul_f32 v78, v78, v129
    v_mul_f32 v79, v79, v129
    v_cvt_pk_bf16_f32 v23, v78, v79
    v_sub_f32 v80, v80, v128
    v_sub_f32 v81, v81, v128
    v_cvt_pk_bf16_f32 v131, v80, v81
    v_and_b32 v81, 0xffff0000, v131
    v_lshlrev_b32 v80, 16, v131
    v_mul_f32 v80, v80, v129
    v_mul_f32 v81, v81, v129
    v_cvt_pk_bf16_f32 v24, v80, v81
    v_sub_f32 v82, v82, v128
    v_sub_f32 v83, v83, v128
    v_cvt_pk_bf16_f32 v131, v82, v83
    v_and_b32 v83, 0xffff0000, v131
    v_lshlrev_b32 v82, 16, v131
    v_mul_f32 v82, v82, v129
    v_mul_f32 v83, v83, v129
    v_cvt_pk_bf16_f32 v25, v82, v83
    v_sub_f32 v84, v84, v128
    v_sub_f32 v85, v85, v128
    v_cvt_pk_bf16_f32 v131, v84, v85
    v_and_b32 v85, 0xffff0000, v131
    v_lshlrev_b32 v84, 16, v131
    v_mul_f32 v84, v84, v129
    v_mul_f32 v85, v85, v129
    v_cvt_pk_bf16_f32 v26, v84, v85
    v_sub_f32 v86, v86, v128
    v_sub_f32 v87, v87, v128
    v_cvt_pk_bf16_f32 v131, v86, v87
    v_and_b32 v87, 0xffff0000, v131
    v_lshlrev_b32 v86, 16, v131
    v_mul_f32 v86, v86, v129
    v_mul_f32 v87, v87, v129
    v_cvt_pk_bf16_f32 v27, v86, v87
    v_sub_f32 v88, v88, v128
    v_sub_f32 v89, v89, v128
    v_cvt_pk_bf16_f32 v131, v88, v89
    v_and_b32 v89, 0xffff0000, v131
    v_lshlrev_b32 v88, 16, v131
    v_mul_f32 v88, v88, v129
    v_mul_f32 v89, v89, v129
    v_cvt_pk_bf16_f32 v28, v88, v89
    v_sub_f32 v90, v90, v128
    v_sub_f32 v91, v91, v128
    v_cvt_pk_bf16_f32 v131, v90, v91
    v_and_b32 v91, 0xffff0000, v131
    v_lshlrev_b32 v90, 16, v131
    v_mul_f32 v90, v90, v129
    v_mul_f32 v91, v91, v129
    v_cvt_pk_bf16_f32 v29, v90, v91
    v_sub_f32 v92, v92, v128
    v_sub_f32 v93, v93, v128
    v_cvt_pk_bf16_f32 v131, v92, v93
    v_and_b32 v93, 0xffff0000, v131
    v_lshlrev_b32 v92, 16, v131
    v_mul_f32 v92, v92, v129
    v_mul_f32 v93, v93, v129
    v_cvt_pk_bf16_f32 v30, v92, v93
    v_sub_f32 v94, v94, v128
    v_sub_f32 v95, v95, v128
    v_cvt_pk_bf16_f32 v131, v94, v95
    v_and_b32 v95, 0xffff0000, v131
    v_lshlrev_b32 v94, 16, v131
    v_mul_f32 v94, v94, v129
    v_mul_f32 v95, v95, v129
    v_cvt_pk_bf16_f32 v31, v94, v95
    v_sub_f32 v96, v96, v128
    v_sub_f32 v97, v97, v128
    v_cvt_pk_bf16_f32 v131, v96, v97
    v_and_b32 v97, 0xffff0000, v131
    v_lshlrev_b32 v96, 16, v131
    v_mul_f32 v96, v96, v129
    v_mul_f32 v97, v97, v129
    v_cvt_pk_bf16_f32 v32, v96, v97
    v_sub_f32 v98, v98, v128
    v_sub_f32 v99, v99, v128
    v_cvt_pk_bf16_f32 v131, v98, v99
    v_and_b32 v99, 0xffff0000, v131
    v_lshlrev_b32 v98, 16, v131
    v_mul_f32 v98, v98, v129
    v_mul_f32 v99, v99, v129
    v_cvt_pk_bf16_f32 v33, v98, v99
    v_sub_f32 v100, v100, v128
    v_sub_f32 v101, v101, v128
    v_cvt_pk_bf16_f32 v131, v100, v101
    v_and_b32 v101, 0xffff0000, v131
    v_lshlrev_b32 v100, 16, v131
    v_mul_f32 v100, v100, v129
    v_mul_f32 v101, v101, v129
    v_cvt_pk_bf16_f32 v34, v100, v101
    v_sub_f32 v102, v102, v128
    v_sub_f32 v103, v103, v128
    v_cvt_pk_bf16_f32 v131, v102, v103
    v_and_b32 v103, 0xffff0000, v131
    v_lshlrev_b32 v102, 16, v131
    v_mul_f32 v102, v102, v129
    v_mul_f32 v103, v103, v129
    v_cvt_pk_bf16_f32 v35, v102, v103
    v_sub_f32 v104, v104, v128
    v_sub_f32 v105, v105, v128
    v_cvt_pk_bf16_f32 v131, v104, v105
    v_and_b32 v105, 0xffff0000, v131
    v_lshlrev_b32 v104, 16, v131
    v_mul_f32 v104, v104, v129
    v_mul_f32 v105, v105, v129
    v_cvt_pk_bf16_f32 v36, v104, v105
    v_sub_f32 v106, v106, v128
    v_sub_f32 v107, v107, v128
    v_cvt_pk_bf16_f32 v131, v106, v107
    v_and_b32 v107, 0xffff0000, v131
    v_lshlrev_b32 v106, 16, v131
    v_mul_f32 v106, v106, v129
    v_mul_f32 v107, v107, v129
    v_cvt_pk_bf16_f32 v37, v106, v107
    v_sub_f32 v108, v108, v128
    v_sub_f32 v109, v109, v128
    v_cvt_pk_bf16_f32 v131, v108, v109
    v_and_b32 v109, 0xffff0000, v131
    v_lshlrev_b32 v108, 16, v131
    v_mul_f32 v108, v108, v129
    v_mul_f32 v109, v109, v129
    v_cvt_pk_bf16_f32 v38, v108, v109
    v_sub_f32 v110, v110, v128
    v_sub_f32 v111, v111, v128
    v_cvt_pk_bf16_f32 v131, v110, v111
    v_and_b32 v111, 0xffff0000, v131
    v_lshlrev_b32 v110, 16, v131
    v_mul_f32 v110, v110, v129
    v_mul_f32 v111, v111, v129
    v_cvt_pk_bf16_f32 v39, v110, v111
    v_sub_f32 v112, v112, v128
    v_sub_f32 v113, v113, v128
    v_cvt_pk_bf16_f32 v131, v112, v113
    v_and_b32 v113, 0xffff0000, v131
    v_lshlrev_b32 v112, 16, v131
    v_mul_f32 v112, v112, v129
    v_mul_f32 v113, v113, v129
    v_cvt_pk_bf16_f32 v40, v112, v113
    v_sub_f32 v114, v114, v128
    v_sub_f32 v115, v115, v128
    v_cvt_pk_bf16_f32 v131, v114, v115
    v_and_b32 v115, 0xffff0000, v131
    v_lshlrev_b32 v114, 16, v131
    v_mul_f32 v114, v114, v129
    v_mul_f32 v115, v115, v129
    v_cvt_pk_bf16_f32 v41, v114, v115
    v_sub_f32 v116, v116, v128
    v_sub_f32 v117, v117, v128
    v_cvt_pk_bf16_f32 v131, v116, v117
    v_and_b32 v117, 0xffff0000, v131
    v_lshlrev_b32 v116, 16, v131
    v_mul_f32 v116, v116, v129
    v_mul_f32 v117, v117, v129
    v_cvt_pk_bf16_f32 v42, v116, v117
    v_sub_f32 v118, v118, v128
    v_sub_f32 v119, v119, v128
    v_cvt_pk_bf16_f32 v131, v118, v119
    v_and_b32 v119, 0xffff0000, v131
    v_lshlrev_b32 v118, 16, v131
    v_mul_f32 v118, v118, v129
    v_mul_f32 v119, v119, v129
    v_cvt_pk_bf16_f32 v43, v118, v119
    v_sub_f32 v120, v120, v128
    v_sub_f32 v121, v121, v128
    v_cvt_pk_bf16_f32 v131, v120, v121
    v_and_b32 v121, 0xffff0000, v131
    v_lshlrev_b32 v120, 16, v131
    v_mul_f32 v120, v120, v129
    v_mul_f32 v121, v121, v129
    v_cvt_pk_bf16_f32 v44, v120, v121
    v_sub_f32 v122, v122, v128
    v_sub_f32 v123, v123, v128
    v_cvt_pk_bf16_f32 v131, v122, v123
    v_and_b32 v123, 0xffff0000, v131
    v_lshlrev_b32 v122, 16, v131
    v_mul_f32 v122, v122, v129
    v_mul_f32 v123, v123, v129
    v_cvt_pk_bf16_f32 v45, v122, v123
    v_sub_f32 v124, v124, v128
    v_sub_f32 v125, v125, v128
    v_cvt_pk_bf16_f32 v131, v124, v125
    v_and_b32 v125, 0xffff0000, v131
    v_lshlrev_b32 v124, 16, v131
    v_mul_f32 v124, v124, v129
    v_mul_f32 v125, v125, v129
    v_cvt_pk_bf16_f32 v46, v124, v125
    v_sub_f32 v126, v126, v128
    v_sub_f32 v127, v127, v128
    v_cvt_pk_bf16_f32 v131, v126, v127
    v_and_b32 v127, 0xffff0000, v131
    v_lshlrev_b32 v126, 16, v131
    v_mul_f32 v126, v126, v129
    v_mul_f32 v127, v127, v129
    v_cvt_pk_bf16_f32 v47, v126, v127
    buffer_store_dwordx4 v[8:11], v5, s[4:7], s35 offen sc1
    s_add_u32 s35, s35, 4096
    buffer_store_dwordx4 v[12:15], v5, s[4:7], s35 offen sc1
    s_add_u32 s35, s35, 4096
    buffer_store_dwordx4 v[16:19], v5, s[4:7], s35 offen sc1
    s_add_u32 s35, s35, 4096
    buffer_store_dwordx4 v[20:23], v5, s[4:7], s35 offen sc1
    s_add_u32 s35, s35, 4096
    buffer_store_dwordx4 v[24:27], v5, s[4:7], s35 offen sc1
    s_add_u32 s35, s35, 4096
    buffer_store_dwordx4 v[28:31], v5, s[4:7], s35 offen sc1
    s_add_u32 s35, s35, 4096
    buffer_store_dwordx4 v[32:35], v5, s[4:7], s35 offen sc1
    s_add_u32 s35, s35, 4096
    buffer_store_dwordx4 v[36:39], v5, s[4:7], s35 offen sc1
    s_add_u32 s35, s35, 4096
    buffer_store_dwordx4 v[40:43], v5, s[4:7], s35 offen sc1
    s_add_u32 s35, s35, 4096
    buffer_store_dwordx4 v[44:47], v5, s[4:7], s35 offen sc1
    s_waitcnt vmcnt(0)
    s_barrier
    s_cmp_lg_u32 s28, 0
    s_cbranch_scc1 ln_79
    s_cmp_ge_u32 s52, 2
    s_cbranch_scc1 ln_80
    s_lshl_b32 s34, s52, 7
    s_add_u32 s34, s34, 64
    v_mov_b32 v6, 1
    v_mov_b32 v7, 0
    s_mov_b64 exec, 1
    buffer_store_dword v6, v7, s[16:19], s34 offen sc1
    s_mov_b64 exec, -1
ln_80:
    v_mov_b32 v129, 36
dw_81:
    buffer_load_dword v128, v129, s[16:19], 0 offen sc1
    s_waitcnt vmcnt(0)
    v_readfirstlane_b32 s34, v128
    s_sub_u32 s33, s33, 1
    s_cbranch_scc1 END
    s_sleep 2
    s_cmp_lt_u32 s34, 192
    s_cbranch_scc1 dw_81
    s_lshl_b32 s34, s52, 7
    s_add_u32 s34, s34, 0x6460040
    v_mov_b32 v6, 1
    v_mov_b32 v7, 0
    s_mov_b64 exec, 1
    buffer_store_dword v6, v7, s[4:7], s34 offen sc1
    s_mov_b64 exec, -1
ln_79:
noln_78:
    s_cmp_lg_u32 s28, 0
    s_cbranch_scc1 w0_82
    v_mov_b32 v49, 128
dw_83:
    buffer_load_dword v48, v49, s[16:19], 0 offen sc1
    s_waitcnt vmcnt(0)
    v_readfirstlane_b32 s34, v48
    s_sub_u32 s33, s33, 1
    s_cbranch_scc1 END
    s_sleep 8
    s_cmp_lt_u32 s34, 64
    s_cbranch_scc1 dw_83
w0_82:
    s_barrier
    s_mul_i32 s34, s42, 6554
    s_lshr_b32 s53, s34, 16
    s_mul_i32 s34, s53, 10
    s_sub_u32 s54, s42, s34
    s_mul_i32 s46, s53, 1310720
    s_lshl_b32 s34, s54, 7
    s_add_u32 s46, s46, s34
    v_lshrrev_b32 v48, 4, v1
    v_and_b32 v49, 15, v1
    v_lshlrev_b32 v50, 1, v48
    v_xor_b32 v49, v49, v50
    s_lshr_b32 s34, s28, 1
    s_lshl_b32 s34, s34, 3
    v_xor_b32 v49, s34, v49
    v_lshrrev_b32 v50, 3, v49
    v_lshlrev_b32 v50, 5, v50
    v_add_u32 v48, v48, v50
    v_and_b32 v49, 7, v49
    s_mov_b32 s34, 1280
    v_mul_lo_u32 v48, v48, s34
    v_lshlrev_b32 v49, 4, v49
    v_add_u32 v5, v48, v49
    s_mul_i32 s41, s28, 5120
    s_add_u32 s41, s41, s46
    s_lshl_b32 s40, s28, 10
    s_add_u32 s40, s40, 0
    s_mov_b32 m0, s40
    s_nop 0
    buffer_load_dwordx4 v5, s[8:11], s41 offen lds
    s_add_u32 s40, s40, 4096
    s_add_u32 s41, s41, 20480
    s_mov_b32 m0, s40
    s_nop 0
    buffer_load_dwordx4 v5, s[8:11], s41 offen lds
    s_add_u32 s40, s40, 4096
    s_add_u32 s41, s41, 61440
    s_mov_b32 m0, s40
    s_nop 0
    buffer_load_dwordx4 v5, s[8:11], s41 offen lds
    s_add_u32 s40, s40, 4096
    s_add_u32 s41, s41, 20480
    s_mov_b32 m0, s40
    s_nop 0
    buffer_load_dwordx4 v5, s[8:11], s41 offen lds
    s_add_u32 s40, s40, 4096
    s_add_u32 s41, s41, 61440
    s_mov_b32 m0, s40
    s_nop 0
    buffer_load_dwordx4 v5, s[8:11], s41 offen lds
    s_add_u32 s40, s40, 4096
    s_add_u32 s41, s41, 20480
    s_mov_b32 m0, s40
    s_nop 0
    buffer_load_dwordx4 v5, s[8:11], s41 offen lds
    s_add_u32 s40, s40, 4096
    s_add_u32 s41, s41, 61440
    s_mov_b32 m0, s40
    s_nop 0
    buffer_load_dwordx4 v5, s[8:11], s41 offen lds
    s_add_u32 s40, s40, 4096
    s_add_u32 s41, s41, 20480
    s_mov_b32 m0, s40
    s_nop 0
    buffer_load_dwordx4 v5, s[8:11], s41 offen lds
    s_add_u32 s40, s40, 4096
    s_add_u32 s41, s41, 61440
    s_mov_b32 m0, s40
    s_nop 0
    buffer_load_dwordx4 v5, s[8:11], s41 offen lds
    s_add_u32 s40, s40, 4096
    s_add_u32 s41, s41, 20480
    s_mov_b32 m0, s40
    s_nop 0
    buffer_load_dwordx4 v5, s[8:11], s41 offen lds
    s_add_u32 s40, s40, 4096
    s_add_u32 s41, s41, 61440
    s_mov_b32 m0, s40
    s_nop 0
    buffer_load_dwordx4 v5, s[8:11], s41 offen lds
    s_add_u32 s40, s40, 4096
    s_add_u32 s41, s41, 20480
    s_mov_b32 m0, s40
    s_nop 0
    buffer_load_dwordx4 v5, s[8:11], s41 offen lds
    s_add_u32 s40, s40, 4096
    s_add_u32 s41, s41, 61440
    s_mov_b32 m0, s40
    s_nop 0
    buffer_load_dwordx4 v5, s[8:11], s41 offen lds
    s_add_u32 s40, s40, 4096
    s_add_u32 s41, s41, 20480
    s_mov_b32 m0, s40
    s_nop 0
    buffer_load_dwordx4 v5, s[8:11], s41 offen lds
    s_add_u32 s40, s40, 4096
    s_add_u32 s41, s41, 61440
    s_mov_b32 m0, s40
    s_nop 0
    buffer_load_dwordx4 v5, s[8:11], s41 offen lds
    s_add_u32 s40, s40, 4096
    s_add_u32 s41, s41, 20480
    s_mov_b32 m0, s40
    s_nop 0
    buffer_load_dwordx4 v5, s[8:11], s41 offen lds
    s_add_u32 s40, s40, 4096
    s_add_u32 s41, s41, 61440
    s_mov_b32 m0, s40
    s_nop 0
    buffer_load_dwordx4 v5, s[8:11], s41 offen lds
    s_add_u32 s40, s40, 4096
    s_add_u32 s41, s41, 20480
    s_mov_b32 m0, s40
    s_nop 0
    buffer_load_dwordx4 v5, s[8:11], s41 offen lds
    s_add_u32 s40, s40, 4096
    s_add_u32 s41, s41, 61440
    s_mov_b32 m0, s40
    s_nop 0
    buffer_load_dwordx4 v5, s[8:11], s41 offen lds
    s_add_u32 s40, s40, 4096
    s_add_u32 s41, s41, 20480
    s_mov_b32 m0, s40
    s_nop 0
    buffer_load_dwordx4 v5, s[8:11], s41 offen lds
    s_add_u32 s40, s40, 4096
    s_add_u32 s41, s41, 61440
    s_mov_b32 m0, s40
    s_nop 0
    buffer_load_dwordx4 v5, s[8:11], s41 offen lds
    s_add_u32 s40, s40, 4096
    s_add_u32 s41, s41, 20480
    s_mov_b32 m0, s40
    s_nop 0
    buffer_load_dwordx4 v5, s[8:11], s41 offen lds
    s_add_u32 s40, s40, 4096
    s_add_u32 s41, s41, 61440
    s_mov_b32 m0, s40
    s_nop 0
    buffer_load_dwordx4 v5, s[8:11], s41 offen lds
    s_add_u32 s40, s40, 4096
    s_add_u32 s41, s41, 20480
    s_mov_b32 m0, s40
    s_nop 0
    buffer_load_dwordx4 v5, s[8:11], s41 offen lds
    s_add_u32 s40, s40, 4096
    s_add_u32 s41, s41, 61440
    s_mov_b32 m0, s40
    s_nop 0
    buffer_load_dwordx4 v5, s[8:11], s41 offen lds
    s_add_u32 s40, s40, 4096
    s_add_u32 s41, s41, 20480
    s_mov_b32 m0, s40
    s_nop 0
    buffer_load_dwordx4 v5, s[8:11], s41 offen lds
    s_add_u32 s40, s40, 4096
    s_add_u32 s41, s41, 61440
    s_mov_b32 m0, s40
    s_nop 0
    buffer_load_dwordx4 v5, s[8:11], s41 offen lds
    s_add_u32 s40, s40, 4096
    s_add_u32 s41, s41, 20480
    s_mov_b32 m0, s40
    s_nop 0
    buffer_load_dwordx4 v5, s[8:11], s41 offen lds
    s_add_u32 s40, s40, 4096
    s_add_u32 s41, s41, 61440
    s_mov_b32 m0, s40
    s_nop 0
    buffer_load_dwordx4 v5, s[8:11], s41 offen lds
    s_add_u32 s40, s40, 4096
    s_add_u32 s41, s41, 20480
    s_mov_b32 m0, s40
    s_nop 0
    buffer_load_dwordx4 v5, s[8:11], s41 offen lds
    s_add_u32 s40, s40, 4096
    s_add_u32 s41, s41, 61440
    s_mov_b32 m0, s40
    s_nop 0
    buffer_load_dwordx4 v5, s[8:11], s41 offen lds
    s_add_u32 s40, s40, 4096
    s_add_u32 s41, s41, 20480
    s_mov_b32 m0, s40
    s_nop 0
    buffer_load_dwordx4 v5, s[8:11], s41 offen lds
    v_lshrrev_b32 v48, 4, v1
    v_bfe_u32 v49, v1, 2, 2
    v_and_b32 v52, 3, v1
    v_add_u32 v50, 0, v52
    v_mov_b32 v51, 0
    v_and_b32 v53, 1, v48
    v_lshl_or_b32 v53, v53, 2, v49
    v_lshlrev_b32 v53, 1, v53
    v_xor_b32 v50, v50, v53
    v_lshlrev_b32 v50, 4, v50
    v_lshl_add_u32 v50, v51, 3, v50
    v_lshl_add_u32 v50, v49, 8, v50
    v_lshl_add_u32 v8, v48, 11, v50
    v_lshrrev_b32 v48, 4, v1
    v_bfe_u32 v49, v1, 2, 2
    v_and_b32 v52, 3, v1
    v_add_u32 v50, 0, v52
    v_mov_b32 v51, 1
    v_and_b32 v53, 1, v48
    v_lshl_or_b32 v53, v53, 2, v49
    v_lshlrev_b32 v53, 1, v53
    v_xor_b32 v50, v50, v53
    v_lshlrev_b32 v50, 4, v50
    v_lshl_add_u32 v50, v51, 3, v50
    v_lshl_add_u32 v50, v49, 8, v50
    v_lshl_add_u32 v9, v48, 11, v50
    v_lshrrev_b32 v48, 4, v1
    v_bfe_u32 v49, v1, 2, 2
    v_and_b32 v52, 3, v1
    v_add_u32 v50, 4, v52
    v_mov_b32 v51, 0
    v_and_b32 v53, 1, v48
    v_lshl_or_b32 v53, v53, 2, v49
    v_lshlrev_b32 v53, 1, v53
    v_xor_b32 v50, v50, v53
    v_lshlrev_b32 v50, 4, v50
    v_lshl_add_u32 v50, v51, 3, v50
    v_lshl_add_u32 v50, v49, 8, v50
    v_lshl_add_u32 v10, v48, 11, v50
    v_lshrrev_b32 v48, 4, v1
    v_bfe_u32 v49, v1, 2, 2
    v_and_b32 v52, 3, v1
    v_add_u32 v50, 4, v52
    v_mov_b32 v51, 1
    v_and_b32 v53, 1, v48
    v_lshl_or_b32 v53, v53, 2, v49
    v_lshlrev_b32 v53, 1, v53
    v_xor_b32 v50, v50, v53
    v_lshlrev_b32 v50, 4, v50
    v_lshl_add_u32 v50, v51, 3, v50
    v_lshl_add_u32 v50, v49, 8, v50
    v_lshl_add_u32 v11, v48, 11, v50
    s_lshl_b32 s34, s28, 15
    v_add_u32 v8, s34, v8
    v_xor_b32 v12, 128, v8
    v_add_u32 v9, s34, v9
    v_xor_b32 v13, 128, v9
    v_add_u32 v10, s34, v10
    v_xor_b32 v14, 128, v10
    v_add_u32 v11, s34, v11
    v_xor_b32 v15, 128, v11
    s_waitcnt vmcnt(0)
    s_barrier
    ds_read_b64_tr_b16 a[0:1], v8 offset:0
    ds_read_b64_tr_b16 a[2:3], v8 offset:1024
    ds_read_b64_tr_b16 a[32:33], v9 offset:0
    ds_read_b64_tr_b16 a[34:35], v9 offset:1024
    ds_read_b64_tr_b16 a[64:65], v10 offset:0
    ds_read_b64_tr_b16 a[66:67], v10 offset:1024
    ds_read_b64_tr_b16 a[96:97], v11 offset:0
    ds_read_b64_tr_b16 a[98:99], v11 offset:1024
    s_waitcnt lgkmcnt(0)
    ds_read_b64_tr_b16 a[4:5], v12 offset:0
    ds_read_b64_tr_b16 a[6:7], v12 offset:1024
    ds_read_b64_tr_b16 a[36:37], v13 offset:0
    ds_read_b64_tr_b16 a[38:39], v13 offset:1024
    ds_read_b64_tr_b16 a[68:69], v14 offset:0
    ds_read_b64_tr_b16 a[70:71], v14 offset:1024
    ds_read_b64_tr_b16 a[100:101], v15 offset:0
    ds_read_b64_tr_b16 a[102:103], v15 offset:1024
    s_waitcnt lgkmcnt(0)
    ds_read_b64_tr_b16 a[8:9], v8 offset:8192
    ds_read_b64_tr_b16 a[10:11], v8 offset:9216
    ds_read_b64_tr_b16 a[40:41], v9 offset:8192
    ds_read_b64_tr_b16 a[42:43], v9 offset:9216
    ds_read_b64_tr_b16 a[72:73], v10 offset:8192
    ds_read_b64_tr_b16 a[74:75], v10 offset:9216
    ds_read_b64_tr_b16 a[104:105], v11 offset:8192
    ds_read_b64_tr_b16 a[106:107], v11 offset:9216
    s_waitcnt lgkmcnt(0)
    ds_read_b64_tr_b16 a[12:13], v12 offset:8192
    ds_read_b64_tr_b16 a[14:15], v12 offset:9216
    ds_read_b64_tr_b16 a[44:45], v13 offset:8192
    ds_read_b64_tr_b16 a[46:47], v13 offset:9216
    ds_read_b64_tr_b16 a[76:77], v14 offset:8192
    ds_read_b64_tr_b16 a[78:79], v14 offset:9216
    ds_read_b64_tr_b16 a[108:109], v15 offset:8192
    ds_read_b64_tr_b16 a[110:111], v15 offset:9216
    s_waitcnt lgkmcnt(0)
    ds_read_b64_tr_b16 a[16:17], v8 offset:16384
    ds_read_b64_tr_b16 a[18:19], v8 offset:17408
    ds_read_b64_tr_b16 a[48:49], v9 offset:16384
    ds_read_b64_tr_b16 a[50:51], v9 offset:17408
    ds_read_b64_tr_b16 a[80:81], v10 offset:16384
    ds_read_b64_tr_b16 a[82:83], v10 offset:17408
    ds_read_b64_tr_b16 a[112:113], v11 offset:16384
    ds_read_b64_tr_b16 a[114:115], v11 offset:17408
    s_waitcnt lgkmcnt(0)
    ds_read_b64_tr_b16 a[20:21], v12 offset:16384
    ds_read_b64_tr_b16 a[22:23], v12 offset:17408
    ds_read_b64_tr_b16 a[52:53], v13 offset:16384
    ds_read_b64_tr_b16 a[54:55], v13 offset:17408
    ds_read_b64_tr_b16 a[84:85], v14 offset:16384
    ds_read_b64_tr_b16 a[86:87], v14 offset:17408
    ds_read_b64_tr_b16 a[116:117], v15 offset:16384
    ds_read_b64_tr_b16 a[118:119], v15 offset:17408
    s_waitcnt lgkmcnt(0)
    ds_read_b64_tr_b16 a[24:25], v8 offset:24576
    ds_read_b64_tr_b16 a[26:27], v8 offset:25600
    ds_read_b64_tr_b16 a[56:57], v9 offset:24576
    ds_read_b64_tr_b16 a[58:59], v9 offset:25600
    ds_read_b64_tr_b16 a[88:89], v10 offset:24576
    ds_read_b64_tr_b16 a[90:91], v10 offset:25600
    ds_read_b64_tr_b16 a[120:121], v11 offset:24576
    ds_read_b64_tr_b16 a[122:123], v11 offset:25600
    s_waitcnt lgkmcnt(0)
    ds_read_b64_tr_b16 a[28:29], v12 offset:24576
    ds_read_b64_tr_b16 a[30:31], v12 offset:25600
    ds_read_b64_tr_b16 a[60:61], v13 offset:24576
    ds_read_b64_tr_b16 a[62:63], v13 offset:25600
    ds_read_b64_tr_b16 a[92:93], v14 offset:24576
    ds_read_b64_tr_b16 a[94:95], v14 offset:25600
    ds_read_b64_tr_b16 a[124:125], v15 offset:24576
    ds_read_b64_tr_b16 a[126:127], v15 offset:25600
    s_waitcnt lgkmcnt(0)
    s_barrier
    v_lshlrev_b32 v2, 4, v1
    v_lshrrev_b32 v3, 4, v1
    v_lshlrev_b32 v3, 9, v3
    v_and_b32 v4, 15, v1
    v_lshl_add_u32 v3, v4, 4, v3
    v_and_b32 v5, 7, v1
    s_lshl_b32 s34, s53, 3
    s_add_u32 s34, s34, 128
    v_add_u32 v5, s34, v5
    v_lshlrev_b32 v5, 7, v5
    v_add_u32 v5, 0x6460000, v5
    v_and_b32 v48, 15, v1
    v_lshrrev_b32 v49, 4, v1
    s_mul_i32 s34, s28, 8704
    v_mul_u32_u24 v6, 272, v48
    v_lshl_add_u32 v6, v49, 5, v6
    v_add_u32 v6, s34, v6
    v_lshrrev_b32 v48, 3, v0
    v_and_b32 v49, 7, v0
    v_mul_u32_u24 v7, 272, v48
    v_lshl_add_u32 v7, v49, 5, v7
    s_mov_b32 s34, 2560
    v_mul_lo_u32 v4, v48, s34
    v_lshl_add_u32 v4, v49, 5, v4
    s_lshl_b32 s34, s54, 8
    v_add_u32 v4, s34, v4
    v_mov_b32 v49, 36
dw_84:
    buffer_load_dword v48, v49, s[16:19], 0 offen sc1
    s_waitcnt vmcnt(0)
    v_readfirstlane_b32 s34, v48
    s_sub_u32 s33, s33, 1
    s_cbranch_scc1 END
    s_sleep 2
    s_cmp_lt_u32 s34, 192
    s_cbranch_scc1 dw_84
    s_mov_b32 s31, 0
OP_85:
    s_add_u32 s51, s31, 1
fw_86:
    buffer_load_dword v48, v5, s[4:7], 0 offen sc1
    s_waitcnt vmcnt(0)
    v_cmp_gt_u32 vcc, s51, v48
    s_sub_u32 s33, s33, 1
    s_cbranch_scc1 END
    s_cbranch_vccz fd_87
    s_sleep 2
    s_branch fw_86
fd_87:
    s_lshl_b32 s48, s31, 18
    s_lshl_b32 s34, s53, 16
    s_add_u32 s48, s48, s34
    s_lshl_b32 s34, s28, 14
    s_add_u32 s48, s48, s34
    s_add_u32 s48, s48, 0x2400000
    buffer_load_dwordx4 v[64:67], v3, s[4:7], s48 offen offset:0 sc1
    buffer_load_dwordx4 v[68:71], v3, s[4:7], s48 offen offset:256 sc1
    s_add_u32 s48, s48, 2048
    buffer_load_dwordx4 v[72:75], v3, s[4:7], s48 offen offset:0 sc1
    buffer_load_dwordx4 v[76:79], v3, s[4:7], s48 offen offset:256 sc1
    s_add_u32 s48, s48, 2048
    buffer_load_dwordx4 v[80:83], v3, s[4:7], s48 offen offset:0 sc1
    buffer_load_dwordx4 v[84:87], v3, s[4:7], s48 offen offset:256 sc1
    s_add_u32 s48, s48, 2048
    buffer_load_dwordx4 v[88:91], v3, s[4:7], s48 offen offset:0 sc1
    buffer_load_dwordx4 v[92:95], v3, s[4:7], s48 offen offset:256 sc1
    s_add_u32 s48, s48, 2048
    buffer_load_dwordx4 v[96:99], v3, s[4:7], s48 offen offset:0 sc1
    buffer_load_dwordx4 v[100:103], v3, s[4:7], s48 offen offset:256 sc1
    s_add_u32 s48, s48, 2048
    buffer_load_dwordx4 v[104:107], v3, s[4:7], s48 offen offset:0 sc1
    buffer_load_dwordx4 v[108:111], v3, s[4:7], s48 offen offset:256 sc1
    s_add_u32 s48, s48, 2048
    buffer_load_dwordx4 v[112:115], v3, s[4:7], s48 offen offset:0 sc1
    buffer_load_dwordx4 v[116:119], v3, s[4:7], s48 offen offset:256 sc1
    s_add_u32 s48, s48, 2048
    buffer_load_dwordx4 v[120:123], v3, s[4:7], s48 offen offset:0 sc1
    buffer_load_dwordx4 v[124:127], v3, s[4:7], s48 offen offset:256 sc1
    s_waitcnt vmcnt(14)
    v_mfma_f32_16x16x32_bf16 v[8:11], a[0:3], v[64:67], 0
    v_mfma_f32_16x16x32_bf16 v[16:19], a[32:35], v[64:67], 0
    v_mfma_f32_16x16x32_bf16 v[24:27], a[64:67], v[64:67], 0
    v_mfma_f32_16x16x32_bf16 v[32:35], a[96:99], v[64:67], 0
    v_mfma_f32_16x16x32_bf16 v[12:15], a[0:3], v[68:71], 0
    v_mfma_f32_16x16x32_bf16 v[20:23], a[32:35], v[68:71], 0
    v_mfma_f32_16x16x32_bf16 v[28:31], a[64:67], v[68:71], 0
    v_mfma_f32_16x16x32_bf16 v[36:39], a[96:99], v[68:71], 0
    s_waitcnt vmcnt(12)
    v_mfma_f32_16x16x32_bf16 v[8:11], a[4:7], v[72:75], v[8:11]
    v_mfma_f32_16x16x32_bf16 v[16:19], a[36:39], v[72:75], v[16:19]
    v_mfma_f32_16x16x32_bf16 v[24:27], a[68:71], v[72:75], v[24:27]
    v_mfma_f32_16x16x32_bf16 v[32:35], a[100:103], v[72:75], v[32:35]
    v_mfma_f32_16x16x32_bf16 v[12:15], a[4:7], v[76:79], v[12:15]
    v_mfma_f32_16x16x32_bf16 v[20:23], a[36:39], v[76:79], v[20:23]
    v_mfma_f32_16x16x32_bf16 v[28:31], a[68:71], v[76:79], v[28:31]
    v_mfma_f32_16x16x32_bf16 v[36:39], a[100:103], v[76:79], v[36:39]
    s_waitcnt vmcnt(10)
    v_mfma_f32_16x16x32_bf16 v[8:11], a[8:11], v[80:83], v[8:11]
    v_mfma_f32_16x16x32_bf16 v[16:19], a[40:43], v[80:83], v[16:19]
    v_mfma_f32_16x16x32_bf16 v[24:27], a[72:75], v[80:83], v[24:27]
    v_mfma_f32_16x16x32_bf16 v[32:35], a[104:107], v[80:83], v[32:35]
    v_mfma_f32_16x16x32_bf16 v[12:15], a[8:11], v[84:87], v[12:15]
    v_mfma_f32_16x16x32_bf16 v[20:23], a[40:43], v[84:87], v[20:23]
    v_mfma_f32_16x16x32_bf16 v[28:31], a[72:75], v[84:87], v[28:31]
    v_mfma_f32_16x16x32_bf16 v[36:39], a[104:107], v[84:87], v[36:39]
    s_waitcnt vmcnt(8)
    v_mfma_f32_16x16x32_bf16 v[8:11], a[12:15], v[88:91], v[8:11]
    v_mfma_f32_16x16x32_bf16 v[16:19], a[44:47], v[88:91], v[16:19]
    v_mfma_f32_16x16x32_bf16 v[24:27], a[76:79], v[88:91], v[24:27]
    v_mfma_f32_16x16x32_bf16 v[32:35], a[108:111], v[88:91], v[32:35]
    v_mfma_f32_16x16x32_bf16 v[12:15], a[12:15], v[92:95], v[12:15]
    v_mfma_f32_16x16x32_bf16 v[20:23], a[44:47], v[92:95], v[20:23]
    v_mfma_f32_16x16x32_bf16 v[28:31], a[76:79], v[92:95], v[28:31]
    v_mfma_f32_16x16x32_bf16 v[36:39], a[108:111], v[92:95], v[36:39]
    s_waitcnt vmcnt(6)
    v_mfma_f32_16x16x32_bf16 v[8:11], a[16:19], v[96:99], v[8:11]
    v_mfma_f32_16x16x32_bf16 v[16:19], a[48:51], v[96:99], v[16:19]
    v_mfma_f32_16x16x32_bf16 v[24:27], a[80:83], v[96:99], v[24:27]
    v_mfma_f32_16x16x32_bf16 v[32:35], a[112:115], v[96:99], v[32:35]
    v_mfma_f32_16x16x32_bf16 v[12:15], a[16:19], v[100:103], v[12:15]
    v_mfma_f32_16x16x32_bf16 v[20:23], a[48:51], v[100:103], v[20:23]
    v_mfma_f32_16x16x32_bf16 v[28:31], a[80:83], v[100:103], v[28:31]
    v_mfma_f32_16x16x32_bf16 v[36:39], a[112:115], v[100:103], v[36:39]
    s_waitcnt vmcnt(4)
    v_mfma_f32_16x16x32_bf16 v[8:11], a[20:23], v[104:107], v[8:11]
    v_mfma_f32_16x16x32_bf16 v[16:19], a[52:55], v[104:107], v[16:19]
    v_mfma_f32_16x16x32_bf16 v[24:27], a[84:87], v[104:107], v[24:27]
    v_mfma_f32_16x16x32_bf16 v[32:35], a[116:119], v[104:107], v[32:35]
    v_mfma_f32_16x16x32_bf16 v[12:15], a[20:23], v[108:111], v[12:15]
    v_mfma_f32_16x16x32_bf16 v[20:23], a[52:55], v[108:111], v[20:23]
    v_mfma_f32_16x16x32_bf16 v[28:31], a[84:87], v[108:111], v[28:31]
    v_mfma_f32_16x16x32_bf16 v[36:39], a[116:119], v[108:111], v[36:39]
    s_waitcnt vmcnt(2)
    v_mfma_f32_16x16x32_bf16 v[8:11], a[24:27], v[112:115], v[8:11]
    v_mfma_f32_16x16x32_bf16 v[16:19], a[56:59], v[112:115], v[16:19]
    v_mfma_f32_16x16x32_bf16 v[24:27], a[88:91], v[112:115], v[24:27]
    v_mfma_f32_16x16x32_bf16 v[32:35], a[120:123], v[112:115], v[32:35]
    v_mfma_f32_16x16x32_bf16 v[12:15], a[24:27], v[116:119], v[12:15]
    v_mfma_f32_16x16x32_bf16 v[20:23], a[56:59], v[116:119], v[20:23]
    v_mfma_f32_16x16x32_bf16 v[28:31], a[88:91], v[116:119], v[28:31]
    v_mfma_f32_16x16x32_bf16 v[36:39], a[120:123], v[116:119], v[36:39]
    s_waitcnt vmcnt(0)
    v_mfma_f32_16x16x32_bf16 v[8:11], a[28:31], v[120:123], v[8:11]
    v_mfma_f32_16x16x32_bf16 v[16:19], a[60:63], v[120:123], v[16:19]
    v_mfma_f32_16x16x32_bf16 v[24:27], a[92:95], v[120:123], v[24:27]
    v_mfma_f32_16x16x32_bf16 v[32:35], a[124:127], v[120:123], v[32:35]
    v_mfma_f32_16x16x32_bf16 v[12:15], a[28:31], v[124:127], v[12:15]
    v_mfma_f32_16x16x32_bf16 v[20:23], a[60:63], v[124:127], v[20:23]
    v_mfma_f32_16x16x32_bf16 v[28:31], a[92:95], v[124:127], v[28:31]
    v_mfma_f32_16x16x32_bf16 v[36:39], a[124:127], v[124:127], v[36:39]
    s_nop 7
    ds_write_b128 v6, v[8:11] offset:0
    ds_write_b128 v6, v[16:19] offset:16
    ds_write_b128 v6, v[24:27] offset:128
    ds_write_b128 v6, v[32:35] offset:144
    ds_write_b128 v6, v[12:15] offset:4352
    ds_write_b128 v6, v[20:23] offset:4368
    ds_write_b128 v6, v[28:31] offset:4480
    ds_write_b128 v6, v[36:39] offset:4496
    s_waitcnt lgkmcnt(0)
    s_barrier
    ds_read_b128 v[40:43], v7 offset:0
    ds_read_b128 v[44:47], v7 offset:16
    ds_read_b128 v[48:51], v7 offset:8704
    ds_read_b128 v[52:55], v7 offset:8720
    ds_read_b128 v[56:59], v7 offset:17408
    ds_read_b128 v[60:63], v7 offset:17424
    ds_read_b128 v[64:67], v7 offset:26112
    ds_read_b128 v[68:71], v7 offset:26128
    s_waitcnt lgkmcnt(0)
    s_barrier
    v_add_f32 v40, v40, v48
    v_add_f32 v56, v56, v64
    v_add_f32 v40, v40, v56
    v_add_f32 v41, v41, v49
    v_add_f32 v57, v57, v65
    v_add_f32 v41, v41, v57
    v_add_f32 v42, v42, v50
    v_add_f32 v58, v58, v66
    v_add_f32 v42, v42, v58
    v_add_f32 v43, v43, v51
    v_add_f32 v59, v59, v67
    v_add_f32 v43, v43, v59
    v_add_f32 v44, v44, v52
    v_add_f32 v60, v60, v68
    v_add_f32 v44, v44, v60
    v_add_f32 v45, v45, v53
    v_add_f32 v61, v61, v69
    v_add_f32 v45, v45, v61
    v_add_f32 v46, v46, v54
    v_add_f32 v62, v62, v70
    v_add_f32 v46, v46, v62
    v_add_f32 v47, v47, v55
    v_add_f32 v63, v63, v71
    v_add_f32 v47, v47, v63
    s_mul_i32 s48, s31, 327680
    s_mul_i32 s34, s53, 81920
    s_add_u32 s48, s48, s34
    s_add_u32 s48, s48, 0x4000000
    buffer_store_dwordx4 v[40:43], v4, s[4:7], s48 offen sc1
    buffer_store_dwordx4 v[44:47], v4, s[4:7], s48 offen offset:16 sc1
    s_waitcnt vmcnt(0)
    s_barrier
    s_cmp_lg_u32 s28, 0
    s_cbranch_scc1 fp_88
    s_lshl_b32 s34, s29, 7
    s_add_u32 s34, s34, 0x6460000
    v_mov_b32 v48, s51
    v_mov_b32 v49, 0
    s_mov_b64 exec, 1
    buffer_store_dword v48, v49, s[4:7], s34 offen sc1
    s_mov_b64 exec, -1
fp_88:
    s_mov_b32 s31, s51
    s_cmp_lt_u32 s31, 64
    s_cbranch_scc1 OP_85
    s_branch END
ROLE_F1:
    s_load_dwordx2 s[8:9], s[0:1], 64
    s_mov_b32 s10, 0x21c000
    s_mov_b32 s11, 0x20000
    s_load_dwordx2 s[12:13], s[0:1], 72
    s_mov_b32 s14, 0x21c000
    s_mov_b32 s15, 0x20000
    s_waitcnt lgkmcnt(0)
    s_cmp_lg_u32 s28, 0
    s_cbranch_scc1 w0_89
    v_mov_b32 v49, 128
dw_90:
    buffer_load_dword v48, v49, s[16:19], 0 offen sc1
    s_waitcnt vmcnt(0)
    v_readfirstlane_b32 s34, v48
    s_sub_u32 s33, s33, 1
    s_cbranch_scc1 END
    s_sleep 8
    s_cmp_lt_u32 s34, 64
    s_cbranch_scc1 dw_90
w0_89:
    s_barrier
    s_sub_u32 s42, s29, 200
    s_lshl_b32 s46, s42, 7
    v_lshrrev_b32 v48, 4, v1
    v_and_b32 v49, 15, v1
    v_lshlrev_b32 v50, 1, v48
    v_xor_b32 v49, v49, v50
    s_lshr_b32 s34, s28, 1
    s_lshl_b32 s34, s34, 3
    v_xor_b32 v49, s34, v49
    v_lshrrev_b32 v50, 3, v49
    v_lshlrev_b32 v50, 5, v50
    v_add_u32 v48, v48, v50
    v_and_b32 v49, 7, v49
    s_mov_b32 s34, 3456
    v_mul_lo_u32 v48, v48, s34
    v_lshlrev_b32 v49, 4, v49
    v_add_u32 v5, v48, v49
    s_mul_i32 s41, s28, 13824
    s_add_u32 s41, s41, s46
    s_lshl_b32 s40, s28, 10
    s_add_u32 s40, s40, 0
    s_mov_b32 m0, s40
    s_nop 0
    buffer_load_dwordx4 v5, s[8:11], s41 offen lds
    s_add_u32 s40, s40, 4096
    s_add_u32 s41, s41, 55296
    s_mov_b32 m0, s40
    s_nop 0
    buffer_load_dwordx4 v5, s[8:11], s41 offen lds
    s_add_u32 s40, s40, 4096
    s_add_u32 s41, s41, 165888
    s_mov_b32 m0, s40
    s_nop 0
    buffer_load_dwordx4 v5, s[8:11], s41 offen lds
    s_add_u32 s40, s40, 4096
    s_add_u32 s41, s41, 55296
    s_mov_b32 m0, s40
    s_nop 0
    buffer_load_dwordx4 v5, s[8:11], s41 offen lds
    s_add_u32 s40, s40, 4096
    s_add_u32 s41, s41, 165888
    s_mov_b32 m0, s40
    s_nop 0
    buffer_load_dwordx4 v5, s[8:11], s41 offen lds
    s_add_u32 s40, s40, 4096
    s_add_u32 s41, s41, 55296
    s_mov_b32 m0, s40
    s_nop 0
    buffer_load_dwordx4 v5, s[8:11], s41 offen lds
    s_add_u32 s40, s40, 4096
    s_add_u32 s41, s41, 165888
    s_mov_b32 m0, s40
    s_nop 0
    buffer_load_dwordx4 v5, s[8:11], s41 offen lds
    s_add_u32 s40, s40, 4096
    s_add_u32 s41, s41, 55296
    s_mov_b32 m0, s40
    s_nop 0
    buffer_load_dwordx4 v5, s[8:11], s41 offen lds
    s_add_u32 s40, s40, 4096
    s_add_u32 s41, s41, 165888
    s_mov_b32 m0, s40
    s_nop 0
    buffer_load_dwordx4 v5, s[8:11], s41 offen lds
    s_add_u32 s40, s40, 4096
    s_add_u32 s41, s41, 55296
    s_mov_b32 m0, s40
    s_nop 0
    buffer_load_dwordx4 v5, s[8:11], s41 offen lds
    s_add_u32 s40, s40, 4096
    s_add_u32 s41, s41, 165888
    s_mov_b32 m0, s40
    s_nop 0
    buffer_load_dwordx4 v5, s[8:11], s41 offen lds
    s_add_u32 s40, s40, 4096
    s_add_u32 s41, s41, 55296
    s_mov_b32 m0, s40
    s_nop 0
    buffer_load_dwordx4 v5, s[8:11], s41 offen lds
    s_add_u32 s40, s40, 4096
    s_add_u32 s41, s41, 165888
    s_mov_b32 m0, s40
    s_nop 0
    buffer_load_dwordx4 v5, s[8:11], s41 offen lds
    s_add_u32 s40, s40, 4096
    s_add_u32 s41, s41, 55296
    s_mov_b32 m0, s40
    s_nop 0
    buffer_load_dwordx4 v5, s[8:11], s41 offen lds
    s_add_u32 s40, s40, 4096
    s_add_u32 s41, s41, 165888
    s_mov_b32 m0, s40
    s_nop 0
    buffer_load_dwordx4 v5, s[8:11], s41 offen lds
    s_add_u32 s40, s40, 4096
    s_add_u32 s41, s41, 55296
    s_mov_b32 m0, s40
    s_nop 0
    buffer_load_dwordx4 v5, s[8:11], s41 offen lds
    s_add_u32 s40, s40, 4096
    s_add_u32 s41, s41, 165888
    s_mov_b32 m0, s40
    s_nop 0
    buffer_load_dwordx4 v5, s[8:11], s41 offen lds
    s_add_u32 s40, s40, 4096
    s_add_u32 s41, s41, 55296
    s_mov_b32 m0, s40
    s_nop 0
    buffer_load_dwordx4 v5, s[8:11], s41 offen lds
    s_add_u32 s40, s40, 4096
    s_add_u32 s41, s41, 165888
    s_mov_b32 m0, s40
    s_nop 0
    buffer_load_dwordx4 v5, s[8:11], s41 offen lds
    s_add_u32 s40, s40, 4096
    s_add_u32 s41, s41, 55296
    s_mov_b32 m0, s40
    s_nop 0
    buffer_load_dwordx4 v5, s[8:11], s41 offen lds
    s_mul_i32 s41, s28, 13824
    s_add_u32 s41, s41, s46
    s_lshl_b32 s40, s28, 10
    s_add_u32 s40, s40, 81920
    s_mov_b32 m0, s40
    s_nop 0
    buffer_load_dwordx4 v5, s[12:15], s41 offen lds
    s_add_u32 s40, s40, 4096
    s_add_u32 s41, s41, 55296
    s_mov_b32 m0, s40
    s_nop 0
    buffer_load_dwordx4 v5, s[12:15], s41 offen lds
    s_add_u32 s40, s40, 4096
    s_add_u32 s41, s41, 165888
    s_mov_b32 m0, s40
    s_nop 0
    buffer_load_dwordx4 v5, s[12:15], s41 offen lds
    s_add_u32 s40, s40, 4096
    s_add_u32 s41, s41, 55296
    s_mov_b32 m0, s40
    s_nop 0
    buffer_load_dwordx4 v5, s[12:15], s41 offen lds
    s_add_u32 s40, s40, 4096
    s_add_u32 s41, s41, 165888
    s_mov_b32 m0, s40
    s_nop 0
    buffer_load_dwordx4 v5, s[12:15], s41 offen lds
    s_add_u32 s40, s40, 4096
    s_add_u32 s41, s41, 55296
    s_mov_b32 m0, s40
    s_nop 0
    buffer_load_dwordx4 v5, s[12:15], s41 offen lds
    s_add_u32 s40, s40, 4096
    s_add_u32 s41, s41, 165888
    s_mov_b32 m0, s40
    s_nop 0
    buffer_load_dwordx4 v5, s[12:15], s41 offen lds
    s_add_u32 s40, s40, 4096
    s_add_u32 s41, s41, 55296
    s_mov_b32 m0, s40
    s_nop 0
    buffer_load_dwordx4 v5, s[12:15], s41 offen lds
    s_add_u32 s40, s40, 4096
    s_add_u32 s41, s41, 165888
    s_mov_b32 m0, s40
    s_nop 0
    buffer_load_dwordx4 v5, s[12:15], s41 offen lds
    s_add_u32 s40, s40, 4096
    s_add_u32 s41, s41, 55296
    s_mov_b32 m0, s40
    s_nop 0
    buffer_load_dwordx4 v5, s[12:15], s41 offen lds
    s_add_u32 s40, s40, 4096
    s_add_u32 s41, s41, 165888
    s_mov_b32 m0, s40
    s_nop 0
    buffer_load_dwordx4 v5, s[12:15], s41 offen lds
    s_add_u32 s40, s40, 4096
    s_add_u32 s41, s41, 55296
    s_mov_b32 m0, s40
    s_nop 0
    buffer_load_dwordx4 v5, s[12:15], s41 offen lds
    s_add_u32 s40, s40, 4096
    s_add_u32 s41, s41, 165888
    s_mov_b32 m0, s40
    s_nop 0
    buffer_load_dwordx4 v5, s[12:15], s41 offen lds
    s_add_u32 s40, s40, 4096
    s_add_u32 s41, s41, 55296
    s_mov_b32 m0, s40
    s_nop 0
    buffer_load_dwordx4 v5, s[12:15], s41 offen lds
    s_add_u32 s40, s40, 4096
    s_add_u32 s41, s41, 165888
    s_mov_b32 m0, s40
    s_nop 0
    buffer_load_dwordx4 v5, s[12:15], s41 offen lds
    s_add_u32 s40, s40, 4096
    s_add_u32 s41, s41, 55296
    s_mov_b32 m0, s40
    s_nop 0
    buffer_load_dwordx4 v5, s[12:15], s41 offen lds
    s_add_u32 s40, s40, 4096
    s_add_u32 s41, s41, 165888
    s_mov_b32 m0, s40
    s_nop 0
    buffer_load_dwordx4 v5, s[12:15], s41 offen lds
    s_add_u32 s40, s40, 4096
    s_add_u32 s41, s41, 55296
    s_mov_b32 m0, s40
    s_nop 0
    buffer_load_dwordx4 v5, s[12:15], s41 offen lds
    s_add_u32 s40, s40, 4096
    s_add_u32 s41, s41, 165888
    s_mov_b32 m0, s40
    s_nop 0
    buffer_load_dwordx4 v5, s[12:15], s41 offen lds
    s_add_u32 s40, s40, 4096
    s_add_u32 s41, s41, 55296
    s_mov_b32 m0, s40
    s_nop 0
    buffer_load_dwordx4 v5, s[12:15], s41 offen lds
    s_lshl_b32 s47, s28, 1
    v_lshrrev_b32 v48, 4, v1
    v_bfe_u32 v49, v1, 2, 2
    v_and_b32 v52, 3, v1
    v_lshrrev_b32 v50, 1, v52
    v_add_u32 v50, s47, v50
    v_and_b32 v51, 1, v52
    v_and_b32 v53, 1, v48
    v_lshl_or_b32 v53, v53, 2, v49
    v_lshlrev_b32 v53, 1, v53
    v_xor_b32 v50, v50, v53
    v_lshlrev_b32 v50, 4, v50
    v_lshl_add_u32 v50, v51, 3, v50
    v_lshl_add_u32 v50, v49, 8, v50
    v_lshl_add_u32 v6, v48, 11, v50
    v_xor_b32 v7, 128, v6
    v_add_u32 v54, 0x10000, v6
    v_add_u32 v55, 0x10000, v7
    v_add_u32 v56, 0x20000, v6
    v_add_u32 v57, 0x20000, v7
    s_waitcnt vmcnt(0)
    s_barrier
    ds_read_b64_tr_b16 a[0:1], v6 offset:0
    ds_read_b64_tr_b16 a[2:3], v6 offset:1024
    ds_read_b64_tr_b16 a[4:5], v7 offset:0
    ds_read_b64_tr_b16 a[6:7], v7 offset:1024
    ds_read_b64_tr_b16 a[8:9], v6 offset:8192
    ds_read_b64_tr_b16 a[10:11], v6 offset:9216
    ds_read_b64_tr_b16 a[12:13], v7 offset:8192
    ds_read_b64_tr_b16 a[14:15], v7 offset:9216
    s_waitcnt lgkmcnt(0)
    ds_read_b64_tr_b16 a[16:17], v6 offset:16384
    ds_read_b64_tr_b16 a[18:19], v6 offset:17408
    ds_read_b64_tr_b16 a[20:21], v7 offset:16384
    ds_read_b64_tr_b16 a[22:23], v7 offset:17408
    ds_read_b64_tr_b16 a[24:25], v6 offset:24576
    ds_read_b64_tr_b16 a[26:27], v6 offset:25600
    ds_read_b64_tr_b16 a[28:29], v7 offset:24576
    ds_read_b64_tr_b16 a[30:31], v7 offset:25600
    s_waitcnt lgkmcnt(0)
    ds_read_b64_tr_b16 a[32:33], v6 offset:32768
    ds_read_b64_tr_b16 a[34:35], v6 offset:33792
    ds_read_b64_tr_b16 a[36:37], v7 offset:32768
    ds_read_b64_tr_b16 a[38:39], v7 offset:33792
    ds_read_b64_tr_b16 a[40:41], v6 offset:40960
    ds_read_b64_tr_b16 a[42:43], v6 offset:41984
    ds_read_b64_tr_b16 a[44:45], v7 offset:40960
    ds_read_b64_tr_b16 a[46:47], v7 offset:41984
    s_waitcnt lgkmcnt(0)
    ds_read_b64_tr_b16 a[48:49], v6 offset:49152
    ds_read_b64_tr_b16 a[50:51], v6 offset:50176
    ds_read_b64_tr_b16 a[52:53], v7 offset:49152
    ds_read_b64_tr_b16 a[54:55], v7 offset:50176
    ds_read_b64_tr_b16 a[56:57], v6 offset:57344
    ds_read_b64_tr_b16 a[58:59], v6 offset:58368
    ds_read_b64_tr_b16 a[60:61], v7 offset:57344
    ds_read_b64_tr_b16 a[62:63], v7 offset:58368
    s_waitcnt lgkmcnt(0)
    ds_read_b64_tr_b16 a[64:65], v54 offset:0
    ds_read_b64_tr_b16 a[66:67], v54 offset:1024
    ds_read_b64_tr_b16 a[68:69], v55 offset:0
    ds_read_b64_tr_b16 a[70:71], v55 offset:1024
    ds_read_b64_tr_b16 a[72:73], v54 offset:8192
    ds_read_b64_tr_b16 a[74:75], v54 offset:9216
    ds_read_b64_tr_b16 a[76:77], v55 offset:8192
    ds_read_b64_tr_b16 a[78:79], v55 offset:9216
    s_waitcnt lgkmcnt(0)
    ds_read_b64_tr_b16 a[80:81], v54 offset:16384
    ds_read_b64_tr_b16 a[82:83], v54 offset:17408
    ds_read_b64_tr_b16 a[84:85], v55 offset:16384
    ds_read_b64_tr_b16 a[86:87], v55 offset:17408
    ds_read_b64_tr_b16 a[88:89], v54 offset:24576
    ds_read_b64_tr_b16 a[90:91], v54 offset:25600
    ds_read_b64_tr_b16 a[92:93], v55 offset:24576
    ds_read_b64_tr_b16 a[94:95], v55 offset:25600
    s_waitcnt lgkmcnt(0)
    ds_read_b64_tr_b16 a[96:97], v54 offset:32768
    ds_read_b64_tr_b16 a[98:99], v54 offset:33792
    ds_read_b64_tr_b16 a[100:101], v55 offset:32768
    ds_read_b64_tr_b16 a[102:103], v55 offset:33792
    ds_read_b64_tr_b16 a[104:105], v54 offset:40960
    ds_read_b64_tr_b16 a[106:107], v54 offset:41984
    ds_read_b64_tr_b16 a[108:109], v55 offset:40960
    ds_read_b64_tr_b16 a[110:111], v55 offset:41984
    s_waitcnt lgkmcnt(0)
    ds_read_b64_tr_b16 a[112:113], v54 offset:49152
    ds_read_b64_tr_b16 a[114:115], v54 offset:50176
    ds_read_b64_tr_b16 a[116:117], v55 offset:49152
    ds_read_b64_tr_b16 a[118:119], v55 offset:50176
    ds_read_b64_tr_b16 a[120:121], v54 offset:57344
    ds_read_b64_tr_b16 a[122:123], v54 offset:58368
    ds_read_b64_tr_b16 a[124:125], v55 offset:57344
    ds_read_b64_tr_b16 a[126:127], v55 offset:58368
    s_waitcnt lgkmcnt(0)
    ds_read_b64_tr_b16 a[128:129], v56 offset:0
    ds_read_b64_tr_b16 a[130:131], v56 offset:1024
    ds_read_b64_tr_b16 a[132:133], v57 offset:0
    ds_read_b64_tr_b16 a[134:135], v57 offset:1024
    ds_read_b64_tr_b16 a[136:137], v56 offset:8192
    ds_read_b64_tr_b16 a[138:139], v56 offset:9216
    ds_read_b64_tr_b16 a[140:141], v57 offset:8192
    ds_read_b64_tr_b16 a[142:143], v57 offset:9216
    s_waitcnt lgkmcnt(0)
    ds_read_b64_tr_b16 a[144:145], v56 offset:16384
    ds_read_b64_tr_b16 a[146:147], v56 offset:17408
    ds_read_b64_tr_b16 a[148:149], v57 offset:16384
    ds_read_b64_tr_b16 a[150:151], v57 offset:17408
    ds_read_b64_tr_b16 a[152:153], v56 offset:24576
    ds_read_b64_tr_b16 a[154:155], v56 offset:25600
    ds_read_b64_tr_b16 a[156:157], v57 offset:24576
    ds_read_b64_tr_b16 a[158:159], v57 offset:25600
    s_waitcnt lgkmcnt(0)
    s_waitcnt lgkmcnt(0)
    s_barrier
    v_lshlrev_b32 v2, 4, v1
    v_lshrrev_b32 v3, 4, v1
    v_lshlrev_b32 v3, 9, v3
    v_and_b32 v4, 15, v1
    v_lshl_add_u32 v3, v4, 4, v3
    s_lshl_b32 s34, s28, 10
    v_add_u32 v59, s34, v2
    s_cmp_lg_u32 s28, 0
    s_cbranch_scc1 w0_91
    v_mov_b32 v49, 192
    v_mov_b32 v50, 1
    v_mov_b32 v51, 64
    v_cmp_eq_u32 vcc, 1, v1
    v_cndmask_b32 v49, v49, v51, vcc
    v_mov_b32 v51, 36
    v_cmp_eq_u32 vcc, 0, v1
    v_cndmask_b32 v49, v49, v51, vcc
    v_mov_b32 v51, 192
    v_cndmask_b32 v50, v50, v51, vcc
fw_92:
    buffer_load_dword v48, v49, s[16:19], 0 offen sc1
    s_waitcnt vmcnt(0)
    v_cmp_gt_u32 vcc, v50, v48
    s_sub_u32 s33, s33, 1
    s_cbranch_scc1 END
    s_cbranch_vccz fd_93
    s_sleep 2
    s_branch fw_92
fd_93:
w0_91:
    s_barrier
    s_mov_b32 s31, 0
    s_mov_b32 s50, 0
    s_mul_i32 s41, s31, 40960
    s_mul_i32 s34, s28, 10240
    s_add_u32 s41, s41, s34
    s_add_u32 s40, s50, s34
    s_mov_b32 m0, s40
    s_nop 0
    buffer_load_dwordx4 v2, s[4:7], s41 offen sc1 lds
    s_add_u32 s40, s40, 1024
    s_add_u32 s41, s41, 1024
    s_mov_b32 m0, s40
    s_nop 0
    buffer_load_dwordx4 v2, s[4:7], s41 offen sc1 lds
    s_add_u32 s40, s40, 1024
    s_add_u32 s41, s41, 1024
    s_mov_b32 m0, s40
    s_nop 0
    buffer_load_dwordx4 v2, s[4:7], s41 offen sc1 lds
    s_add_u32 s40, s40, 1024
    s_add_u32 s41, s41, 1024
    s_mov_b32 m0, s40
    s_nop 0
    buffer_load_dwordx4 v2, s[4:7], s41 offen sc1 lds
    s_add_u32 s40, s40, 1024
    s_add_u32 s41, s41, 1024
    s_mov_b32 m0, s40
    s_nop 0
    buffer_load_dwordx4 v2, s[4:7], s41 offen sc1 lds
    s_add_u32 s40, s40, 1024
    s_add_u32 s41, s41, 1024
    s_mov_b32 m0, s40
    s_nop 0
    buffer_load_dwordx4 v2, s[4:7], s41 offen sc1 lds
    s_add_u32 s40, s40, 1024
    s_add_u32 s41, s41, 1024
    s_mov_b32 m0, s40
    s_nop 0
    buffer_load_dwordx4 v2, s[4:7], s41 offen sc1 lds
    s_add_u32 s40, s40, 1024
    s_add_u32 s41, s41, 1024
    s_mov_b32 m0, s40
    s_nop 0
    buffer_load_dwordx4 v2, s[4:7], s41 offen sc1 lds
    s_add_u32 s40, s40, 1024
    s_add_u32 s41, s41, 1024
    s_mov_b32 m0, s40
    s_nop 0
    buffer_load_dwordx4 v2, s[4:7], s41 offen sc1 lds
    s_add_u32 s40, s40, 1024
    s_add_u32 s41, s41, 1024
    s_mov_b32 m0, s40
    s_nop 0
    buffer_load_dwordx4 v2, s[4:7], s41 offen sc1 lds
    s_waitcnt vmcnt(0)
    s_barrier
F1_94:
    s_cmp_lg_u32 s31, 1
    s_cbranch_scc1 lnw_95
    s_cmp_lg_u32 s28, 0
    s_cbranch_scc1 w0_96
    v_and_b32 v49, 63, v1
    v_lshlrev_b32 v49, 7, v49
    v_add_u32 v49, 0x6460040, v49
fw_97:
    buffer_load_dword v48, v49, s[4:7], 0 offen sc1
    s_waitcnt vmcnt(0)
    v_cmp_gt_u32 vcc, s31, v48
    s_sub_u32 s33, s33, 1
    s_cbranch_scc1 END
    s_cbranch_vccz fd_98
    s_sleep 2
    s_branch fw_97
fd_98:
w0_96:
    s_barrier
lnw_95:
    s_add_u32 s51, s31, 1
    s_min_u32 s39, s51, 63
    s_xor_b32 s52, s50, 40960
    s_mul_i32 s41, s39, 40960
    s_mul_i32 s34, s28, 10240
    s_add_u32 s41, s41, s34
    s_add_u32 s40, s52, s34
    s_mov_b32 m0, s40
    s_nop 0
    buffer_load_dwordx4 v2, s[4:7], s41 offen sc1 lds
    s_add_u32 s40, s40, 1024
    s_add_u32 s41, s41, 1024
    s_mov_b32 m0, s40
    s_nop 0
    buffer_load_dwordx4 v2, s[4:7], s41 offen sc1 lds
    s_add_u32 s40, s40, 1024
    s_add_u32 s41, s41, 1024
    s_mov_b32 m0, s40
    s_nop 0
    buffer_load_dwordx4 v2, s[4:7], s41 offen sc1 lds
    s_add_u32 s40, s40, 1024
    s_add_u32 s41, s41, 1024
    s_mov_b32 m0, s40
    s_nop 0
    buffer_load_dwordx4 v2, s[4:7], s41 offen sc1 lds
    s_add_u32 s40, s40, 1024
    s_add_u32 s41, s41, 1024
    s_mov_b32 m0, s40
    s_nop 0
    buffer_load_dwordx4 v2, s[4:7], s41 offen sc1 lds
    s_add_u32 s40, s40, 1024
    s_add_u32 s41, s41, 1024
    s_mov_b32 m0, s40
    s_nop 0
    buffer_load_dwordx4 v2, s[4:7], s41 offen sc1 lds
    s_add_u32 s40, s40, 1024
    s_add_u32 s41, s41, 1024
    s_mov_b32 m0, s40
    s_nop 0
    buffer_load_dwordx4 v2, s[4:7], s41 offen sc1 lds
    s_add_u32 s40, s40, 1024
    s_add_u32 s41, s41, 1024
    s_mov_b32 m0, s40
    s_nop 0
    buffer_load_dwordx4 v2, s[4:7], s41 offen sc1 lds
    s_add_u32 s40, s40, 1024
    s_add_u32 s41, s41, 1024
    s_mov_b32 m0, s40
    s_nop 0
    buffer_load_dwordx4 v2, s[4:7], s41 offen sc1 lds
    s_add_u32 s40, s40, 1024
    s_add_u32 s41, s41, 1024
    s_mov_b32 m0, s40
    s_nop 0
    buffer_load_dwordx4 v2, s[4:7], s41 offen sc1 lds
    v_add_u32 v58, s50, v3
    ds_read_b128 v[24:27], v58 offset:0
    ds_read_b128 v[28:31], v58 offset:256
    ds_read_b128 v[32:35], v58 offset:2048
    ds_read_b128 v[36:39], v58 offset:2304
    ds_read_b128 v[40:43], v58 offset:4096
    ds_read_b128 v[44:47], v58 offset:4352
    s_waitcnt lgkmcnt(4)
    v_mfma_f32_16x16x32_bf16 v[8:11], a[0:3], v[24:27], 0
    v_mfma_f32_16x16x32_bf16 v[16:19], a[80:83], v[24:27], 0
    v_mfma_f32_16x16x32_bf16 v[12:15], a[0:3], v[28:31], 0
    v_mfma_f32_16x16x32_bf16 v[20:23], a[80:83], v[28:31], 0
    ds_read_b128 v[24:27], v58 offset:6144
    ds_read_b128 v[28:31], v58 offset:6400
    s_waitcnt lgkmcnt(4)
    v_mfma_f32_16x16x32_bf16 v[8:11], a[4:7], v[32:35], v[8:11]
    v_mfma_f32_16x16x32_bf16 v[16:19], a[84:87], v[32:35], v[16:19]
    v_mfma_f32_16x16x32_bf16 v[12:15], a[4:7], v[36:39], v[12:15]
    v_mfma_f32_16x16x32_bf16 v[20:23], a[84:87], v[36:39], v[20:23]
    ds_read_b128 v[32:35], v58 offset:8192
    ds_read_b128 v[36:39], v58 offset:8448
    s_waitcnt lgkmcnt(4)
    v_mfma_f32_16x16x32_bf16 v[8:11], a[8:11], v[40:43], v[8:11]
    v_mfma_f32_16x16x32_bf16 v[16:19], a[88:91], v[40:43], v[16:19]
    v_mfma_f32_16x16x32_bf16 v[12:15], a[8:11], v[44:47], v[12:15]
    v_mfma_f32_16x16x32_bf16 v[20:23], a[88:91], v[44:47], v[20:23]
    ds_read_b128 v[40:43], v58 offset:10240
    ds_read_b128 v[44:47], v58 offset:10496
    s_waitcnt lgkmcnt(4)
    v_mfma_f32_16x16x32_bf16 v[8:11], a[12:15], v[24:27], v[8:11]
    v_mfma_f32_16x16x32_bf16 v[16:19], a[92:95], v[24:27], v[16:19]
    v_mfma_f32_16x16x32_bf16 v[12:15], a[12:15], v[28:31], v[12:15]
    v_mfma_f32_16x16x32_bf16 v[20:23], a[92:95], v[28:31], v[20:23]
    ds_read_b128 v[24:27], v58 offset:12288
    ds_read_b128 v[28:31], v58 offset:12544
    s_waitcnt lgkmcnt(4)
    v_mfma_f32_16x16x32_bf16 v[8:11], a[16:19], v[32:35], v[8:11]
    v_mfma_f32_16x16x32_bf16 v[16:19], a[96:99], v[32:35], v[16:19]
    v_mfma_f32_16x16x32_bf16 v[12:15], a[16:19], v[36:39], v[12:15]
    v_mfma_f32_16x16x32_bf16 v[20:23], a[96:99], v[36:39], v[20:23]
    ds_read_b128 v[32:35], v58 offset:14336
    ds_read_b128 v[36:39], v58 offset:14592
    s_waitcnt lgkmcnt(4)
    v_mfma_f32_16x16x32_bf16 v[8:11], a[20:23], v[40:43], v[8:11]
    v_mfma_f32_16x16x32_bf16 v[16:19], a[100:103], v[40:43], v[16:19]
    v_mfma_f32_16x16x32_bf16 v[12:15], a[20:23], v[44:47], v[12:15]
    v_mfma_f32_16x16x32_bf16 v[20:23], a[100:103], v[44:47], v[20:23]
    ds_read_b128 v[40:43], v58 offset:16384
    ds_read_b128 v[44:47], v58 offset:16640
    s_waitcnt lgkmcnt(4)
    v_mfma_f32_16x16x32_bf16 v[8:11], a[24:27], v[24:27], v[8:11]
    v_mfma_f32_16x16x32_bf16 v[16:19], a[104:107], v[24:27], v[16:19]
    v_mfma_f32_16x16x32_bf16 v[12:15], a[24:27], v[28:31], v[12:15]
    v_mfma_f32_16x16x32_bf16 v[20:23], a[104:107], v[28:31], v[20:23]
    ds_read_b128 v[24:27], v58 offset:18432
    ds_read_b128 v[28:31], v58 offset:18688
    s_waitcnt lgkmcnt(4)
    v_mfma_f32_16x16x32_bf16 v[8:11], a[28:31], v[32:35], v[8:11]
    v_mfma_f32_16x16x32_bf16 v[16:19], a[108:111], v[32:35], v[16:19]
    v_mfma_f32_16x16x32_bf16 v[12:15], a[28:31], v[36:39], v[12:15]
    v_mfma_f32_16x16x32_bf16 v[20:23], a[108:111], v[36:39], v[20:23]
    ds_read_b128 v[32:35], v58 offset:20480
    ds_read_b128 v[36:39], v58 offset:20736
    s_waitcnt lgkmcnt(4)
    v_mfma_f32_16x16x32_bf16 v[8:11], a[32:35], v[40:43], v[8:11]
    v_mfma_f32_16x16x32_bf16 v[16:19], a[112:115], v[40:43], v[16:19]
    v_mfma_f32_16x16x32_bf16 v[12:15], a[32:35], v[44:47], v[12:15]
    v_mfma_f32_16x16x32_bf16 v[20:23], a[112:115], v[44:47], v[20:23]
    ds_read_b128 v[40:43], v58 offset:22528
    ds_read_b128 v[44:47], v58 offset:22784
    s_waitcnt lgkmcnt(4)
    v_mfma_f32_16x16x32_bf16 v[8:11], a[36:39], v[24:27], v[8:11]
    v_mfma_f32_16x16x32_bf16 v[16:19], a[116:119], v[24:27], v[16:19]
    v_mfma_f32_16x16x32_bf16 v[12:15], a[36:39], v[28:31], v[12:15]
    v_mfma_f32_16x16x32_bf16 v[20:23], a[116:119], v[28:31], v[20:23]
    ds_read_b128 v[24:27], v58 offset:24576
    ds_read_b128 v[28:31], v58 offset:24832
    s_waitcnt lgkmcnt(4)
    v_mfma_f32_16x16x32_bf16 v[8:11], a[40:43], v[32:35], v[8:11]
    v_mfma_f32_16x16x32_bf16 v[16:19], a[120:123], v[32:35], v[16:19]
    v_mfma_f32_16x16x32_bf16 v[12:15], a[40:43], v[36:39], v[12:15]
    v_mfma_f32_16x16x32_bf16 v[20:23], a[120:123], v[36:39], v[20:23]
    ds_read_b128 v[32:35], v58 offset:26624
    ds_read_b128 v[36:39], v58 offset:26880
    s_waitcnt lgkmcnt(4)
    v_mfma_f32_16x16x32_bf16 v[8:11], a[44:47], v[40:43], v[8:11]
    v_mfma_f32_16x16x32_bf16 v[16:19], a[124:127], v[40:43], v[16:19]
    v_mfma_f32_16x16x32_bf16 v[12:15], a[44:47], v[44:47], v[12:15]
    v_mfma_f32_16x16x32_bf16 v[20:23], a[124:127], v[44:47], v[20:23]
    ds_read_b128 v[40:43], v58 offset:28672
    ds_read_b128 v[44:47], v58 offset:28928
    s_waitcnt lgkmcnt(4)
    v_mfma_f32_16x16x32_bf16 v[8:11], a[48:51], v[24:27], v[8:11]
    v_mfma_f32_16x16x32_bf16 v[16:19], a[128:131], v[24:27], v[16:19]
    v_mfma_f32_16x16x32_bf16 v[12:15], a[48:51], v[28:31], v[12:15]
    v_mfma_f32_16x16x32_bf16 v[20:23], a[128:131], v[28:31], v[20:23]
    ds_read_b128 v[24:27], v58 offset:30720
    ds_read_b128 v[28:31], v58 offset:30976
    s_waitcnt lgkmcnt(4)
    v_mfma_f32_16x16x32_bf16 v[8:11], a[52:55], v[32:35], v[8:11]
    v_mfma_f32_16x16x32_bf16 v[16:19], a[132:135], v[32:35], v[16:19]
    v_mfma_f32_16x16x32_bf16 v[12:15], a[52:55], v[36:39], v[12:15]
    v_mfma_f32_16x16x32_bf16 v[20:23], a[132:135], v[36:39], v[20:23]
    ds_read_b128 v[32:35], v58 offset:32768
    ds_read_b128 v[36:39], v58 offset:33024
    s_waitcnt lgkmcnt(4)
    v_mfma_f32_16x16x32_bf16 v[8:11], a[56:59], v[40:43], v[8:11]
    v_mfma_f32_16x16x32_bf16 v[16:19], a[136:139], v[40:43], v[16:19]
    v_mfma_f32_16x16x32_bf16 v[12:15], a[56:59], v[44:47], v[12:15]
    v_mfma_f32_16x16x32_bf16 v[20:23], a[136:139], v[44:47], v[20:23]
    ds_read_b128 v[40:43], v58 offset:34816
    ds_read_b128 v[44:47], v58 offset:35072
    s_waitcnt lgkmcnt(4)
    v_mfma_f32_16x16x32_bf16 v[8:11], a[60:63], v[24:27], v[8:11]
    v_mfma_f32_16x16x32_bf16 v[16:19], a[140:143], v[24:27], v[16:19]
    v_mfma_f32_16x16x32_bf16 v[12:15], a[60:63], v[28:31], v[12:15]
    v_mfma_f32_16x16x32_bf16 v[20:23], a[140:143], v[28:31], v[20:23]
    ds_read_b128 v[24:27], v58 offset:36864
    ds_read_b128 v[28:31], v58 offset:37120
    s_waitcnt lgkmcnt(4)
    v_mfma_f32_16x16x32_bf16 v[8:11], a[64:67], v[32:35], v[8:11]
    v_mfma_f32_16x16x32_bf16 v[16:19], a[144:147], v[32:35], v[16:19]
    v_mfma_f32_16x16x32_bf16 v[12:15], a[64:67], v[36:39], v[12:15]
    v_mfma_f32_16x16x32_bf16 v[20:23], a[144:147], v[36:39], v[20:23]
    ds_read_b128 v[32:35], v58 offset:38912
    ds_read_b128 v[36:39], v58 offset:39168
    s_waitcnt lgkmcnt(4)
    v_mfma_f32_16x16x32_bf16 v[8:11], a[68:71], v[40:43], v[8:11]
    v_mfma_f32_16x16x32_bf16 v[16:19], a[148:151], v[40:43], v[16:19]
    v_mfma_f32_16x16x32_bf16 v[12:15], a[68:71], v[44:47], v[12:15]
    v_mfma_f32_16x16x32_bf16 v[20:23], a[148:151], v[44:47], v[20:23]
    s_waitcnt lgkmcnt(2)
    v_mfma_f32_16x16x32_bf16 v[8:11], a[72:75], v[24:27], v[8:11]
    v_mfma_f32_16x16x32_bf16 v[16:19], a[152:155], v[24:27], v[16:19]
    v_mfma_f32_16x16x32_bf16 v[12:15], a[72:75], v[28:31], v[12:15]
    v_mfma_f32_16x16x32_bf16 v[20:23], a[152:155], v[28:31], v[20:23]
    s_waitcnt lgkmcnt(0)
    v_mfma_f32_16x16x32_bf16 v[8:11], a[76:79], v[32:35], v[8:11]
    v_mfma_f32_16x16x32_bf16 v[16:19], a[156:159], v[32:35], v[16:19]
    v_mfma_f32_16x16x32_bf16 v[12:15], a[76:79], v[36:39], v[12:15]
    v_mfma_f32_16x16x32_bf16 v[20:23], a[156:159], v[36:39], v[20:23]
    s_mul_i32 s48, s31, 110592
    s_lshl_b32 s49, s42, 12
    s_add_u32 s48, s48, s49
    s_add_u32 s48, s48, 0x3400000
    s_nop 7
    v_cvt_pk_bf16_f32 v60, v8, v9
    v_cvt_pk_bf16_f32 v61, v16, v17
    v_and_b32 v63, 0xffff0000, v60
    v_lshlrev_b32 v62, 16, v60
    v_and_b32 v65, 0xffff0000, v61
    v_lshlrev_b32 v64, 16, v61
    v_mul_f32 v66, 0xbfb8aa3b, v62
    v_exp_f32 v66, v66
    s_nop 0
    v_add_f32 v66, 1.0, v66
    v_rcp_f32 v66, v66
    s_nop 0
    v_mul_f32 v62, v62, v66
    v_mul_f32 v66, 0xbfb8aa3b, v63
    v_exp_f32 v66, v66
    s_nop 0
    v_add_f32 v66, 1.0, v66
    v_rcp_f32 v66, v66
    s_nop 0
    v_mul_f32 v63, v63, v66
    v_cvt_pk_bf16_f32 v60, v62, v63
    v_and_b32 v63, 0xffff0000, v60
    v_lshlrev_b32 v62, 16, v60
    v_mul_f32 v62, v62, v64
    v_mul_f32 v63, v63, v65
    v_cvt_pk_bf16_f32 v48, v62, v63
    v_cvt_pk_bf16_f32 v60, v10, v11
    v_cvt_pk_bf16_f32 v61, v18, v19
    v_and_b32 v63, 0xffff0000, v60
    v_lshlrev_b32 v62, 16, v60
    v_and_b32 v65, 0xffff0000, v61
    v_lshlrev_b32 v64, 16, v61
    v_mul_f32 v66, 0xbfb8aa3b, v62
    v_exp_f32 v66, v66
    s_nop 0
    v_add_f32 v66, 1.0, v66
    v_rcp_f32 v66, v66
    s_nop 0
    v_mul_f32 v62, v62, v66
    v_mul_f32 v66, 0xbfb8aa3b, v63
    v_exp_f32 v66, v66
    s_nop 0
    v_add_f32 v66, 1.0, v66
    v_rcp_f32 v66, v66
    s_nop 0
    v_mul_f32 v63, v63, v66
    v_cvt_pk_bf16_f32 v60, v62, v63
    v_and_b32 v63, 0xffff0000, v60
    v_lshlrev_b32 v62, 16, v60
    v_mul_f32 v62, v62, v64
    v_mul_f32 v63, v63, v65
    v_cvt_pk_bf16_f32 v50, v62, v63
    v_cvt_pk_bf16_f32 v60, v12, v13
    v_cvt_pk_bf16_f32 v61, v20, v21
    v_and_b32 v63, 0xffff0000, v60
    v_lshlrev_b32 v62, 16, v60
    v_and_b32 v65, 0xffff0000, v61
    v_lshlrev_b32 v64, 16, v61
    v_mul_f32 v66, 0xbfb8aa3b, v62
    v_exp_f32 v66, v66
    s_nop 0
    v_add_f32 v66, 1.0, v66
    v_rcp_f32 v66, v66
    s_nop 0
    v_mul_f32 v62, v62, v66
    v_mul_f32 v66, 0xbfb8aa3b, v63
    v_exp_f32 v66, v66
    s_nop 0
    v_add_f32 v66, 1.0, v66
    v_rcp_f32 v66, v66
    s_nop 0
    v_mul_f32 v63, v63, v66
    v_cvt_pk_bf16_f32 v60, v62, v63
    v_and_b32 v63, 0xffff0000, v60
    v_lshlrev_b32 v62, 16, v60
    v_mul_f32 v62, v62, v64
    v_mul_f32 v63, v63, v65
    v_cvt_pk_bf16_f32 v49, v62, v63
    v_cvt_pk_bf16_f32 v60, v14, v15
    v_cvt_pk_bf16_f32 v61, v22, v23
    v_and_b32 v63, 0xffff0000, v60
    v_lshlrev_b32 v62, 16, v60
    v_and_b32 v65, 0xffff0000, v61
    v_lshlrev_b32 v64, 16, v61
    v_mul_f32 v66, 0xbfb8aa3b, v62
    v_exp_f32 v66, v66
    s_nop 0
    v_add_f32 v66, 1.0, v66
    v_rcp_f32 v66, v66
    s_nop 0
    v_mul_f32 v62, v62, v66
    v_mul_f32 v66, 0xbfb8aa3b, v63
    v_exp_f32 v66, v66
    s_nop 0
    v_add_f32 v66, 1.0, v66
    v_rcp_f32 v66, v66
    s_nop 0
    v_mul_f32 v63, v63, v66
    v_cvt_pk_bf16_f32 v60, v62, v63
    v_and_b32 v63, 0xffff0000, v60
    v_lshlrev_b32 v62, 16, v60
    v_mul_f32 v62, v62, v64
    v_mul_f32 v63, v63, v65
    v_cvt_pk_bf16_f32 v51, v62, v63
    s_nop 1
    v_permlane16_swap_b32 v48, v49
    v_permlane16_swap_b32 v50, v51
    v_mov_b32 v52, v48
    v_mov_b32 v53, v50
    v_mov_b32 v54, v49
    v_mov_b32 v55, v51
    buffer_store_dwordx4 v[52:55], v59, s[4:7], s48 offen sc1
    s_waitcnt vmcnt(0)
    s_barrier
    s_cmp_lg_u32 s28, 0
    s_cbranch_scc1 fp_99
    s_lshl_b32 s34, s29, 7
    s_add_u32 s34, s34, 0x6460000
    v_mov_b32 v48, s51
    v_mov_b32 v49, 0
    s_mov_b64 exec, 1
    buffer_store_dword v48, v49, s[4:7], s34 offen sc1
    s_mov_b64 exec, -1
fp_99:
    s_mov_b32 s31, s51
    s_mov_b32 s50, s52
    s_cmp_lt_u32 s31, 64
    s_cbranch_scc1 F1_94
    s_branch END
ROLE_F2:
    s_load_dwordx2 s[8:9], s[0:1], 80
    s_mov_b32 s10, 0x21c000
    s_mov_b32 s11, 0x20000
    s_load_dwordx2 s[20:21], s[0:1], 0
    s_mov_b32 s22, 0x280000
    s_mov_b32 s23, 0x20000
    s_load_dwordx2 s[24:25], s[0:1], 88
    s_mov_b32 s26, 0x280000
    s_mov_b32 s27, 0x20000
    s_waitcnt lgkmcnt(0)
    s_cmp_lg_u32 s28, 0
    s_cbranch_scc1 w0_100
    v_mov_b32 v49, 128
dw_101:
    buffer_load_dword v48, v49, s[16:19], 0 offen sc1
    s_waitcnt vmcnt(0)
    v_readfirstlane_b32 s34, v48
    s_sub_u32 s33, s33, 1
    s_cbranch_scc1 END
    s_sleep 8
    s_cmp_lt_u32 s34, 64
    s_cbranch_scc1 dw_101
w0_100:
    s_barrier
    s_sub_u32 s42, s29, 227
    s_lshl_b32 s46, s42, 6
    v_lshrrev_b32 v48, 4, v1
    v_and_b32 v49, 15, v1
    v_lshlrev_b32 v50, 1, v48
    v_xor_b32 v49, v49, v50
    s_lshr_b32 s34, s28, 1
    s_lshl_b32 s34, s34, 3
    v_xor_b32 v49, s34, v49
    v_lshrrev_b32 v50, 2, v49
    v_lshlrev_b32 v50, 5, v50
    v_add_u32 v48, v48, v50
    v_and_b32 v49, 3, v49
    s_mov_b32 s34, 1280
    v_mul_lo_u32 v48, v48, s34
    v_lshlrev_b32 v49, 4, v49
    v_add_u32 v5, v48, v49
    s_mul_i32 s41, s28, 5120
    s_add_u32 s41, s41, s46
    s_lshl_b32 s40, s28, 10
    s_add_u32 s40, s40, 0
    s_mov_b32 m0, s40
    s_nop 0
    buffer_load_dwordx4 v5, s[8:11], s41 offen lds
    s_add_u32 s40, s40, 4096
    s_add_u32 s41, s41, 20480
    s_mov_b32 m0, s40
    s_nop 0
    buffer_load_dwordx4 v5, s[8:11], s41 offen lds
    s_add_u32 s40, s40, 4096
    s_add_u32 s41, s41, 143360
    s_mov_b32 m0, s40
    s_nop 0
    buffer_load_dwordx4 v5, s[8:11], s41 offen lds
    s_add_u32 s40, s40, 4096
    s_add_u32 s41, s41, 20480
    s_mov_b32 m0, s40
    s_nop 0
    buffer_load_dwordx4 v5, s[8:11], s41 offen lds
    s_add_u32 s40, s40, 4096
    s_add_u32 s41, s41, 143360
    s_mov_b32 m0, s40
    s_nop 0
    buffer_load_dwordx4 v5, s[8:11], s41 offen lds
    s_add_u32 s40, s40, 4096
    s_add_u32 s41, s41, 20480
    s_mov_b32 m0, s40
    s_nop 0
    buffer_load_dwordx4 v5, s[8:11], s41 offen lds
    s_add_u32 s40, s40, 4096
    s_add_u32 s41, s41, 143360
    s_mov_b32 m0, s40
    s_nop 0
    buffer_load_dwordx4 v5, s[8:11], s41 offen lds
    s_add_u32 s40, s40, 4096
    s_add_u32 s41, s41, 20480
    s_mov_b32 m0, s40
    s_nop 0
    buffer_load_dwordx4 v5, s[8:11], s41 offen lds
    s_add_u32 s40, s40, 4096
    s_add_u32 s41, s41, 143360
    s_mov_b32 m0, s40
    s_nop 0
    buffer_load_dwordx4 v5, s[8:11], s41 offen lds
    s_add_u32 s40, s40, 4096
    s_add_u32 s41, s41, 20480
    s_mov_b32 m0, s40
    s_nop 0
    buffer_load_dwordx4 v5, s[8:11], s41 offen lds
    s_add_u32 s40, s40, 4096
    s_add_u32 s41, s41, 143360
    s_mov_b32 m0, s40
    s_nop 0
    buffer_load_dwordx4 v5, s[8:11], s41 offen lds
    s_add_u32 s40, s40, 4096
    s_add_u32 s41, s41, 20480
    s_mov_b32 m0, s40
    s_nop 0
    buffer_load_dwordx4 v5, s[8:11], s41 offen lds
    s_add_u32 s40, s40, 4096
    s_add_u32 s41, s41, 143360
    s_mov_b32 m0, s40
    s_nop 0
    buffer_load_dwordx4 v5, s[8:11], s41 offen lds
    s_add_u32 s40, s40, 4096
    s_add_u32 s41, s41, 20480
    s_mov_b32 m0, s40
    s_nop 0
    buffer_load_dwordx4 v5, s[8:11], s41 offen lds
    s_add_u32 s40, s40, 4096
    s_add_u32 s41, s41, 143360
    s_mov_b32 m0, s40
    s_nop 0
    buffer_load_dwordx4 v5, s[8:11], s41 offen lds
    s_add_u32 s40, s40, 4096
    s_add_u32 s41, s41, 20480
    s_mov_b32 m0, s40
    s_nop 0
    buffer_load_dwordx4 v5, s[8:11], s41 offen lds
    s_add_u32 s40, s40, 4096
    s_add_u32 s41, s41, 143360
    s_mov_b32 m0, s40
    s_nop 0
    buffer_load_dwordx4 v5, s[8:11], s41 offen lds
    s_add_u32 s40, s40, 4096
    s_add_u32 s41, s41, 20480
    s_mov_b32 m0, s40
    s_nop 0
    buffer_load_dwordx4 v5, s[8:11], s41 offen lds
    s_add_u32 s40, s40, 4096
    s_add_u32 s41, s41, 143360
    s_mov_b32 m0, s40
    s_nop 0
    buffer_load_dwordx4 v5, s[8:11], s41 offen lds
    s_add_u32 s40, s40, 4096
    s_add_u32 s41, s41, 20480
    s_mov_b32 m0, s40
    s_nop 0
    buffer_load_dwordx4 v5, s[8:11], s41 offen lds
    s_add_u32 s40, s40, 4096
    s_add_u32 s41, s41, 143360
    s_mov_b32 m0, s40
    s_nop 0
    buffer_load_dwordx4 v5, s[8:11], s41 offen lds
    s_add_u32 s40, s40, 4096
    s_add_u32 s41, s41, 20480
    s_mov_b32 m0, s40
    s_nop 0
    buffer_load_dwordx4 v5, s[8:11], s41 offen lds
    s_add_u32 s40, s40, 4096
    s_add_u32 s41, s41, 143360
    s_mov_b32 m0, s40
    s_nop 0
    buffer_load_dwordx4 v5, s[8:11], s41 offen lds
    s_add_u32 s40, s40, 4096
    s_add_u32 s41, s41, 20480
    s_mov_b32 m0, s40
    s_nop 0
    buffer_load_dwordx4 v5, s[8:11], s41 offen lds
    s_add_u32 s40, s40, 4096
    s_add_u32 s41, s41, 143360
    s_mov_b32 m0, s40
    s_nop 0
    buffer_load_dwordx4 v5, s[8:11], s41 offen lds
    s_add_u32 s40, s40, 4096
    s_add_u32 s41, s41, 20480
    s_mov_b32 m0, s40
    s_nop 0
    buffer_load_dwordx4 v5, s[8:11], s41 offen lds
    s_add_u32 s40, s40, 4096
    s_add_u32 s41, s41, 143360
    s_mov_b32 m0, s40
    s_nop 0
    buffer_load_dwordx4 v5, s[8:11], s41 offen lds
    s_add_u32 s40, s40, 4096
    s_add_u32 s41, s41, 20480
    s_mov_b32 m0, s40
    s_nop 0
    buffer_load_dwordx4 v5, s[8:11], s41 offen lds
    v_lshrrev_b32 v48, 4, v1
    v_bfe_u32 v49, v1, 2, 2
    v_and_b32 v52, 3, v1
    v_add_u32 v50, 0, v52
    v_mov_b32 v51, 0
    v_and_b32 v53, 1, v48
    v_lshl_or_b32 v53, v53, 2, v49
    v_lshlrev_b32 v53, 1, v53
    v_xor_b32 v50, v50, v53
    v_lshlrev_b32 v50, 4, v50
    v_lshl_add_u32 v50, v51, 3, v50
    v_lshl_add_u32 v50, v49, 8, v50
    v_lshl_add_u32 v6, v48, 11, v50
    v_lshrrev_b32 v48, 4, v1
    v_bfe_u32 v49, v1, 2, 2
    v_and_b32 v52, 3, v1
    v_add_u32 v50, 0, v52
    v_mov_b32 v51, 1
    v_and_b32 v53, 1, v48
    v_lshl_or_b32 v53, v53, 2, v49
    v_lshlrev_b32 v53, 1, v53
    v_xor_b32 v50, v50, v53
    v_lshlrev_b32 v50, 4, v50
    v_lshl_add_u32 v50, v51, 3, v50
    v_lshl_add_u32 v50, v49, 8, v50
    v_lshl_add_u32 v7, v48, 11, v50
    s_mul_i32 s47, s28, 14
    s_waitcnt vmcnt(0)
    s_barrier
    s_and_b32 s34, s28, 1
    s_cmp_eq_u32 s34, 1
    s_cbranch_scc1 f2odd_103
    s_lshr_b32 s34, s47, 2
    s_lshl_b32 s34, s34, 13
    v_xor_b32 v48, 0, v6
    v_add_u32 v48, s34, v48
    v_xor_b32 v49, 64, v6
    v_add_u32 v49, s34, v49
    v_xor_b32 v50, 128, v6
    v_add_u32 v50, s34, v50
    v_xor_b32 v51, 192, v6
    v_add_u32 v51, s34, v51
    v_xor_b32 v52, 0, v7
    v_add_u32 v52, s34, v52
    v_xor_b32 v53, 64, v7
    v_add_u32 v53, s34, v53
    v_xor_b32 v54, 128, v7
    v_add_u32 v54, s34, v54
    v_xor_b32 v55, 192, v7
    v_add_u32 v55, s34, v55
    ds_read_b64_tr_b16 a[0:1], v48 offset:0
    ds_read_b64_tr_b16 a[2:3], v48 offset:1024
    ds_read_b64_tr_b16 a[56:57], v52 offset:0
    ds_read_b64_tr_b16 a[58:59], v52 offset:1024
    ds_read_b64_tr_b16 a[4:5], v49 offset:0
    ds_read_b64_tr_b16 a[6:7], v49 offset:1024
    ds_read_b64_tr_b16 a[60:61], v53 offset:0
    ds_read_b64_tr_b16 a[62:63], v53 offset:1024
    ds_read_b64_tr_b16 a[8:9], v50 offset:0
    ds_read_b64_tr_b16 a[10:11], v50 offset:1024
    ds_read_b64_tr_b16 a[64:65], v54 offset:0
    ds_read_b64_tr_b16 a[66:67], v54 offset:1024
    ds_read_b64_tr_b16 a[12:13], v51 offset:0
    ds_read_b64_tr_b16 a[14:15], v51 offset:1024
    ds_read_b64_tr_b16 a[68:69], v55 offset:0
    ds_read_b64_tr_b16 a[70:71], v55 offset:1024
    s_waitcnt lgkmcnt(0)
    ds_read_b64_tr_b16 a[16:17], v48 offset:8192
    ds_read_b64_tr_b16 a[18:19], v48 offset:9216
    ds_read_b64_tr_b16 a[72:73], v52 offset:8192
    ds_read_b64_tr_b16 a[74:75], v52 offset:9216
    ds_read_b64_tr_b16 a[20:21], v49 offset:8192
    ds_read_b64_tr_b16 a[22:23], v49 offset:9216
    ds_read_b64_tr_b16 a[76:77], v53 offset:8192
    ds_read_b64_tr_b16 a[78:79], v53 offset:9216
    ds_read_b64_tr_b16 a[24:25], v50 offset:8192
    ds_read_b64_tr_b16 a[26:27], v50 offset:9216
    ds_read_b64_tr_b16 a[80:81], v54 offset:8192
    ds_read_b64_tr_b16 a[82:83], v54 offset:9216
    ds_read_b64_tr_b16 a[28:29], v51 offset:8192
    ds_read_b64_tr_b16 a[30:31], v51 offset:9216
    ds_read_b64_tr_b16 a[84:85], v55 offset:8192
    ds_read_b64_tr_b16 a[86:87], v55 offset:9216
    s_waitcnt lgkmcnt(0)
    ds_read_b64_tr_b16 a[32:33], v48 offset:16384
    ds_read_b64_tr_b16 a[34:35], v48 offset:17408
    ds_read_b64_tr_b16 a[88:89], v52 offset:16384
    ds_read_b64_tr_b16 a[90:91], v52 offset:17408
    ds_read_b64_tr_b16 a[36:37], v49 offset:16384
    ds_read_b64_tr_b16 a[38:39], v49 offset:17408
    ds_read_b64_tr_b16 a[92:93], v53 offset:16384
    ds_read_b64_tr_b16 a[94:95], v53 offset:17408
    ds_read_b64_tr_b16 a[40:41], v50 offset:16384
    ds_read_b64_tr_b16 a[42:43], v50 offset:17408
    ds_read_b64_tr_b16 a[96:97], v54 offset:16384
    ds_read_b64_tr_b16 a[98:99], v54 offset:17408
    ds_read_b64_tr_b16 a[44:45], v51 offset:16384
    ds_read_b64_tr_b16 a[46:47], v51 offset:17408
    ds_read_b64_tr_b16 a[100:101], v55 offset:16384
    ds_read_b64_tr_b16 a[102:103], v55 offset:17408
    s_waitcnt lgkmcnt(0)
    ds_read_b64_tr_b16 a[48:49], v48 offset:24576
    ds_read_b64_tr_b16 a[50:51], v48 offset:25600
    ds_read_b64_tr_b16 a[104:105], v52 offset:24576
    ds_read_b64_tr_b16 a[106:107], v52 offset:25600
    ds_read_b64_tr_b16 a[52:53], v49 offset:24576
    ds_read_b64_tr_b16 a[54:55], v49 offset:25600
    ds_read_b64_tr_b16 a[108:109], v53 offset:24576
    ds_read_b64_tr_b16 a[110:111], v53 offset:25600
    s_waitcnt lgkmcnt(0)
    s_branch f2join_104
f2odd_103:
    s_lshr_b32 s34, s47, 2
    s_lshl_b32 s34, s34, 13
    v_xor_b32 v48, 0, v6
    v_add_u32 v48, s34, v48
    v_xor_b32 v49, 64, v6
    v_add_u32 v49, s34, v49
    v_xor_b32 v50, 128, v6
    v_add_u32 v50, s34, v50
    v_xor_b32 v51, 192, v6
    v_add_u32 v51, s34, v51
    v_xor_b32 v52, 0, v7
    v_add_u32 v52, s34, v52
    v_xor_b32 v53, 64, v7
    v_add_u32 v53, s34, v53
    v_xor_b32 v54, 128, v7
    v_add_u32 v54, s34, v54
    v_xor_b32 v55, 192, v7
    v_add_u32 v55, s34, v55
    ds_read_b64_tr_b16 a[0:1], v50 offset:0
    ds_read_b64_tr_b16 a[2:3], v50 offset:1024
    ds_read_b64_tr_b16 a[56:57], v54 offset:0
    ds_read_b64_tr_b16 a[58:59], v54 offset:1024
    ds_read_b64_tr_b16 a[4:5], v51 offset:0
    ds_read_b64_tr_b16 a[6:7], v51 offset:1024
    ds_read_b64_tr_b16 a[60:61], v55 offset:0
    ds_read_b64_tr_b16 a[62:63], v55 offset:1024
    ds_read_b64_tr_b16 a[8:9], v48 offset:8192
    ds_read_b64_tr_b16 a[10:11], v48 offset:9216
    ds_read_b64_tr_b16 a[64:65], v52 offset:8192
    ds_read_b64_tr_b16 a[66:67], v52 offset:9216
    ds_read_b64_tr_b16 a[12:13], v49 offset:8192
    ds_read_b64_tr_b16 a[14:15], v49 offset:9216
    ds_read_b64_tr_b16 a[68:69], v53 offset:8192
    ds_read_b64_tr_b16 a[70:71], v53 offset:9216
    s_waitcnt lgkmcnt(0)
    ds_read_b64_tr_b16 a[16:17], v50 offset:8192
    ds_read_b64_tr_b16 a[18:19], v50 offset:9216
    ds_read_b64_tr_b16 a[72:73], v54 offset:8192
    ds_read_b64_tr_b16 a[74:75], v54 offset:9216
    ds_read_b64_tr_b16 a[20:21], v51 offset:8192
    ds_read_b64_tr_b16 a[22:23], v51 offset:9216
    ds_read_b64_tr_b16 a[76:77], v55 offset:8192
    ds_read_b64_tr_b16 a[78:79], v55 offset:9216
    ds_read_b64_tr_b16 a[24:25], v48 offset:16384
    ds_read_b64_tr_b16 a[26:27], v48 offset:17408
    ds_read_b64_tr_b16 a[80:81], v52 offset:16384
    ds_read_b64_tr_b16 a[82:83], v52 offset:17408
    ds_read_b64_tr_b16 a[28:29], v49 offset:16384
    ds_read_b64_tr_b16 a[30:31], v49 offset:17408
    ds_read_b64_tr_b16 a[84:85], v53 offset:16384
    ds_read_b64_tr_b16 a[86:87], v53 offset:17408
    s_waitcnt lgkmcnt(0)
    ds_read_b64_tr_b16 a[32:33], v50 offset:16384
    ds_read_b64_tr_b16 a[34:35], v50 offset:17408
    ds_read_b64_tr_b16 a[88:89], v54 offset:16384
    ds_read_b64_tr_b16 a[90:91], v54 offset:17408
    ds_read_b64_tr_b16 a[36:37], v51 offset:16384
    ds_read_b64_tr_b16 a[38:39], v51 offset:17408
    ds_read_b64_tr_b16 a[92:93], v55 offset:16384
    ds_read_b64_tr_b16 a[94:95], v55 offset:17408
    ds_read_b64_tr_b16 a[40:41], v48 offset:24576
    ds_read_b64_tr_b16 a[42:43], v48 offset:25600
    ds_read_b64_tr_b16 a[96:97], v52 offset:24576
    ds_read_b64_tr_b16 a[98:99], v52 offset:25600
    ds_read_b64_tr_b16 a[44:45], v49 offset:24576
    ds_read_b64_tr_b16 a[46:47], v49 offset:25600
    ds_read_b64_tr_b16 a[100:101], v53 offset:24576
    ds_read_b64_tr_b16 a[102:103], v53 offset:25600
    s_waitcnt lgkmcnt(0)
    ds_read_b64_tr_b16 a[48:49], v50 offset:24576
    ds_read_b64_tr_b16 a[50:51], v50 offset:25600
    ds_read_b64_tr_b16 a[104:105], v54 offset:24576
    ds_read_b64_tr_b16 a[106:107], v54 offset:25600
    ds_read_b64_tr_b16 a[52:53], v51 offset:24576
    ds_read_b64_tr_b16 a[54:55], v51 offset:25600
    ds_read_b64_tr_b16 a[108:109], v55 offset:24576
    ds_read_b64_tr_b16 a[110:111], v55 offset:25600
    s_waitcnt lgkmcnt(0)
f2join_104:
    s_barrier
    v_lshlrev_b32 v2, 4, v1
    v_lshrrev_b32 v3, 4, v1
    v_lshlrev_b32 v3, 9, v3
    v_and_b32 v4, 15, v1
    v_lshl_add_u32 v3, v4, 4, v3
    s_lshl_b32 s34, s47, 11
    v_add_u32 v4, s34, v3
    v_min_u32 v5, 26, v1
    v_add_u32 v5, 200, v5
    v_lshlrev_b32 v5, 7, v5
    v_add_u32 v5, 0x6460000, v5
    v_and_b32 v48, 15, v1
    v_lshrrev_b32 v49, 4, v1
    s_mul_i32 s34, s28, 4608
    v_mul_u32_u24 v6, 144, v48
    v_lshl_add_u32 v6, v49, 5, v6
    v_add_u32 v6, s34, v6
    v_lshrrev_b32 v48, 3, v0
    v_and_b32 v49, 7, v0
    v_mul_u32_u24 v7, 144, v48
    v_lshl_add_u32 v7, v49, 4, v7
    v_lshlrev_b32 v59, 3, v0
    v_mov_b32 v49, 36
dw_106:
    buffer_load_dword v48, v49, s[16:19], 0 offen sc1
    s_waitcnt vmcnt(0)
    v_readfirstlane_b32 s34, v48
    s_sub_u32 s33, s33, 1
    s_cbranch_scc1 END
    s_sleep 2
    s_cmp_lt_u32 s34, 192
    s_cbranch_scc1 dw_106
    s_mov_b32 s31, 0
    s_mov_b32 s53, 0
F2_107:
    s_add_u32 s51, s31, 1
    s_cmp_ge_u32 s53, s51
    s_cbranch_scc1 f2d_109
f2p_108:
    buffer_load_dword v48, v5, s[4:7], 0 offen sc1
    s_waitcnt vmcnt(0)
    v_cmp_gt_u32 vcc, s51, v48
    s_sub_u32 s33, s33, 1
    s_cbranch_scc1 END
    s_cbranch_vccz f2q_110
    s_sleep 4
    s_branch f2p_108
f2q_110:
    v_mov_b32 v49, v48
    s_nop 1
    v_mov_b32_dpp v49, v48 row_ror:1 row_mask:0xf bank_mask:0xf
    s_nop 1
    v_min_u32 v48, v48, v49
    v_mov_b32 v49, v48
    s_nop 1
    v_mov_b32_dpp v49, v48 row_ror:2 row_mask:0xf bank_mask:0xf
    s_nop 1
    v_min_u32 v48, v48, v49
    v_mov_b32 v49, v48
    s_nop 1
    v_mov_b32_dpp v49, v48 row_ror:4 row_mask:0xf bank_mask:0xf
    s_nop 1
    v_min_u32 v48, v48, v49
    v_mov_b32 v49, v48
    s_nop 1
    v_mov_b32_dpp v49, v48 row_ror:8 row_mask:0xf bank_mask:0xf
    s_nop 1
    v_min_u32 v48, v48, v49
    s_nop 0
    v_readlane_b32 s53, v48, 0
    v_readlane_b32 s34, v48, 16
    s_min_u32 s53, s53, s34
f2d_109:
    s_mul_i32 s48, s31, 110592
    s_add_u32 s48, s48, 0x3400000
    buffer_load_dwordx4 v[64:67], v4, s[4:7], s48 offen offset:0 sc1
    buffer_load_dwordx4 v[68:71], v4, s[4:7], s48 offen offset:256 sc1
    s_add_u32 s48, s48, 2048
    buffer_load_dwordx4 v[72:75], v4, s[4:7], s48 offen offset:0 sc1
    buffer_load_dwordx4 v[76:79], v4, s[4:7], s48 offen offset:256 sc1
    s_add_u32 s48, s48, 2048
    buffer_load_dwordx4 v[80:83], v4, s[4:7], s48 offen offset:0 sc1
    buffer_load_dwordx4 v[84:87], v4, s[4:7], s48 offen offset:256 sc1
    s_add_u32 s48, s48, 2048
    buffer_load_dwordx4 v[88:91], v4, s[4:7], s48 offen offset:0 sc1
    buffer_load_dwordx4 v[92:95], v4, s[4:7], s48 offen offset:256 sc1
    s_add_u32 s48, s48, 2048
    buffer_load_dwordx4 v[96:99], v4, s[4:7], s48 offen offset:0 sc1
    buffer_load_dwordx4 v[100:103], v4, s[4:7], s48 offen offset:256 sc1
    s_add_u32 s48, s48, 2048
    buffer_load_dwordx4 v[104:107], v4, s[4:7], s48 offen offset:0 sc1
    buffer_load_dwordx4 v[108:111], v4, s[4:7], s48 offen offset:256 sc1
    s_add_u32 s48, s48, 2048
    buffer_load_dwordx4 v[112:115], v4, s[4:7], s48 offen offset:0 sc1
    buffer_load_dwordx4 v[116:119], v4, s[4:7], s48 offen offset:256 sc1
    s_add_u32 s48, s48, 2048
    buffer_load_dwordx4 v[120:123], v4, s[4:7], s48 offen offset:0 sc1
    buffer_load_dwordx4 v[124:127], v4, s[4:7], s48 offen offset:256 sc1
    s_add_u32 s48, s48, 2048
    buffer_load_dwordx4 v[128:131], v4, s[4:7], s48 offen offset:0 sc1
    buffer_load_dwordx4 v[132:135], v4, s[4:7], s48 offen offset:256 sc1
    s_add_u32 s48, s48, 2048
    buffer_load_dwordx4 v[136:139], v4, s[4:7], s48 offen offset:0 sc1
    buffer_load_dwordx4 v[140:143], v4, s[4:7], s48 offen offset:256 sc1
    s_add_u32 s48, s48, 2048
    buffer_load_dwordx4 v[144:147], v4, s[4:7], s48 offen offset:0 sc1
    buffer_load_dwordx4 v[148:151], v4, s[4:7], s48 offen offset:256 sc1
    s_add_u32 s48, s48, 2048
    buffer_load_dwordx4 v[152:155], v4, s[4:7], s48 offen offset:0 sc1
    buffer_load_dwordx4 v[156:159], v4, s[4:7], s48 offen offset:256 sc1
    s_add_u32 s48, s48, 2048
    s_cmp_eq_u32 s28, 3
    s_cbranch_scc1 f2sk_111
    buffer_load_dwordx4 v[160:163], v4, s[4:7], s48 offen offset:0 sc1
    buffer_load_dwordx4 v[164:167], v4, s[4:7], s48 offen offset:256 sc1
    s_add_u32 s48, s48, 2048
    buffer_load_dwordx4 v[168:171], v4, s[4:7], s48 offen offset:0 sc1
    buffer_load_dwordx4 v[172:175], v4, s[4:7], s48 offen offset:256 sc1
    s_add_u32 s48, s48, 2048
f2sk_111:
    s_waitcnt vmcnt(0)
    v_mfma_f32_16x16x32_bf16 v[8:11], a[0:3], v[64:67], 0
    v_mfma_f32_16x16x32_bf16 v[16:19], a[56:59], v[64:67], 0
    v_mfma_f32_16x16x32_bf16 v[12:15], a[0:3], v[68:71], 0
    v_mfma_f32_16x16x32_bf16 v[20:23], a[56:59], v[68:71], 0
    v_mfma_f32_16x16x32_bf16 v[8:11], a[4:7], v[72:75], v[8:11]
    v_mfma_f32_16x16x32_bf16 v[16:19], a[60:63], v[72:75], v[16:19]
    v_mfma_f32_16x16x32_bf16 v[12:15], a[4:7], v[76:79], v[12:15]
    v_mfma_f32_16x16x32_bf16 v[20:23], a[60:63], v[76:79], v[20:23]
    v_mfma_f32_16x16x32_bf16 v[8:11], a[8:11], v[80:83], v[8:11]
    v_mfma_f32_16x16x32_bf16 v[16:19], a[64:67], v[80:83], v[16:19]
    v_mfma_f32_16x16x32_bf16 v[12:15], a[8:11], v[84:87], v[12:15]
    v_mfma_f32_16x16x32_bf16 v[20:23], a[64:67], v[84:87], v[20:23]
    v_mfma_f32_16x16x32_bf16 v[8:11], a[12:15], v[88:91], v[8:11]
    v_mfma_f32_16x16x32_bf16 v[16:19], a[68:71], v[88:91], v[16:19]
    v_mfma_f32_16x16x32_bf16 v[12:15], a[12:15], v[92:95], v[12:15]
    v_mfma_f32_16x16x32_bf16 v[20:23], a[68:71], v[92:95], v[20:23]
    v_mfma_f32_16x16x32_bf16 v[8:11], a[16:19], v[96:99], v[8:11]
    v_mfma_f32_16x16x32_bf16 v[16:19], a[72:75], v[96:99], v[16:19]
    v_mfma_f32_16x16x32_bf16 v[12:15], a[16:19], v[100:103], v[12:15]
    v_mfma_f32_16x16x32_bf16 v[20:23], a[72:75], v[100:103], v[20:23]
    v_mfma_f32_16x16x32_bf16 v[8:11], a[20:23], v[104:107], v[8:11]
    v_mfma_f32_16x16x32_bf16 v[16:19], a[76:79], v[104:107], v[16:19]
    v_mfma_f32_16x16x32_bf16 v[12:15], a[20:23], v[108:111], v[12:15]
    v_mfma_f32_16x16x32_bf16 v[20:23], a[76:79], v[108:111], v[20:23]
    v_mfma_f32_16x16x32_bf16 v[8:11], a[24:27], v[112:115], v[8:11]
    v_mfma_f32_16x16x32_bf16 v[16:19], a[80:83], v[112:115], v[16:19]
    v_mfma_f32_16x16x32_bf16 v[12:15], a[24:27], v[116:119], v[12:15]
    v_mfma_f32_16x16x32_bf16 v[20:23], a[80:83], v[116:119], v[20:23]
    v_mfma_f32_16x16x32_bf16 v[8:11], a[28:31], v[120:123], v[8:11]
    v_mfma_f32_16x16x32_bf16 v[16:19], a[84:87], v[120:123], v[16:19]
    v_mfma_f32_16x16x32_bf16 v[12:15], a[28:31], v[124:127], v[12:15]
    v_mfma_f32_16x16x32_bf16 v[20:23], a[84:87], v[124:127], v[20:23]
    v_mfma_f32_16x16x32_bf16 v[8:11], a[32:35], v[128:131], v[8:11]
    v_mfma_f32_16x16x32_bf16 v[16:19], a[88:91], v[128:131], v[16:19]
    v_mfma_f32_16x16x32_bf16 v[12:15], a[32:35], v[132:135], v[12:15]
    v_mfma_f32_16x16x32_bf16 v[20:23], a[88:91], v[132:135], v[20:23]
    v_mfma_f32_16x16x32_bf16 v[8:11], a[36:39], v[136:139], v[8:11]
    v_mfma_f32_16x16x32_bf16 v[16:19], a[92:95], v[136:139], v[16:19]
    v_mfma_f32_16x16x32_bf16 v[12:15], a[36:39], v[140:143], v[12:15]
    v_mfma_f32_16x16x32_bf16 v[20:23], a[92:95], v[140:143], v[20:23]
    v_mfma_f32_16x16x32_bf16 v[8:11], a[40:43], v[144:147], v[8:11]
    v_mfma_f32_16x16x32_bf16 v[16:19], a[96:99], v[144:147], v[16:19]
    v_mfma_f32_16x16x32_bf16 v[12:15], a[40:43], v[148:151], v[12:15]
    v_mfma_f32_16x16x32_bf16 v[20:23], a[96:99], v[148:151], v[20:23]
    v_mfma_f32_16x16x32_bf16 v[8:11], a[44:47], v[152:155], v[8:11]
    v_mfma_f32_16x16x32_bf16 v[16:19], a[100:103], v[152:155], v[16:19]
    v_mfma_f32_16x16x32_bf16 v[12:15], a[44:47], v[156:159], v[12:15]
    v_mfma_f32_16x16x32_bf16 v[20:23], a[100:103], v[156:159], v[20:23]
    s_cmp_eq_u32 s28, 3
    s_cbranch_scc1 f2sk2_112
    v_mfma_f32_16x16x32_bf16 v[8:11], a[48:51], v[160:163], v[8:11]
    v_mfma_f32_16x16x32_bf16 v[16:19], a[104:107], v[160:163], v[16:19]
    v_mfma_f32_16x16x32_bf16 v[12:15], a[48:51], v[164:167], v[12:15]
    v_mfma_f32_16x16x32_bf16 v[20:23], a[104:107], v[164:167], v[20:23]
    v_mfma_f32_16x16x32_bf16 v[8:11], a[52:55], v[168:171], v[8:11]
    v_mfma_f32_16x16x32_bf16 v[16:19], a[108:111], v[168:171], v[16:19]
    v_mfma_f32_16x16x32_bf16 v[12:15], a[52:55], v[172:175], v[12:15]
    v_mfma_f32_16x16x32_bf16 v[20:23], a[108:111], v[172:175], v[20:23]
f2sk2_112:
    s_nop 7
    ds_write_b128 v6, v[8:11] offset:0
    ds_write_b128 v6, v[16:19] offset:16
    ds_write_b128 v6, v[12:15] offset:2304
    ds_write_b128 v6, v[20:23] offset:2320
    s_waitcnt lgkmcnt(0)
    s_barrier
    ds_read_b128 v[24:27], v7 offset:0
    ds_read_b128 v[28:31], v7 offset:4608
    ds_read_b128 v[32:35], v7 offset:9216
    ds_read_b128 v[36:39], v7 offset:13824
    s_waitcnt lgkmcnt(0)
    s_barrier
    v_add_f32 v24, v24, v28
    v_add_f32 v25, v25, v29
    v_add_f32 v26, v26, v30
    v_add_f32 v27, v27, v31
    v_add_f32 v24, v24, v32
    v_add_f32 v25, v25, v33
    v_add_f32 v26, v26, v34
    v_add_f32 v27, v27, v35
    v_add_f32 v24, v24, v36
    v_add_f32 v25, v25, v37
    v_add_f32 v26, v26, v38
    v_add_f32 v27, v27, v39
    v_cvt_pk_bf16_f32 v28, v24, v25
    v_cvt_pk_bf16_f32 v29, v26, v27
    v_and_b32 v25, 0xffff0000, v28
    v_lshlrev_b32 v24, 16, v28
    v_and_b32 v27, 0xffff0000, v29
    v_lshlrev_b32 v26, 16, v29
    v_mul_f32 v30, 0xbfb8aa3b, v24
    v_exp_f32 v30, v30
    s_nop 0
    v_add_f32 v30, 1.0, v30
    v_rcp_f32 v30, v30
    s_nop 0
    v_mul_f32 v24, v24, v30
    v_mul_f32 v30, 0xbfb8aa3b, v25
    v_exp_f32 v30, v30
    s_nop 0
    v_add_f32 v30, 1.0, v30
    v_rcp_f32 v30, v30
    s_nop 0
    v_mul_f32 v25, v25, v30
    v_mul_f32 v30, 0xbfb8aa3b, v26
    v_exp_f32 v30, v30
    s_nop 0
    v_add_f32 v30, 1.0, v30
    v_rcp_f32 v30, v30
    s_nop 0
    v_mul_f32 v26, v26, v30
    v_mul_f32 v30, 0xbfb8aa3b, v27
    v_exp_f32 v30, v30
    s_nop 0
    v_add_f32 v30, 1.0, v30
    v_rcp_f32 v30, v30
    s_nop 0
    v_mul_f32 v27, v27, v30
    v_cvt_pk_bf16_f32 v28, v24, v25
    v_cvt_pk_bf16_f32 v29, v26, v27
    s_mul_i32 s48, s31, 40960
    s_lshl_b32 s49, s42, 11
    s_add_u32 s48, s48, s49
    s_add_u32 s48, s48, 0x3c00000
    buffer_store_dwordx2 v[28:29], v59, s[4:7], s48 offen
    s_mov_b32 s31, s51
    s_cmp_lt_u32 s31, 64
    s_cbranch_scc1 F2_107
    s_waitcnt vmcnt(0)
    v_lshrrev_b32 v48, 3, v0
    v_and_b32 v49, 7, v0
    s_mov_b32 s34, 2560
    v_mul_lo_u32 v4, v48, s34
    v_lshl_add_u32 v4, v49, 4, v4
    s_lshl_b32 s34, s42, 7
    v_add_u32 v4, s34, v4
    v_bfe_u32 v50, v48, 2, 2
    v_lshlrev_b32 v50, 3, v50
    v_lshrrev_b32 v51, 4, v48
    v_lshl_add_u32 v50, v51, 2, v50
    v_and_b32 v51, 3, v48
    v_add_u32 v50, v50, v51
    s_mov_b32 s34, 1280
    v_mul_lo_u32 v6, v50, s34
    v_lshl_add_u32 v6, v49, 3, v6
    s_lshl_b32 s34, s42, 6
    v_add_u32 v6, s34, v6
    v_and_b32 v5, 3, v1
    v_mul_u32_u24 v5, 10, v5
    s_lshr_b32 s34, s42, 1
    s_add_u32 s34, s34, 160
    v_add_u32 v5, s34, v5
    v_lshlrev_b32 v5, 7, v5
    v_add_u32 v5, 0x6460000, v5
    s_mov_b32 s31, 0
    s_mov_b32 s53, 0
FIN_113:
    s_add_u32 s51, s31, 1
    s_mul_i32 s48, s31, 40960
    s_lshl_b32 s49, s42, 11
    s_add_u32 s49, s48, s49
    s_add_u32 s49, s49, 0x3c00000
    buffer_load_dwordx2 v[28:29], v59, s[4:7], s49 offen
    buffer_load_dwordx2 v[30:31], v6, s[20:23], s48 offen
    s_cmp_ge_u32 s53, s51
    s_cbranch_scc1 cd_115
cw_114:
    buffer_load_dword v48, v5, s[4:7], 0 offen sc1
    s_waitcnt vmcnt(0)
    v_readlane_b32 s53, v48, 0
    v_readlane_b32 s34, v48, 1
    s_min_u32 s53, s53, s34
    v_readlane_b32 s34, v48, 2
    s_min_u32 s53, s53, s34
    v_readlane_b32 s34, v48, 3
    s_min_u32 s53, s53, s34
    s_sub_u32 s33, s33, 1
    s_cbranch_scc1 END
    s_cmp_ge_u32 s53, s51
    s_cbranch_scc1 cd_115
    s_sleep 1
    s_branch cw_114
cd_115:
    s_mul_i32 s49, s31, 327680
    s_add_u32 s49, s49, 0x4000000
    buffer_load_dwordx4 v[8:11], v4, s[4:7], s49 offen sc1
    s_add_u32 s49, s49, 81920
    buffer_load_dwordx4 v[12:15], v4, s[4:7], s49 offen sc1
    s_add_u32 s49, s49, 81920
    buffer_load_dwordx4 v[16:19], v4, s[4:7], s49 offen sc1
    s_add_u32 s49, s49, 81920
    buffer_load_dwordx4 v[20:23], v4, s[4:7], s49 offen sc1
    s_waitcnt vmcnt(0)
    v_add_f32 v8, v8, v12
    v_add_f32 v16, v16, v20
    v_add_f32 v8, v8, v16
    v_add_f32 v9, v9, v13
    v_add_f32 v17, v17, v21
    v_add_f32 v9, v9, v17
    v_add_f32 v10, v10, v14
    v_add_f32 v18, v18, v22
    v_add_f32 v10, v10, v18
    v_add_f32 v11, v11, v15
    v_add_f32 v19, v19, v23
    v_add_f32 v11, v11, v19
    v_cvt_pk_bf16_f32 v12, v8, v9
    v_cvt_pk_bf16_f32 v13, v10, v11
    v_and_b32 v9, 0xffff0000, v12
    v_lshlrev_b32 v8, 16, v12
    v_and_b32 v11, 0xffff0000, v13
    v_lshlrev_b32 v10, 16, v13
    v_and_b32 v13, 0xffff0000, v28
    v_lshlrev_b32 v12, 16, v28
    v_and_b32 v15, 0xffff0000, v29
    v_lshlrev_b32 v14, 16, v29
    v_mul_f32 v8, v8, v12
    v_mul_f32 v9, v9, v13
    v_mul_f32 v10, v10, v14
    v_mul_f32 v11, v11, v15
    v_cvt_pk_bf16_f32 v12, v8, v9
    v_cvt_pk_bf16_f32 v13, v10, v11
    v_and_b32 v9, 0xffff0000, v12
    v_lshlrev_b32 v8, 16, v12
    v_and_b32 v11, 0xffff0000, v13
    v_lshlrev_b32 v10, 16, v13
    v_and_b32 v13, 0xffff0000, v30
    v_lshlrev_b32 v12, 16, v30
    v_and_b32 v15, 0xffff0000, v31
    v_lshlrev_b32 v14, 16, v31
    v_add_f32 v8, v8, v12
    v_add_f32 v9, v9, v13
    v_add_f32 v10, v10, v14
    v_add_f32 v11, v11, v15
    v_cvt_pk_bf16_f32 v12, v8, v9
    v_cvt_pk_bf16_f32 v13, v10, v11
    buffer_store_dwordx2 v[12:13], v6, s[24:27], s48 offen
    s_mov_b32 s31, s51
    s_cmp_lt_u32 s31, 64
    s_cbranch_scc1 FIN_113
    s_waitcnt vmcnt(0)
    s_branch END
.section .rodata,"a"
.p2align 6
.amdhsa_kernel recurrent_scan__memory_aug_recurrent_mem_tr__swiglu_ffn__prompt_kernel
  .amdhsa_next_free_vgpr 512
  .amdhsa_next_free_sgpr 102
  .amdhsa_accum_offset 256
  .amdhsa_group_segment_fixed_size 0
  .amdhsa_kernarg_size 112
  .amdhsa_user_sgpr_count 2
  .amdhsa_user_sgpr_kernarg_segment_ptr 1
  .amdhsa_system_sgpr_workgroup_id_x 1
.end_amdhsa_kernel
```
